```python
import torch

def _softmax(x, axis=-1):
    return torch.softmax(x, dim=axis)
def _gelu(x):
    return torch.nn.functional.gelu(x, approximate="tanh")
def _silu(x):
    return torch.nn.functional.silu(x)
def _sigmoid(x):
    return torch.sigmoid(x)
def _layernorm(x, axis=-1, eps=1e-5):
    m = x.mean(dim=axis, keepdim=True)
    v = x.var(dim=axis, keepdim=True, unbiased=False)
    return (x - m) / torch.sqrt(v + eps)
def _scatter_add(tgt, idx, src, axis=0):
    return tgt.clone().index_add_(axis, idx, src)
def _segment_sum(src, seg, n):
    out = torch.zeros((n,) + src.shape[1:], dtype=src.dtype)
    return out.index_add_(0, seg, src)
def _pad(x, pw):
    flat = tuple(v for pair in reversed(pw) for v in pair)
    return torch.nn.functional.pad(x, flat)

kernel_name = 'interleave_layers__sliding_block__glu_gated_swiglu__prompt'

def setup_inputs():

    _w = (lambda a: (lambda t: t.to(torch.bfloat16) if t.is_floating_point() else t)(torch.as_tensor(a)))
    def _A_setup():
        B, S, D = 1, 2048, 448
        return {
            "x": _w((lambda *s: torch.randn(*s, dtype=torch.bfloat16) * 0.05)(B, S, D)),
            "wqkv": _w((lambda *s: torch.randn(*s, dtype=torch.bfloat16) * 0.05)(D, 3 * D)),
            "wo": _w((lambda *s: torch.randn(*s, dtype=torch.bfloat16) * 0.05)(D, D)),
        }
    _A_in = _A_setup()

    def _B_setup():
        B, S, D, F = 1, 2048, 448, 1792
        return {
            "x": _w((lambda *s: torch.randn(*s, dtype=torch.bfloat16) * 0.05)(B, S, D)),
            "w1": _w((lambda *s: torch.randn(*s, dtype=torch.bfloat16) * 0.8)(D, F) * (2.0 / D) ** 0.5),
            "w3": _w((lambda *s: torch.randn(*s, dtype=torch.bfloat16) * 0.8)(D, F) * (2.0 / D) ** 0.5),
            "w2": _w((lambda *s: torch.randn(*s, dtype=torch.bfloat16) * 0.8)(F, D) * (2.0 / F) ** 0.5),
        }
    _B_in = _B_setup()

    return {
        "A_x": _A_in["x"],
        "A_wqkv": _A_in["wqkv"],
        "A_wo": _A_in["wo"],
        "B_x": _B_in["x"],
        "B_w1": _B_in["w1"],
        "B_w3": _B_in["w3"],
        "B_w2": _B_in["w2"],
    }

def reference(A_x, A_wqkv, A_wo, B_x, B_w1, B_w3, B_w2):
    def _A_ref(x, wqkv, wo):
        B, S, D = x.shape
        H = 16; Dh = D // H; W = 256
        qkv = (lambda x, *d: x.permute(*d))((x @ wqkv).reshape(B, S, 3, H, Dh), 2, 0, 3, 1, 4)
        q, k, v = qkv[0], qkv[1], qkv[2]
        scores = torch.einsum("bhqd,bhkd->bhqk", q, k) * (Dh ** -0.5)
        idx = torch.arange(S)
        mask = (idx[:, None] - idx[None, :] >= 0) & (idx[:, None] - idx[None, :] < W)
        scores = torch.where(mask[None, None], scores, -1e9)
        p = _softmax(scores, axis=-1)
        o = torch.einsum("bhqk,bhkd->bhqd", p, v)
        return (lambda x, *d: x.permute(*d))(o, 0, 2, 1, 3).reshape(B, S, D) @ wo

    def _B_ref(x, w1, w3, w2):
        gate = torch.einsum("bsd,df->bsf", x, w1)
        up = torch.einsum("bsd,df->bsf", x, w3)
        h = _silu(gate) * up
        out = torch.einsum("bsf,fd->bsd", h, w2)
        return out

    x = A_x
    x = x + _A_ref(_layernorm(x, axis=-1), A_wqkv, A_wo)
    x = x + _B_ref(_layernorm(x, axis=-1), B_w1, B_w3, B_w2)
    x = x + _A_ref(_layernorm(x, axis=-1), A_wqkv, A_wo)
    x = x + _B_ref(_layernorm(x, axis=-1), B_w1, B_w3, B_w2)
    return x
```

```asm
; @launch grid=(256,1,1) block=(256,1,1) lds=163840
.amdgcn_target "amdgcn-amd-amdhsa--gfx950"
.text
.globl interleave_layers__sliding_block__glu_gated_swiglu__prompt_kernel
.p2align 8
.type interleave_layers__sliding_block__glu_gated_swiglu__prompt_kernel,@function
interleave_layers__sliding_block__glu_gated_swiglu__prompt_kernel:
    s_cmp_ge_u32 s2, 256
    s_cbranch_scc1 MAIN_end
    s_load_dwordx16 s[72:87], s[0:1], 0
    s_load_dwordx2 s[16:17], s[0:1], 64
    s_load_dwordx2 s[8:9], s[0:1], 72
    v_lshrrev_b32 v22, 6, v0
    v_and_b32 v2, 63, v0
    v_readfirstlane_b32 s3, v22
    v_lshlrev_b32 v1, 4, v2
    v_and_b32 v3, 31, v2
    v_lshrrev_b32 v4, 5, v2
    s_and_b32 s48, s2, 7
    s_lshr_b32 s49, s2, 3
    s_lshr_b32 s50, s49, 4
    s_lshl_b32 s4, s48, 1
    s_add_u32 s4, s4, s50
    s_and_b32 s5, s49, 15
    s_lshl_b32 s6, s4, 2
    s_add_u32 s6, s6, s3
    s_mov_b32 s10, 268435456
    s_mov_b32 s11, 0x00020000
    s_mov_b32 s14, 1835008
    s_mov_b32 s15, 0x00020000
    s_mov_b32 s18, 256
    s_mov_b32 s19, 0x00020000
    s_mov_b32 s22, 1835008
    s_mov_b32 s23, 0x00020000
    s_mov_b32 s7, 0
    s_mov_b32 s96, 0
    s_mov_b32 s97, -1
    s_lshl_b32 s49, s3, 12
    s_add_u32 s49, s49, 86016
    v_add_u32 v12, s49, v1
    v_mov_b32 v11, 0
    v_mov_b32 v13, 0
    v_mov_b32 v8, 1065369472
    v_cmp_eq_u32 s[98:99], 28, v3
    s_cmp_ge_u32 s5, 7
    s_cselect_b32 s48, 1, 0
    s_mul_i32 s49, s48, 7
    s_sub_u32 s49, s5, s49
    s_cmp_lt_u32 s5, 14
    s_cselect_b32 s46, 1, 0
    s_cselect_b32 s49, s49, 0
    s_lshl_b32 s54, s49, 1
    s_and_b32 s50, s3, 1
    s_add_u32 s54, s54, s50
    s_xor_b32 s56, s54, 1
    s_lshl_b32 s55, s4, 2
    s_lshl_b32 s48, s48, 1
    s_add_u32 s55, s55, s48
    s_lshr_b32 s50, s3, 1
    s_add_u32 s55, s55, s50
    s_xor_b32 s57, s55, 1
    s_mul_i32 s26, s3, 7168
    s_waitcnt lgkmcnt(0)
    s_mov_b32 s20, s72
    s_mov_b32 s21, s73
    s_mov_b32 s12, s86
    s_mov_b32 s13, s87
    v_and_b32 v22, 3, v2
    v_lshrrev_b32 v23, 2, v2
    s_lshl_b32 s48, s4, 2
    v_add_u32 v24, s48, v22
    v_lshlrev_b32 v25, 7, v24
    s_lshl_b32 s49, s5, 2
    s_add_u32 s49, s49, 8192
    v_add_u32 v25, s49, v25
    v_and_b32 v5, 1, v23
    v_lshl_add_u32 v25, v5, 14, v25
    s_and_b32 s48, s55, -2
    s_and_b32 s49, s54, -2
    v_lshrrev_b32 v6, 1, v22
    v_add_u32 v6, s48, v6
    v_and_b32 v7, 1, v22
    v_add_u32 v7, s49, v7
    v_lshlrev_b32 v6, 7, v6
    v_lshl_add_u32 v6, v7, 2, v6
    v_add_u32 v6, 0, v6
    v_lshl_add_u32 v6, v5, 14, v6
    v_cmp_le_u32 vcc, 2, v23
    s_lshl_b32 s48, s5, 8
    s_add_u32 s48, s48, 32768
    v_cndmask_b32 v25, v25, v6, vcc
    v_lshlrev_b32 v6, 2, v24
    v_add_u32 v6, s48, v6
    v_cmp_le_u32 vcc, 4, v23
    s_lshl_b32 s48, s2, 7
    s_add_u32 s48, s48, 65536
    v_cndmask_b32 v25, v25, v6, vcc
    v_mov_b32 v6, s48
    v_cmp_le_u32 vcc, 5, v23
    s_cmp_eq_u32 s3, 0
    s_cselect_b32 s48, 0, 536870912
    v_cndmask_b32 v25, v25, v6, vcc
    s_mov_b64 exec, 0x1fffff
    buffer_store_dword v11, v25, s[8:11], s48 offen sc1
    s_mov_b64 exec, -1
    s_mov_b32 s64, s74
    s_mov_b32 s65, s75
    s_mov_b32 s66, 1204224
    s_mov_b32 s67, 0x00020000
    s_mov_b32 s71, 0x00020000
    s_lshr_b32 s52, s3, 1
    s_and_b32 s53, s3, 1
    s_cmp_ge_u32 s2, 182
    s_cbranch_scc1 F_none
    s_cmp_ge_u32 s2, 168
    s_cbranch_scc1 F_wo
    s_cmp_ge_u32 s2, 112
    s_cbranch_scc1 F_w2
    s_lshr_b32 s48, s2, 2
    s_and_b32 s49, s2, 3
    s_cmp_eq_u32 s52, 1
    s_cselect_b32 s68, s82, s80
    s_cselect_b32 s69, s83, s81
    s_mov_b32 s70, 1605632
    s_mov_b32 s88, 0
    s_mov_b32 s93, 3584
    s_mul_i32 s94, s49, 112
    s_mul_i32 s50, s53, 56
    s_add_u32 s94, s94, s50
    s_mul_i32 s94, s94, 3584
    s_lshl_b32 s50, s48, 7
    s_add_u32 s94, s94, s50
    s_lshl_b32 s50, s48, 2
    s_add_u32 s50, s50, s3
    s_mul_i32 s89, s50, 28
    s_mul_i32 s48, s49, 7
    s_add_u32 s89, s89, s48
    s_lshl_b32 s89, s89, 10
    s_add_u32 s89, s89, 4091904
    s_mul_i32 s90, s49, 112
    s_add_u32 s90, s90, s50
    s_lshl_b32 s90, s90, 7
    s_add_u32 s90, s90, 131072
    s_mov_b32 s91, 14336
    s_lshl_b32 s92, s3, 5
    s_branch F_dec
F_w2:
    s_sub_u32 s48, s2, 112
    s_and_b32 s49, s48, 7
    s_lshr_b32 s48, s48, 3
    s_mov_b32 s68, s84
    s_mov_b32 s69, s85
    s_mov_b32 s70, 1605632
    s_mov_b32 s88, 1
    s_mov_b32 s93, 896
    s_mul_i32 s94, s49, 224
    s_mul_i32 s50, s3, 56
    s_add_u32 s94, s94, s50
    s_mul_i32 s94, s94, 896
    s_lshl_b32 s50, s48, 7
    s_add_u32 s94, s94, s50
    s_lshl_b32 s50, s48, 1
    s_add_u32 s50, s50, s53
    s_mul_i32 s89, s50, 112
    s_mul_i32 s48, s49, 14
    s_add_u32 s89, s89, s48
    s_mul_i32 s48, s52, 7
    s_add_u32 s89, s89, s48
    s_lshl_b32 s89, s89, 10
    s_add_u32 s89, s89, 2486272
    s_mov_b32 s90, 0
    s_mov_b32 s91, 32
    s_mul_i32 s92, s52, 14336
    s_lshl_b32 s48, s53, 6
    s_add_u32 s92, s92, s48
    s_branch F_dec
F_wo:
    s_sub_u32 s48, s2, 168
    s_and_b32 s49, s48, 1
    s_lshr_b32 s48, s48, 1
    s_mov_b32 s68, s76
    s_mov_b32 s69, s77
    s_mov_b32 s70, 401408
    s_mov_b32 s88, 2
    s_mov_b32 s93, 896
    s_mul_i32 s94, s49, 224
    s_mul_i32 s50, s3, 56
    s_add_u32 s94, s94, s50
    s_mul_i32 s94, s94, 896
    s_lshl_b32 s50, s48, 7
    s_add_u32 s94, s94, s50
    s_lshl_b32 s50, s48, 1
    s_add_u32 s50, s50, s53
    s_lshl_b32 s89, s50, 5
    s_lshl_b32 s48, s49, 4
    s_add_u32 s89, s89, s48
    s_lshl_b32 s48, s52, 3
    s_add_u32 s89, s89, s48
    s_lshl_b32 s89, s89, 10
    s_add_u32 s89, s89, 651264
    s_mov_b32 s90, 0
    s_mov_b32 s91, 32
    s_mul_i32 s92, s52, 14336
    s_lshl_b32 s48, s53, 6
    s_add_u32 s92, s92, s48
    s_branch F_dec
F_none:
    s_mov_b32 s68, s76
    s_mov_b32 s69, s77
    s_mov_b32 s70, 0
    s_mov_b32 s88, 3
    s_mov_b32 s93, 0
    s_mov_b32 s94, 0
    s_mov_b32 s89, 0
    s_mov_b32 s90, 0
    s_mov_b32 s91, 0
    s_mov_b32 s92, 0
F_dec:
    v_lshrrev_b32 v23, 3, v2
    v_mul_lo_u32 v144, v23, s93
    v_and_b32 v24, 7, v2
    v_lshl_add_u32 v144, v24, 4, v144
    s_lshl_b32 s93, s93, 3
    v_xor_b32 v24, v24, v23
    v_mul_u32_u24 v7, 896, v23
    v_lshl_add_u32 v7, v24, 4, v7
    v_lshrrev_b32 v19, 2, v2
    v_mul_u32_u24 v19, 2688, v19
    v_and_b32 v23, 3, v2
    v_lshl_add_u32 v19, v23, 4, v19
    s_mul_i32 s78, s3, 301056
    s_mul_i32 s50, s5, 56
    s_add_u32 s78, s78, s50
    s_mul_i32 s79, s6, 28672
    s_lshl_b32 s95, s3, 13
    s_add_u32 s95, s95, 115200
    s_getpc_b64 s[58:59]
    s_lshr_b32 s48, s2, 3
    s_lshl_b32 s48, s48, 2
    s_add_u32 s48, s48, s3
    s_lshl_b32 s48, s48, 9
    v_min_u32 v23, 3, v2
    v_lshlrev_b32 v23, 7, v23
    v_add_u32 v23, s48, v23
    v_min_u32 v23, 48128, v23
    global_load_dword v0, v23, s[58:59]
    s_mov_b32 s44, 1
    s_mov_b32 s39, 7303168
    s_mov_b32 s42, 7303168
    s_mov_b32 s40, 192512
    s_mov_b32 s43, 421888
    s_mov_b32 s37, 11235328
    s_mov_b32 s38, 9138176
    s_mov_b32 s41, 19623936
    s_lshl_b32 s100, s5, 6
    s_add_u32 s100, s100, s6
    s_lshl_b32 s100, s100, 11
    s_add_u32 s100, s100, s38
    s_mul_i32 s61, s6, 112
    s_mul_i32 s53, s5, 7
    s_add_u32 s61, s61, s53
    s_lshl_b32 s61, s61, 10
    s_add_u32 s61, s61, s41
    s_mul_i32 s101, s55, 28
    s_lshl_b32 s49, s54, 1
    s_add_u32 s101, s101, s49
    s_lshl_b32 s101, s101, 10
    s_add_u32 s101, s101, s39
    s_mul_i32 s1, s55, 14
    s_add_u32 s1, s1, s54
    s_lshl_b32 s1, s1, 8
    s_add_u32 s1, s1, s40
    s_add_u32 m0, s26, 0
    s_add_u32 s77, s79, 0
    buffer_load_dwordx4 v7, s[20:23], s77 offen lds
    s_add_u32 m0, s26, 1024
    s_add_u32 s77, s79, 7168
    buffer_load_dwordx4 v7, s[20:23], s77 offen lds
    s_add_u32 m0, s26, 2048
    s_add_u32 s77, s79, 14336
    buffer_load_dwordx4 v7, s[20:23], s77 offen lds
    s_add_u32 m0, s26, 3072
    s_add_u32 s77, s79, 21504
    buffer_load_dwordx4 v7, s[20:23], s77 offen lds
    s_add_u32 m0, s95, 0
    s_add_u32 s77, s79, 128
    buffer_load_dwordx4 v7, s[20:23], s77 offen lds
    s_add_u32 m0, s95, 1024
    s_add_u32 s77, s79, 7296
    buffer_load_dwordx4 v7, s[20:23], s77 offen lds
    s_add_u32 m0, s95, 2048
    s_add_u32 s77, s79, 14464
    buffer_load_dwordx4 v7, s[20:23], s77 offen lds
    s_add_u32 m0, s95, 3072
    s_add_u32 s77, s79, 21632
    buffer_load_dwordx4 v7, s[20:23], s77 offen lds
    s_add_u32 m0, s95, 4096
    s_add_u32 s77, s79, 256
    buffer_load_dwordx4 v7, s[20:23], s77 offen lds
    s_add_u32 m0, s95, 5120
    s_add_u32 s77, s79, 7424
    buffer_load_dwordx4 v7, s[20:23], s77 offen lds
    s_add_u32 m0, s95, 6144
    s_add_u32 s77, s79, 14592
    buffer_load_dwordx4 v7, s[20:23], s77 offen lds
    s_add_u32 m0, s95, 7168
    s_add_u32 s77, s79, 21760
    buffer_load_dwordx4 v7, s[20:23], s77 offen lds
    s_add_u32 m0, s26, 28672
    s_add_u32 s77, s78, 896
    buffer_load_dwordx4 v19, s[64:67], s77 offen lds
    s_add_u32 m0, s26, 29696
    s_add_u32 s77, s78, 43904
    buffer_load_dwordx4 v19, s[64:67], s77 offen lds
    s_add_u32 m0, s26, 30720
    s_add_u32 s77, s78, 86912
    buffer_load_dwordx4 v19, s[64:67], s77 offen lds
    s_add_u32 m0, s26, 31744
    s_add_u32 s77, s78, 129920
    buffer_load_dwordx4 v19, s[64:67], s77 offen lds
    s_add_u32 m0, s26, 32768
    s_add_u32 s77, s78, 172928
    buffer_load_dwordx4 v19, s[64:67], s77 offen lds
    s_add_u32 m0, s26, 33792
    s_add_u32 s77, s78, 215936
    buffer_load_dwordx4 v19, s[64:67], s77 offen lds
    s_add_u32 m0, s26, 34816
    s_add_u32 s77, s78, 258944
    buffer_load_dwordx4 v19, s[64:67], s77 offen lds
    s_waitcnt vmcnt(20)
    s_getreg_b32 s60, hwreg(HW_REG_XCC_ID, 0, 4)
    s_mul_i32 s62, s60, s60
    s_lshl_b32 s62, s62, 16
    s_lshl_b32 s60, s60, 8
    s_or_b32 s60, s60, s62
    s_or_b32 s60, s60, 1
    v_mov_b32 v18, s60
    s_lshl_b32 s62, s4, 4
    s_cmp_eq_u32 s3, 0
    s_cselect_b32 s62, s62, 4096
    s_mov_b64 exec, 1
    buffer_atomic_add v18, v11, s[16:19], s62 offen sc1
    s_mov_b64 exec, -1
    v_lshlrev_b32 v23, 3, v4
    v_bfe_u32 v24, v2, 2, 2
    v_add_u32 v23, v23, v24
    v_and_b32 v24, 1, v2
    v_lshlrev_b32 v24, 4, v24
    v_bfe_u32 v25, v2, 1, 1
    v_lshl_or_b32 v24, v25, 3, v24
    v_bfe_u32 v25, v2, 4, 1
    v_lshl_add_u32 v5, v23, 6, v24
    v_lshl_add_u32 v5, v25, 5, v5
    v_add_u32 v6, 57344, v5
    v_lshl_add_u32 v9, v23, 7, v24
    v_mad_u32_u24 v9, v25, s91, v9
    s_add_u32 s48, s92, 86016
    v_add_u32 v9, s48, v9
    v_add_u32 v26, s26, v5
    v_add_u32 v27, s26, v6
    v_mov_b32 v10, 0
    v_mov_b32 v14, 0
    v_mov_b32 v15, 0
    v_mov_b32 v16, 0
    v_mov_b32 v17, 0
    v_cmp_le_u32 s[72:73], 28, v3
    s_sub_u32 s48, s95, s26
    v_add_u32 v23, 0, v4
    v_and_b32 v24, 7, v3
    v_xor_b32 v23, v23, v24
    v_lshlrev_b32 v23, 4, v23
    v_lshl_add_u32 v240, v3, 7, v23
    v_add_u32 v240, s26, v240
    v_add_u32 v244, s48, v240
    v_add_u32 v23, 2, v4
    v_and_b32 v24, 7, v3
    v_xor_b32 v23, v23, v24
    v_lshlrev_b32 v23, 4, v23
    v_lshl_add_u32 v241, v3, 7, v23
    v_add_u32 v241, s26, v241
    v_add_u32 v245, s48, v241
    v_add_u32 v23, 4, v4
    v_and_b32 v24, 7, v3
    v_xor_b32 v23, v23, v24
    v_lshlrev_b32 v23, 4, v23
    v_lshl_add_u32 v242, v3, 7, v23
    v_add_u32 v242, s26, v242
    v_add_u32 v246, s48, v242
    v_add_u32 v23, 6, v4
    v_and_b32 v24, 7, v3
    v_xor_b32 v23, v23, v24
    v_lshlrev_b32 v23, 4, v23
    v_lshl_add_u32 v243, v3, 7, v23
    v_add_u32 v243, s26, v243
    v_add_u32 v247, s48, v243
    s_or_b64 s[74:75], s[96:97], s[72:73]
    s_mov_b32 s45, 0
    s_mul_i32 s25, s5, 200704
    s_add_u32 s25, s25, 4091904
    s_add_u32 s25, s25, s26
    s_mul_i32 s28, s3, 21504
    s_mul_i32 s27, s5, 86016
    s_add_u32 s27, s27, 1110016
    s_add_u32 s27, s27, s28
    s_mul_i32 s24, s3, 28672
    s_add_u32 s24, s24, 2486272
    s_mul_i32 s29, s54, 114688
    s_add_u32 s29, s29, s24
    s_mul_i32 s30, s56, 114688
    s_add_u32 s30, s30, s24
    s_lshl_b32 s24, s3, 13
    s_add_u32 s24, s24, 651264
    s_lshl_b32 s31, s54, 15
    s_add_u32 s31, s31, s24
    s_lshl_b32 s32, s56, 15
    s_add_u32 s32, s32, s24
    s_movk_i32 s82, 2048
    s_cmp_eq_u32 s88, 2
    s_cselect_b32 s82, 1792, s82
    s_cselect_b32 s83, 256, 0
    s_mov_b32 s80, 0
    s_cselect_b32 s81, -1, 0
    s_add_u32 s48, s89, 4096
    s_cmp_eq_u32 s88, 2
    s_cselect_b32 s84, s48, 536870912
    s_cmp_eq_u32 s88, 0
    s_cselect_b32 s90, s90, 536870912
    s_cmp_eq_u32 s88, 3
    s_cselect_b32 s89, 536870912, s89
    s_waitcnt vmcnt(16)
    ds_read_b128 v[32:35], v240 offset:0
    ds_read_b128 v[36:39], v241 offset:0
    ds_read_b128 v[40:43], v242 offset:0
    ds_read_b128 v[44:47], v243 offset:0
    s_waitcnt vmcnt(12)
    ds_read_b128 v[48:51], v244 offset:0
    ds_read_b128 v[52:55], v245 offset:0
    ds_read_b128 v[56:59], v246 offset:0
    ds_read_b128 v[60:63], v247 offset:0
    s_waitcnt vmcnt(8)
    ds_read_b128 v[64:67], v244 offset:4096
    ds_read_b128 v[68:71], v245 offset:4096
    ds_read_b128 v[72:75], v246 offset:4096
    ds_read_b128 v[76:79], v247 offset:4096
    s_waitcnt lgkmcnt(0)
    s_add_u32 m0, s26, 0
    s_add_u32 s77, s79, 384
    buffer_load_dwordx4 v7, s[20:23], s77 offen lds
    s_add_u32 m0, s26, 1024
    s_add_u32 s77, s79, 7552
    buffer_load_dwordx4 v7, s[20:23], s77 offen lds
    s_add_u32 m0, s26, 2048
    s_add_u32 s77, s79, 14720
    buffer_load_dwordx4 v7, s[20:23], s77 offen lds
    s_add_u32 m0, s26, 3072
    s_add_u32 s77, s79, 21888
    buffer_load_dwordx4 v7, s[20:23], s77 offen lds
    s_add_u32 m0, s95, 0
    s_add_u32 s77, s79, 512
    buffer_load_dwordx4 v7, s[20:23], s77 offen lds
    s_add_u32 m0, s95, 1024
    s_add_u32 s77, s79, 7680
    buffer_load_dwordx4 v7, s[20:23], s77 offen lds
    s_add_u32 m0, s95, 2048
    s_add_u32 s77, s79, 14848
    buffer_load_dwordx4 v7, s[20:23], s77 offen lds
    s_add_u32 m0, s95, 3072
    s_add_u32 s77, s79, 22016
    buffer_load_dwordx4 v7, s[20:23], s77 offen lds
    s_add_u32 m0, s95, 4096
    s_add_u32 s77, s79, 640
    buffer_load_dwordx4 v7, s[20:23], s77 offen lds
    s_add_u32 m0, s95, 5120
    s_add_u32 s77, s79, 7808
    buffer_load_dwordx4 v7, s[20:23], s77 offen lds
    s_add_u32 m0, s95, 6144
    s_add_u32 s77, s79, 14976
    buffer_load_dwordx4 v7, s[20:23], s77 offen lds
    s_add_u32 m0, s95, 7168
    s_add_u32 s77, s79, 22144
    buffer_load_dwordx4 v7, s[20:23], s77 offen lds
    s_add_u32 m0, s26, 57344
    s_add_u32 s77, s78, 1792
    buffer_load_dwordx4 v19, s[64:67], s77 offen lds
    s_add_u32 m0, s26, 58368
    s_add_u32 s77, s78, 44800
    buffer_load_dwordx4 v19, s[64:67], s77 offen lds
    s_add_u32 m0, s26, 59392
    s_add_u32 s77, s78, 87808
    buffer_load_dwordx4 v19, s[64:67], s77 offen lds
    s_add_u32 m0, s26, 60416
    s_add_u32 s77, s78, 130816
    buffer_load_dwordx4 v19, s[64:67], s77 offen lds
    s_add_u32 m0, s26, 61440
    s_add_u32 s77, s78, 173824
    buffer_load_dwordx4 v19, s[64:67], s77 offen lds
    s_add_u32 m0, s26, 62464
    s_add_u32 s77, s78, 216832
    buffer_load_dwordx4 v19, s[64:67], s77 offen lds
    s_add_u32 m0, s26, 63488
    s_add_u32 s77, s78, 259840
    buffer_load_dwordx4 v19, s[64:67], s77 offen lds
    v_dot2_f32_bf16 v10, v32, v8, v10
    v_dot2_f32_bf16 v14, v32, v32, v14
    v_dot2_f32_bf16 v10, v33, v8, v10
    v_dot2_f32_bf16 v14, v33, v33, v14
    v_dot2_f32_bf16 v10, v34, v8, v10
    v_dot2_f32_bf16 v14, v34, v34, v14
    v_dot2_f32_bf16 v10, v35, v8, v10
    v_dot2_f32_bf16 v14, v35, v35, v14
    v_dot2_f32_bf16 v10, v36, v8, v10
    v_dot2_f32_bf16 v14, v36, v36, v14
    v_dot2_f32_bf16 v10, v37, v8, v10
    v_dot2_f32_bf16 v14, v37, v37, v14
    v_dot2_f32_bf16 v10, v38, v8, v10
    v_dot2_f32_bf16 v14, v38, v38, v14
    v_dot2_f32_bf16 v10, v39, v8, v10
    v_dot2_f32_bf16 v14, v39, v39, v14
    v_dot2_f32_bf16 v10, v40, v8, v10
    v_dot2_f32_bf16 v14, v40, v40, v14
    v_dot2_f32_bf16 v10, v41, v8, v10
    v_dot2_f32_bf16 v14, v41, v41, v14
    v_dot2_f32_bf16 v10, v42, v8, v10
    v_dot2_f32_bf16 v14, v42, v42, v14
    v_dot2_f32_bf16 v10, v43, v8, v10
    v_dot2_f32_bf16 v14, v43, v43, v14
    v_dot2_f32_bf16 v10, v44, v8, v10
    v_dot2_f32_bf16 v14, v44, v44, v14
    v_dot2_f32_bf16 v10, v45, v8, v10
    v_dot2_f32_bf16 v14, v45, v45, v14
    v_dot2_f32_bf16 v10, v46, v8, v10
    v_dot2_f32_bf16 v14, v46, v46, v14
    v_dot2_f32_bf16 v10, v47, v8, v10
    v_dot2_f32_bf16 v14, v47, v47, v14
    v_dot2_f32_bf16 v10, v48, v8, v10
    v_dot2_f32_bf16 v14, v48, v48, v14
    v_dot2_f32_bf16 v10, v49, v8, v10
    v_dot2_f32_bf16 v14, v49, v49, v14
    v_dot2_f32_bf16 v10, v50, v8, v10
    v_dot2_f32_bf16 v14, v50, v50, v14
    v_dot2_f32_bf16 v10, v51, v8, v10
    v_dot2_f32_bf16 v14, v51, v51, v14
    v_dot2_f32_bf16 v10, v52, v8, v10
    v_dot2_f32_bf16 v14, v52, v52, v14
    v_dot2_f32_bf16 v10, v53, v8, v10
    v_dot2_f32_bf16 v14, v53, v53, v14
    v_dot2_f32_bf16 v10, v54, v8, v10
    v_dot2_f32_bf16 v14, v54, v54, v14
    v_dot2_f32_bf16 v10, v55, v8, v10
    v_dot2_f32_bf16 v14, v55, v55, v14
    v_dot2_f32_bf16 v10, v56, v8, v10
    v_dot2_f32_bf16 v14, v56, v56, v14
    v_dot2_f32_bf16 v10, v57, v8, v10
    v_dot2_f32_bf16 v14, v57, v57, v14
    v_dot2_f32_bf16 v10, v58, v8, v10
    v_dot2_f32_bf16 v14, v58, v58, v14
    v_dot2_f32_bf16 v10, v59, v8, v10
    v_dot2_f32_bf16 v14, v59, v59, v14
    v_dot2_f32_bf16 v10, v60, v8, v10
    v_dot2_f32_bf16 v14, v60, v60, v14
    v_dot2_f32_bf16 v10, v61, v8, v10
    v_dot2_f32_bf16 v14, v61, v61, v14
    v_dot2_f32_bf16 v10, v62, v8, v10
    v_dot2_f32_bf16 v14, v62, v62, v14
    v_dot2_f32_bf16 v10, v63, v8, v10
    v_dot2_f32_bf16 v14, v63, v63, v14
    v_dot2_f32_bf16 v10, v64, v8, v10
    v_dot2_f32_bf16 v14, v64, v64, v14
    v_dot2_f32_bf16 v10, v65, v8, v10
    v_dot2_f32_bf16 v14, v65, v65, v14
    v_dot2_f32_bf16 v10, v66, v8, v10
    v_dot2_f32_bf16 v14, v66, v66, v14
    v_dot2_f32_bf16 v10, v67, v8, v10
    v_dot2_f32_bf16 v14, v67, v67, v14
    v_dot2_f32_bf16 v10, v68, v8, v10
    v_dot2_f32_bf16 v14, v68, v68, v14
    v_dot2_f32_bf16 v10, v69, v8, v10
    v_dot2_f32_bf16 v14, v69, v69, v14
    v_dot2_f32_bf16 v10, v70, v8, v10
    v_dot2_f32_bf16 v14, v70, v70, v14
    v_dot2_f32_bf16 v10, v71, v8, v10
    v_dot2_f32_bf16 v14, v71, v71, v14
    v_dot2_f32_bf16 v10, v72, v8, v10
    v_dot2_f32_bf16 v14, v72, v72, v14
    v_dot2_f32_bf16 v10, v73, v8, v10
    v_dot2_f32_bf16 v14, v73, v73, v14
    v_dot2_f32_bf16 v10, v74, v8, v10
    v_dot2_f32_bf16 v14, v74, v74, v14
    v_dot2_f32_bf16 v10, v75, v8, v10
    v_dot2_f32_bf16 v14, v75, v75, v14
    v_dot2_f32_bf16 v10, v76, v8, v10
    v_dot2_f32_bf16 v14, v76, v76, v14
    v_dot2_f32_bf16 v10, v77, v8, v10
    v_dot2_f32_bf16 v14, v77, v77, v14
    v_dot2_f32_bf16 v10, v78, v8, v10
    v_dot2_f32_bf16 v14, v78, v78, v14
    v_dot2_f32_bf16 v10, v79, v8, v10
    v_dot2_f32_bf16 v14, v79, v79, v14
    s_waitcnt vmcnt(20)
    ds_read_b64_tr_b16 v[192:193], v26 offset:28672
    ds_read_b64_tr_b16 v[194:195], v26 offset:28928
    ds_read_b64_tr_b16 v[196:197], v26 offset:29696
    ds_read_b64_tr_b16 v[198:199], v26 offset:29952
    ds_read_b64_tr_b16 v[200:201], v26 offset:30720
    ds_read_b64_tr_b16 v[202:203], v26 offset:30976
    ds_read_b64_tr_b16 v[204:205], v26 offset:31744
    ds_read_b64_tr_b16 v[206:207], v26 offset:32000
    ds_read_b64_tr_b16 v[208:209], v26 offset:32768
    ds_read_b64_tr_b16 v[210:211], v26 offset:33024
    ds_read_b64_tr_b16 v[212:213], v26 offset:33792
    ds_read_b64_tr_b16 v[214:215], v26 offset:34048
    ds_read_b64_tr_b16 v[216:217], v26 offset:34816
    ds_read_b64_tr_b16 v[218:219], v26 offset:35072
    s_waitcnt lgkmcnt(13)
    v_dot2_f32_bf16 v15, v192, v8, v15
    v_dot2_f32_bf16 v15, v193, v8, v15
    s_waitcnt lgkmcnt(12)
    v_dot2_f32_bf16 v15, v194, v8, v15
    v_dot2_f32_bf16 v15, v195, v8, v15
    s_waitcnt lgkmcnt(11)
    v_dot2_f32_bf16 v15, v196, v8, v15
    v_dot2_f32_bf16 v15, v197, v8, v15
    s_waitcnt lgkmcnt(10)
    v_dot2_f32_bf16 v15, v198, v8, v15
    v_dot2_f32_bf16 v15, v199, v8, v15
    s_waitcnt lgkmcnt(9)
    v_dot2_f32_bf16 v15, v200, v8, v15
    v_dot2_f32_bf16 v15, v201, v8, v15
    s_waitcnt lgkmcnt(8)
    v_dot2_f32_bf16 v15, v202, v8, v15
    v_dot2_f32_bf16 v15, v203, v8, v15
    s_waitcnt lgkmcnt(7)
    v_dot2_f32_bf16 v15, v204, v8, v15
    v_dot2_f32_bf16 v15, v205, v8, v15
    s_waitcnt lgkmcnt(6)
    v_dot2_f32_bf16 v15, v206, v8, v15
    v_dot2_f32_bf16 v15, v207, v8, v15
    s_waitcnt lgkmcnt(5)
    v_dot2_f32_bf16 v15, v208, v8, v15
    v_dot2_f32_bf16 v15, v209, v8, v15
    s_waitcnt lgkmcnt(4)
    v_dot2_f32_bf16 v15, v210, v8, v15
    v_dot2_f32_bf16 v15, v211, v8, v15
    s_waitcnt lgkmcnt(3)
    v_dot2_f32_bf16 v15, v212, v8, v15
    v_dot2_f32_bf16 v15, v213, v8, v15
    s_waitcnt lgkmcnt(2)
    v_dot2_f32_bf16 v15, v214, v8, v15
    v_dot2_f32_bf16 v15, v215, v8, v15
    s_waitcnt lgkmcnt(1)
    v_dot2_f32_bf16 v15, v216, v8, v15
    v_dot2_f32_bf16 v15, v217, v8, v15
    s_waitcnt lgkmcnt(0)
    v_dot2_f32_bf16 v15, v218, v8, v15
    v_dot2_f32_bf16 v15, v219, v8, v15
    s_nop 2
    v_mov_b32 v22, v15
    s_nop 1
    v_permlane32_swap_b32 v15, v22
    v_add_f32 v15, v15, v22
    s_mul_i32 s48, s3, 384
    s_add_u32 s48, s48, 162304
    v_lshlrev_b32 v25, 2, v3
    v_add_u32 v24, s48, v25
    ds_write_b32 v24, v15 offset:128
    s_waitcnt vmcnt(15)
    ds_read_b128 v[80:83], v240 offset:0
    ds_read_b128 v[84:87], v241 offset:0
    ds_read_b128 v[88:91], v242 offset:0
    ds_read_b128 v[92:95], v243 offset:0
    s_waitcnt vmcnt(11)
    ds_read_b128 v[96:99], v244 offset:0
    ds_read_b128 v[100:103], v245 offset:0
    ds_read_b128 v[104:107], v246 offset:0
    ds_read_b128 v[108:111], v247 offset:0
    s_waitcnt lgkmcnt(0)
    s_add_u32 m0, s95, 0
    s_add_u32 s77, s79, 768
    buffer_load_dwordx4 v7, s[20:23], s77 offen lds
    s_add_u32 m0, s95, 1024
    s_add_u32 s77, s79, 7936
    buffer_load_dwordx4 v7, s[20:23], s77 offen lds
    s_add_u32 m0, s95, 2048
    s_add_u32 s77, s79, 15104
    buffer_load_dwordx4 v7, s[20:23], s77 offen lds
    s_add_u32 m0, s95, 3072
    s_add_u32 s77, s79, 22272
    buffer_load_dwordx4 v7, s[20:23], s77 offen lds
    s_add_u32 m0, s26, 86016
    s_nop 0
    buffer_load_dwordx4 v144, s[68:71], s94 offen lds
    s_add_u32 s94, s94, s93
    s_add_u32 m0, s26, 87040
    s_nop 0
    buffer_load_dwordx4 v144, s[68:71], s94 offen lds
    s_add_u32 s94, s94, s93
    s_add_u32 m0, s26, 88064
    s_nop 0
    buffer_load_dwordx4 v144, s[68:71], s94 offen lds
    s_add_u32 s94, s94, s93
    s_add_u32 m0, s26, 89088
    s_nop 0
    buffer_load_dwordx4 v144, s[68:71], s94 offen lds
    s_add_u32 s94, s94, s93
    s_add_u32 m0, s26, 90112
    s_nop 0
    buffer_load_dwordx4 v144, s[68:71], s94 offen lds
    s_add_u32 s94, s94, s93
    s_add_u32 m0, s26, 91136
    s_nop 0
    buffer_load_dwordx4 v144, s[68:71], s94 offen lds
    s_add_u32 s94, s94, s93
    s_add_u32 m0, s26, 92160
    s_nop 0
    buffer_load_dwordx4 v144, s[68:71], s94 offen lds
    s_add_u32 s94, s94, s93
    s_waitcnt vmcnt(18)
    ds_read_b128 v[112:115], v244 offset:4096
    ds_read_b128 v[116:119], v245 offset:4096
    ds_read_b128 v[120:123], v246 offset:4096
    ds_read_b128 v[124:127], v247 offset:4096
    v_dot2_f32_bf16 v10, v80, v8, v10
    v_dot2_f32_bf16 v14, v80, v80, v14
    v_dot2_f32_bf16 v10, v81, v8, v10
    v_dot2_f32_bf16 v14, v81, v81, v14
    v_dot2_f32_bf16 v10, v82, v8, v10
    v_dot2_f32_bf16 v14, v82, v82, v14
    v_dot2_f32_bf16 v10, v83, v8, v10
    v_dot2_f32_bf16 v14, v83, v83, v14
    v_dot2_f32_bf16 v10, v84, v8, v10
    v_dot2_f32_bf16 v14, v84, v84, v14
    v_dot2_f32_bf16 v10, v85, v8, v10
    v_dot2_f32_bf16 v14, v85, v85, v14
    v_dot2_f32_bf16 v10, v86, v8, v10
    v_dot2_f32_bf16 v14, v86, v86, v14
    v_dot2_f32_bf16 v10, v87, v8, v10
    v_dot2_f32_bf16 v14, v87, v87, v14
    v_dot2_f32_bf16 v10, v88, v8, v10
    v_dot2_f32_bf16 v14, v88, v88, v14
    v_dot2_f32_bf16 v10, v89, v8, v10
    v_dot2_f32_bf16 v14, v89, v89, v14
    v_dot2_f32_bf16 v10, v90, v8, v10
    v_dot2_f32_bf16 v14, v90, v90, v14
    v_dot2_f32_bf16 v10, v91, v8, v10
    v_dot2_f32_bf16 v14, v91, v91, v14
    v_dot2_f32_bf16 v10, v92, v8, v10
    v_dot2_f32_bf16 v14, v92, v92, v14
    v_dot2_f32_bf16 v10, v93, v8, v10
    v_dot2_f32_bf16 v14, v93, v93, v14
    v_dot2_f32_bf16 v10, v94, v8, v10
    v_dot2_f32_bf16 v14, v94, v94, v14
    v_dot2_f32_bf16 v10, v95, v8, v10
    v_dot2_f32_bf16 v14, v95, v95, v14
    v_dot2_f32_bf16 v10, v96, v8, v10
    v_dot2_f32_bf16 v14, v96, v96, v14
    v_dot2_f32_bf16 v10, v97, v8, v10
    v_dot2_f32_bf16 v14, v97, v97, v14
    v_dot2_f32_bf16 v10, v98, v8, v10
    v_dot2_f32_bf16 v14, v98, v98, v14
    v_dot2_f32_bf16 v10, v99, v8, v10
    v_dot2_f32_bf16 v14, v99, v99, v14
    v_dot2_f32_bf16 v10, v100, v8, v10
    v_dot2_f32_bf16 v14, v100, v100, v14
    v_dot2_f32_bf16 v10, v101, v8, v10
    v_dot2_f32_bf16 v14, v101, v101, v14
    v_dot2_f32_bf16 v10, v102, v8, v10
    v_dot2_f32_bf16 v14, v102, v102, v14
    v_dot2_f32_bf16 v10, v103, v8, v10
    v_dot2_f32_bf16 v14, v103, v103, v14
    v_dot2_f32_bf16 v10, v104, v8, v10
    v_dot2_f32_bf16 v14, v104, v104, v14
    v_dot2_f32_bf16 v10, v105, v8, v10
    v_dot2_f32_bf16 v14, v105, v105, v14
    v_dot2_f32_bf16 v10, v106, v8, v10
    v_dot2_f32_bf16 v14, v106, v106, v14
    v_dot2_f32_bf16 v10, v107, v8, v10
    v_dot2_f32_bf16 v14, v107, v107, v14
    v_dot2_f32_bf16 v10, v108, v8, v10
    v_dot2_f32_bf16 v14, v108, v108, v14
    v_dot2_f32_bf16 v10, v109, v8, v10
    v_dot2_f32_bf16 v14, v109, v109, v14
    v_dot2_f32_bf16 v10, v110, v8, v10
    v_dot2_f32_bf16 v14, v110, v110, v14
    v_dot2_f32_bf16 v10, v111, v8, v10
    v_dot2_f32_bf16 v14, v111, v111, v14
    s_waitcnt lgkmcnt(3)
    v_dot2_f32_bf16 v10, v112, v8, v10
    v_dot2_f32_bf16 v14, v112, v112, v14
    v_dot2_f32_bf16 v10, v113, v8, v10
    v_dot2_f32_bf16 v14, v113, v113, v14
    v_dot2_f32_bf16 v10, v114, v8, v10
    v_dot2_f32_bf16 v14, v114, v114, v14
    v_dot2_f32_bf16 v10, v115, v8, v10
    v_dot2_f32_bf16 v14, v115, v115, v14
    s_waitcnt lgkmcnt(2)
    v_dot2_f32_bf16 v10, v116, v8, v10
    v_dot2_f32_bf16 v14, v116, v116, v14
    v_dot2_f32_bf16 v10, v117, v8, v10
    v_dot2_f32_bf16 v14, v117, v117, v14
    v_dot2_f32_bf16 v10, v118, v8, v10
    v_dot2_f32_bf16 v14, v118, v118, v14
    v_dot2_f32_bf16 v10, v119, v8, v10
    v_dot2_f32_bf16 v14, v119, v119, v14
    s_waitcnt lgkmcnt(1)
    v_dot2_f32_bf16 v10, v120, v8, v10
    v_dot2_f32_bf16 v14, v120, v120, v14
    v_dot2_f32_bf16 v10, v121, v8, v10
    v_dot2_f32_bf16 v14, v121, v121, v14
    v_dot2_f32_bf16 v10, v122, v8, v10
    v_dot2_f32_bf16 v14, v122, v122, v14
    v_dot2_f32_bf16 v10, v123, v8, v10
    v_dot2_f32_bf16 v14, v123, v123, v14
    s_waitcnt lgkmcnt(0)
    v_dot2_f32_bf16 v10, v124, v8, v10
    v_dot2_f32_bf16 v14, v124, v124, v14
    v_dot2_f32_bf16 v10, v125, v8, v10
    v_dot2_f32_bf16 v14, v125, v125, v14
    v_dot2_f32_bf16 v10, v126, v8, v10
    v_dot2_f32_bf16 v14, v126, v126, v14
    v_dot2_f32_bf16 v10, v127, v8, v10
    v_dot2_f32_bf16 v14, v127, v127, v14
    s_waitcnt vmcnt(11)
    ds_read_b64_tr_b16 v[192:193], v27 offset:0
    ds_read_b64_tr_b16 v[194:195], v27 offset:256
    ds_read_b64_tr_b16 v[196:197], v27 offset:1024
    ds_read_b64_tr_b16 v[198:199], v27 offset:1280
    ds_read_b64_tr_b16 v[200:201], v27 offset:2048
    ds_read_b64_tr_b16 v[202:203], v27 offset:2304
    ds_read_b64_tr_b16 v[204:205], v27 offset:3072
    ds_read_b64_tr_b16 v[206:207], v27 offset:3328
    ds_read_b64_tr_b16 v[208:209], v27 offset:4096
    ds_read_b64_tr_b16 v[210:211], v27 offset:4352
    ds_read_b64_tr_b16 v[212:213], v27 offset:5120
    ds_read_b64_tr_b16 v[214:215], v27 offset:5376
    ds_read_b64_tr_b16 v[216:217], v27 offset:6144
    ds_read_b64_tr_b16 v[218:219], v27 offset:6400
    s_waitcnt lgkmcnt(13)
    v_dot2_f32_bf16 v16, v192, v8, v16
    v_dot2_f32_bf16 v16, v193, v8, v16
    s_waitcnt lgkmcnt(12)
    v_dot2_f32_bf16 v16, v194, v8, v16
    v_dot2_f32_bf16 v16, v195, v8, v16
    s_waitcnt lgkmcnt(11)
    v_dot2_f32_bf16 v16, v196, v8, v16
    v_dot2_f32_bf16 v16, v197, v8, v16
    s_waitcnt lgkmcnt(10)
    v_dot2_f32_bf16 v16, v198, v8, v16
    v_dot2_f32_bf16 v16, v199, v8, v16
    s_waitcnt lgkmcnt(9)
    v_dot2_f32_bf16 v16, v200, v8, v16
    v_dot2_f32_bf16 v16, v201, v8, v16
    s_waitcnt lgkmcnt(8)
    v_dot2_f32_bf16 v16, v202, v8, v16
    v_dot2_f32_bf16 v16, v203, v8, v16
    s_waitcnt lgkmcnt(7)
    v_dot2_f32_bf16 v16, v204, v8, v16
    v_dot2_f32_bf16 v16, v205, v8, v16
    s_waitcnt lgkmcnt(6)
    v_dot2_f32_bf16 v16, v206, v8, v16
    v_dot2_f32_bf16 v16, v207, v8, v16
    s_waitcnt lgkmcnt(5)
    v_dot2_f32_bf16 v16, v208, v8, v16
    v_dot2_f32_bf16 v16, v209, v8, v16
    s_waitcnt lgkmcnt(4)
    v_dot2_f32_bf16 v16, v210, v8, v16
    v_dot2_f32_bf16 v16, v211, v8, v16
    s_waitcnt lgkmcnt(3)
    v_dot2_f32_bf16 v16, v212, v8, v16
    v_dot2_f32_bf16 v16, v213, v8, v16
    s_waitcnt lgkmcnt(2)
    v_dot2_f32_bf16 v16, v214, v8, v16
    v_dot2_f32_bf16 v16, v215, v8, v16
    s_waitcnt lgkmcnt(1)
    v_dot2_f32_bf16 v16, v216, v8, v16
    v_dot2_f32_bf16 v16, v217, v8, v16
    s_waitcnt lgkmcnt(0)
    v_dot2_f32_bf16 v16, v218, v8, v16
    v_dot2_f32_bf16 v16, v219, v8, v16
    s_nop 2
    v_mov_b32 v22, v16
    s_nop 1
    v_permlane32_swap_b32 v16, v22
    v_add_f32 v16, v16, v22
    s_mul_i32 s48, s3, 384
    s_add_u32 s48, s48, 162304
    v_lshlrev_b32 v25, 2, v3
    v_add_u32 v24, s48, v25
    ds_write_b32 v24, v16 offset:256
    s_waitcnt vmcnt(7)
    ds_read_b128 v[128:131], v244 offset:0
    ds_read_b128 v[132:135], v245 offset:0
    ds_read_b128 v[136:139], v246 offset:0
    ds_read_b128 v[140:143], v247 offset:0
    s_waitcnt lgkmcnt(3)
    v_dot2_f32_bf16 v10, v128, v8, v10
    v_dot2_f32_bf16 v14, v128, v128, v14
    v_dot2_f32_bf16 v10, v129, v8, v10
    v_dot2_f32_bf16 v14, v129, v129, v14
    v_dot2_f32_bf16 v10, v130, v8, v10
    v_dot2_f32_bf16 v14, v130, v130, v14
    v_dot2_f32_bf16 v10, v131, v8, v10
    v_dot2_f32_bf16 v14, v131, v131, v14
    s_waitcnt lgkmcnt(2)
    v_dot2_f32_bf16 v10, v132, v8, v10
    v_dot2_f32_bf16 v14, v132, v132, v14
    v_dot2_f32_bf16 v10, v133, v8, v10
    v_dot2_f32_bf16 v14, v133, v133, v14
    v_dot2_f32_bf16 v10, v134, v8, v10
    v_dot2_f32_bf16 v14, v134, v134, v14
    v_dot2_f32_bf16 v10, v135, v8, v10
    v_dot2_f32_bf16 v14, v135, v135, v14
    s_waitcnt lgkmcnt(1)
    v_dot2_f32_bf16 v10, v136, v8, v10
    v_dot2_f32_bf16 v14, v136, v136, v14
    v_dot2_f32_bf16 v10, v137, v8, v10
    v_dot2_f32_bf16 v14, v137, v137, v14
    v_dot2_f32_bf16 v10, v138, v8, v10
    v_dot2_f32_bf16 v14, v138, v138, v14
    v_dot2_f32_bf16 v10, v139, v8, v10
    v_dot2_f32_bf16 v14, v139, v139, v14
    s_waitcnt lgkmcnt(0)
    v_dot2_f32_bf16 v10, v140, v8, v10
    v_dot2_f32_bf16 v14, v140, v140, v14
    v_dot2_f32_bf16 v10, v141, v8, v10
    v_dot2_f32_bf16 v14, v141, v141, v14
    v_dot2_f32_bf16 v10, v142, v8, v10
    v_dot2_f32_bf16 v14, v142, v142, v14
    v_dot2_f32_bf16 v10, v143, v8, v10
    v_dot2_f32_bf16 v14, v143, v143, v14
    s_nop 1
    v_mov_b32 v22, v10
    v_mov_b32 v23, v14
    s_nop 0
    v_permlane32_swap_b32 v10, v22
    v_permlane32_swap_b32 v14, v23
    v_add_f32 v10, v10, v22
    v_add_f32 v14, v14, v23
    v_mul_f32 v10, 3138537765, v10
    v_mul_f32 v14, 991054117, v14
    v_fma_f32 v14, -v10, v10, v14
    v_max_f32 v14, 0, v14
    v_cvt_pk_bf16_f32 v20, v10, v10
    v_cvt_pk_bf16_f32 v23, v14, v14
    v_and_b32 v23, 0xffff0000, v23
    v_add_f32 v23, 925353388, v23
    v_cvt_pk_bf16_f32 v23, v23, v23
    v_and_b32 v23, 0xffff0000, v23
    v_sqrt_f32 v23, v23
    s_nop 0
    v_cvt_pk_bf16_f32 v23, v23, v23
    v_and_b32 v23, 0xffff0000, v23
    v_rcp_f32 v21, v23
    v_mov_b32 v28, v20
    v_mov_b32 v29, v20
    v_mov_b32 v30, v20
    v_mov_b32 v31, v20
    v_lshlrev_b32 v25, 2, v3
    v_add_u32 v10, 162304, v25
    s_barrier
    v_add_u32 v14, 153600, v1
    ds_read_b64_tr_b16 v[192:193], v5 offset:28672
    ds_read_b64_tr_b16 v[194:195], v5 offset:28928
    ds_read_b64_tr_b16 v[196:197], v6 offset:0
    ds_read_b64_tr_b16 v[198:199], v6 offset:256
    ds_read_b64_tr_b16 v[200:201], v5 offset:29696
    ds_read_b64_tr_b16 v[202:203], v5 offset:29952
    ds_read_b64_tr_b16 v[204:205], v6 offset:1024
    ds_read_b64_tr_b16 v[206:207], v6 offset:1280
    ds_read_b64_tr_b16 v[208:209], v5 offset:30720
    ds_read_b64_tr_b16 v[210:211], v5 offset:30976
    s_waitcnt lgkmcnt(6)
    v_mfma_f32_32x32x16_bf16 v[160:175], v[192:195], v[32:35], 0
    ds_read_b64_tr_b16 v[212:213], v6 offset:2048
    ds_read_b64_tr_b16 v[214:215], v6 offset:2304
    s_add_u32 m0, s26, 0
    s_add_u32 s77, s78, 0
    buffer_load_dwordx4 v19, s[64:67], s77 offen lds
    v_mfma_f32_32x32x16_bf16 v[176:191], v[32:35], v[196:199], 0
    s_lshl_b32 s48, s3, 8
    s_add_u32 s48, s48, 143360
    v_add_u32 v23, s48, v25
    ds_read_b64_tr_b16 v[192:193], v5 offset:31744
    ds_read_b64_tr_b16 v[194:195], v5 offset:32000
    s_waitcnt lgkmcnt(6)
    v_mfma_f32_32x32x16_bf16 v[160:175], v[200:203], v[36:39], v[160:175]
    ds_write_b32 v23, v21
    v_lshlrev_b32 v23, 4, v4
    v_add_u32 v23, s48, v23
    ds_read_b128 v[240:243], v23 offset:0
    ds_read_b64_tr_b16 v[196:197], v6 offset:3072
    ds_read_b64_tr_b16 v[198:199], v6 offset:3328
    v_mfma_f32_32x32x16_bf16 v[176:191], v[36:39], v[204:207], v[176:191]
    ds_read_b128 v[244:247], v23 offset:32
    ds_read_b128 v[248:251], v23 offset:64
    ds_read_b128 v[252:255], v23 offset:96
    ds_read_b64_tr_b16 v[200:201], v5 offset:32768
    ds_read_b64_tr_b16 v[202:203], v5 offset:33024
    s_waitcnt lgkmcnt(11)
    v_mfma_f32_32x32x16_bf16 v[160:175], v[208:211], v[40:43], v[160:175]
    ds_read_b32 v216, v10 offset:128
    ds_read_b32 v217, v10 offset:512
    ds_read_b32 v218, v10 offset:896
    ds_read_b32 v219, v10 offset:1280
    ds_read_b64_tr_b16 v[204:205], v6 offset:4096
    ds_read_b64_tr_b16 v[206:207], v6 offset:4352
    v_mfma_f32_32x32x16_bf16 v[176:191], v[40:43], v[212:215], v[176:191]
    ds_read_b64_tr_b16 v[208:209], v5 offset:33792
    ds_read_b64_tr_b16 v[210:211], v5 offset:34048
    s_add_u32 m0, s26, 1024
    s_add_u32 s77, s78, 43008
    buffer_load_dwordx4 v19, s[64:67], s77 offen lds
    s_waitcnt lgkmcnt(13)
    v_mfma_f32_32x32x16_bf16 v[160:175], v[192:195], v[44:47], v[160:175]
    s_nop 0
    s_nop 0
    s_nop 0
    s_nop 0
    ds_read_b64_tr_b16 v[212:213], v6 offset:5120
    ds_read_b64_tr_b16 v[214:215], v6 offset:5376
    v_mfma_f32_32x32x16_bf16 v[176:191], v[44:47], v[196:199], v[176:191]
    s_nop 0
    s_nop 0
    s_waitcnt lgkmcnt(8)
    v_add_f32 v216, v216, v217
    ds_read_b64_tr_b16 v[192:193], v5 offset:34816
    ds_read_b64_tr_b16 v[194:195], v5 offset:35072
    s_waitcnt lgkmcnt(6)
    v_mfma_f32_32x32x16_bf16 v[160:175], v[200:203], v[48:51], v[160:175]
    v_add_f32 v218, v218, v219
    v_add_f32 v216, v216, v218
    v_cndmask_b32 v216, v216, 0, s[74:75]
    v_cvt_pk_bf16_f32 v22, v216, v216
    ds_read_b64_tr_b16 v[196:197], v6 offset:6144
    ds_read_b64_tr_b16 v[198:199], v6 offset:6400
    v_mfma_f32_32x32x16_bf16 v[176:191], v[48:51], v[204:207], v[176:191]
    v_and_b32 v22, 0xffff0000, v22
    v_sub_f32 v216, v216, v22
    v_cvt_pk_bf16_f32 v24, v216, v216
    ds_read_b64_tr_b16 v[200:201], v5 offset:35840
    ds_read_b64_tr_b16 v[202:203], v5 offset:36096
    s_waitcnt lgkmcnt(6)
    v_mfma_f32_32x32x16_bf16 v[160:175], v[208:211], v[52:55], v[160:175]
    v_and_b32 v24, 0xffff0000, v24
    ds_read_b64_tr_b16 v[204:205], v6 offset:7168
    ds_read_b64_tr_b16 v[206:207], v6 offset:7424
    s_add_u32 m0, s26, 2048
    s_add_u32 s77, s78, 86016
    buffer_load_dwordx4 v19, s[64:67], s77 offen lds
    v_mfma_f32_32x32x16_bf16 v[176:191], v[52:55], v[212:215], v[176:191]
    v_sub_f32 v216, v216, v24
    v_lshrrev_b32 v22, 16, v22
    v_or_b32 v232, v22, v24
    ds_read_b64_tr_b16 v[208:209], v5 offset:36864
    ds_read_b64_tr_b16 v[210:211], v5 offset:37120
    s_waitcnt lgkmcnt(6)
    v_mfma_f32_32x32x16_bf16 v[160:175], v[192:195], v[56:59], v[160:175]
    v_cvt_pk_bf16_f32 v233, v216, 0
    v_mov_b32 v234, 0
    v_mov_b32 v235, 0
    ds_read_b64_tr_b16 v[212:213], v6 offset:8192
    ds_read_b64_tr_b16 v[214:215], v6 offset:8448
    v_mfma_f32_32x32x16_bf16 v[176:191], v[56:59], v[196:199], v[176:191]
    ds_read_b64_tr_b16 v[192:193], v5 offset:37888
    ds_read_b64_tr_b16 v[194:195], v5 offset:38144
    s_waitcnt lgkmcnt(6)
    v_mfma_f32_32x32x16_bf16 v[160:175], v[200:203], v[60:63], v[160:175]
    ds_write_b128 v14, v[232:235]
    v_add_u32 v14, 1024, v14
    ds_read_b64_tr_b16 v[196:197], v6 offset:9216
    ds_read_b64_tr_b16 v[198:199], v6 offset:9472
    v_mfma_f32_32x32x16_bf16 v[176:191], v[60:63], v[204:207], v[176:191]
    ds_read_b64_tr_b16 v[200:201], v5 offset:38912
    ds_read_b64_tr_b16 v[202:203], v5 offset:39168
    s_add_u32 m0, s26, 3072
    s_add_u32 s77, s78, 129024
    buffer_load_dwordx4 v19, s[64:67], s77 offen lds
    s_waitcnt lgkmcnt(7)
    v_mfma_f32_32x32x16_bf16 v[160:175], v[208:211], v[64:67], v[160:175]
    ds_read_b32 v216, v10 offset:256
    ds_read_b32 v217, v10 offset:640
    ds_read_b32 v218, v10 offset:1024
    ds_read_b32 v219, v10 offset:1408
    ds_read_b64_tr_b16 v[204:205], v6 offset:10240
    ds_read_b64_tr_b16 v[206:207], v6 offset:10496
    v_mfma_f32_32x32x16_bf16 v[176:191], v[64:67], v[212:215], v[176:191]
    s_nop 0
    s_nop 0
    s_nop 0
    ds_read_b64_tr_b16 v[208:209], v5 offset:39936
    ds_read_b64_tr_b16 v[210:211], v5 offset:40192
    s_waitcnt lgkmcnt(10)
    v_mfma_f32_32x32x16_bf16 v[160:175], v[192:195], v[68:71], v[160:175]
    s_nop 0
    s_nop 0
    s_nop 0
    s_waitcnt lgkmcnt(6)
    v_add_f32 v216, v216, v217
    ds_read_b64_tr_b16 v[212:213], v6 offset:11264
    ds_read_b64_tr_b16 v[214:215], v6 offset:11520
    v_mfma_f32_32x32x16_bf16 v[176:191], v[68:71], v[196:199], v[176:191]
    s_waitcnt lgkmcnt(6)
    v_add_f32 v218, v218, v219
    v_add_f32 v216, v216, v218
    ds_read_b64_tr_b16 v[192:193], v5 offset:40960
    ds_read_b64_tr_b16 v[194:195], v5 offset:41216
    s_waitcnt lgkmcnt(6)
    v_mfma_f32_32x32x16_bf16 v[160:175], v[200:203], v[72:75], v[160:175]
    v_cndmask_b32 v216, v216, 0, s[74:75]
    ds_read_b64_tr_b16 v[196:197], v6 offset:12288
    ds_read_b64_tr_b16 v[198:199], v6 offset:12544
    s_add_u32 m0, s26, 4096
    s_add_u32 s77, s78, 172032
    buffer_load_dwordx4 v19, s[64:67], s77 offen lds
    v_mfma_f32_32x32x16_bf16 v[176:191], v[72:75], v[204:207], v[176:191]
    v_cvt_pk_bf16_f32 v22, v216, v216
    v_and_b32 v22, 0xffff0000, v22
    v_sub_f32 v216, v216, v22
    ds_read_b64_tr_b16 v[200:201], v5 offset:41984
    ds_read_b64_tr_b16 v[202:203], v5 offset:42240
    s_waitcnt lgkmcnt(6)
    v_mfma_f32_32x32x16_bf16 v[160:175], v[208:211], v[76:79], v[160:175]
    v_cvt_pk_bf16_f32 v24, v216, v216
    v_and_b32 v24, 0xffff0000, v24
    v_sub_f32 v216, v216, v24
    v_lshrrev_b32 v22, 16, v22
    ds_read_b64_tr_b16 v[204:205], v6 offset:13312
    ds_read_b64_tr_b16 v[206:207], v6 offset:13568
    v_mfma_f32_32x32x16_bf16 v[176:191], v[76:79], v[212:215], v[176:191]
    v_or_b32 v236, v22, v24
    v_cvt_pk_bf16_f32 v237, v216, 0
    v_mov_b32 v238, 0
    ds_read_b64_tr_b16 v[208:209], v5 offset:43008
    ds_read_b64_tr_b16 v[210:211], v5 offset:43264
    s_waitcnt lgkmcnt(6)
    v_mfma_f32_32x32x16_bf16 v[160:175], v[192:195], v[80:83], v[160:175]
    v_mov_b32 v239, 0
    ds_read_b64_tr_b16 v[212:213], v6 offset:14336
    ds_read_b64_tr_b16 v[214:215], v6 offset:14592
    v_mfma_f32_32x32x16_bf16 v[176:191], v[80:83], v[196:199], v[176:191]
    ds_read_b64_tr_b16 v[192:193], v5 offset:44032
    ds_read_b64_tr_b16 v[194:195], v5 offset:44288
    s_add_u32 m0, s26, 5120
    s_add_u32 s77, s78, 215040
    buffer_load_dwordx4 v19, s[64:67], s77 offen lds
    s_waitcnt lgkmcnt(6)
    v_mfma_f32_32x32x16_bf16 v[160:175], v[200:203], v[84:87], v[160:175]
    ds_write_b128 v14, v[236:239]
    v_add_u32 v14, 1024, v14
    ds_read_b64_tr_b16 v[196:197], v6 offset:15360
    ds_read_b64_tr_b16 v[198:199], v6 offset:15616
    v_mfma_f32_32x32x16_bf16 v[176:191], v[84:87], v[204:207], v[176:191]
    s_lshl_b32 s48, s5, 6
    s_add_u32 s48, s48, s6
    s_lshl_b32 s52, s48, 2
    ds_read_b64_tr_b16 v[200:201], v5 offset:45056
    ds_read_b64_tr_b16 v[202:203], v5 offset:45312
    s_waitcnt lgkmcnt(7)
    v_mfma_f32_32x32x16_bf16 v[160:175], v[208:211], v[88:91], v[160:175]
    s_add_u32 s52, s52, 32768
    s_lshl_b32 s53, s48, 12
    s_add_u32 s53, s53, s37
    ds_read_b64_tr_b16 v[204:205], v6 offset:16384
    ds_read_b64_tr_b16 v[206:207], v6 offset:16640
    v_mfma_f32_32x32x16_bf16 v[176:191], v[88:91], v[212:215], v[176:191]
    ds_read_b64_tr_b16 v[208:209], v5 offset:46080
    ds_read_b64_tr_b16 v[210:211], v5 offset:46336
    s_waitcnt lgkmcnt(6)
    v_mfma_f32_32x32x16_bf16 v[160:175], v[192:195], v[92:95], v[160:175]
    ds_read_b64_tr_b16 v[212:213], v6 offset:17408
    ds_read_b64_tr_b16 v[214:215], v6 offset:17664
    s_add_u32 m0, s26, 6144
    s_add_u32 s77, s78, 258048
    buffer_load_dwordx4 v19, s[64:67], s77 offen lds
    v_mfma_f32_32x32x16_bf16 v[176:191], v[92:95], v[196:199], v[176:191]
    ds_read_b64_tr_b16 v[192:193], v5 offset:47104
    ds_read_b64_tr_b16 v[194:195], v5 offset:47360
    s_waitcnt lgkmcnt(6)
    v_mfma_f32_32x32x16_bf16 v[160:175], v[200:203], v[96:99], v[160:175]
    ds_read_b64_tr_b16 v[196:197], v6 offset:18432
    ds_read_b64_tr_b16 v[198:199], v6 offset:18688
    v_mfma_f32_32x32x16_bf16 v[176:191], v[96:99], v[204:207], v[176:191]
    ds_read_b64_tr_b16 v[200:201], v5 offset:48128
    ds_read_b64_tr_b16 v[202:203], v5 offset:48384
    s_waitcnt lgkmcnt(6)
    v_mfma_f32_32x32x16_bf16 v[160:175], v[208:211], v[100:103], v[160:175]
    ds_read_b64_tr_b16 v[204:205], v6 offset:19456
    ds_read_b64_tr_b16 v[206:207], v6 offset:19712
    v_mfma_f32_32x32x16_bf16 v[176:191], v[100:103], v[212:215], v[176:191]
    ds_read_b64_tr_b16 v[208:209], v5 offset:49152
    ds_read_b64_tr_b16 v[210:211], v5 offset:49408
    s_waitcnt lgkmcnt(6)
    v_mfma_f32_32x32x16_bf16 v[160:175], v[192:195], v[104:107], v[160:175]
    ds_read_b64_tr_b16 v[212:213], v6 offset:20480
    ds_read_b64_tr_b16 v[214:215], v6 offset:20736
    v_mfma_f32_32x32x16_bf16 v[176:191], v[104:107], v[196:199], v[176:191]
    ds_read_b64_tr_b16 v[192:193], v5 offset:50176
    ds_read_b64_tr_b16 v[194:195], v5 offset:50432
    s_waitcnt lgkmcnt(6)
    v_mfma_f32_32x32x16_bf16 v[160:175], v[200:203], v[108:111], v[160:175]
    ds_read_b64_tr_b16 v[196:197], v6 offset:21504
    ds_read_b64_tr_b16 v[198:199], v6 offset:21760
    v_mfma_f32_32x32x16_bf16 v[176:191], v[108:111], v[204:207], v[176:191]
    ds_read_b64_tr_b16 v[200:201], v5 offset:51200
    ds_read_b64_tr_b16 v[202:203], v5 offset:51456
    s_waitcnt lgkmcnt(6)
    v_mfma_f32_32x32x16_bf16 v[160:175], v[208:211], v[112:115], v[160:175]
    ds_read_b64_tr_b16 v[204:205], v6 offset:22528
    ds_read_b64_tr_b16 v[206:207], v6 offset:22784
    v_mfma_f32_32x32x16_bf16 v[176:191], v[112:115], v[212:215], v[176:191]
    ds_read_b64_tr_b16 v[208:209], v5 offset:52224
    ds_read_b64_tr_b16 v[210:211], v5 offset:52480
    s_waitcnt lgkmcnt(6)
    v_mfma_f32_32x32x16_bf16 v[160:175], v[192:195], v[116:119], v[160:175]
    ds_read_b64_tr_b16 v[212:213], v6 offset:23552
    ds_read_b64_tr_b16 v[214:215], v6 offset:23808
    v_mfma_f32_32x32x16_bf16 v[176:191], v[116:119], v[196:199], v[176:191]
    ds_read_b64_tr_b16 v[192:193], v5 offset:53248
    ds_read_b64_tr_b16 v[194:195], v5 offset:53504
    s_waitcnt lgkmcnt(6)
    v_mfma_f32_32x32x16_bf16 v[160:175], v[200:203], v[120:123], v[160:175]
    ds_read_b64_tr_b16 v[196:197], v6 offset:24576
    ds_read_b64_tr_b16 v[198:199], v6 offset:24832
    v_mfma_f32_32x32x16_bf16 v[176:191], v[120:123], v[204:207], v[176:191]
    ds_read_b64_tr_b16 v[200:201], v5 offset:54272
    ds_read_b64_tr_b16 v[202:203], v5 offset:54528
    s_waitcnt lgkmcnt(6)
    v_mfma_f32_32x32x16_bf16 v[160:175], v[208:211], v[124:127], v[160:175]
    ds_read_b64_tr_b16 v[204:205], v6 offset:25600
    ds_read_b64_tr_b16 v[206:207], v6 offset:25856
    v_mfma_f32_32x32x16_bf16 v[176:191], v[124:127], v[212:215], v[176:191]
    ds_read_b64_tr_b16 v[208:209], v5 offset:55296
    ds_read_b64_tr_b16 v[210:211], v5 offset:55552
    s_waitcnt lgkmcnt(6)
    v_mfma_f32_32x32x16_bf16 v[160:175], v[192:195], v[128:131], v[160:175]
    ds_read_b64_tr_b16 v[212:213], v6 offset:26624
    ds_read_b64_tr_b16 v[214:215], v6 offset:26880
    v_mfma_f32_32x32x16_bf16 v[176:191], v[128:131], v[196:199], v[176:191]
    ds_read_b64_tr_b16 v[192:193], v5 offset:56320
    ds_read_b64_tr_b16 v[194:195], v5 offset:56576
    s_waitcnt lgkmcnt(6)
    v_mfma_f32_32x32x16_bf16 v[160:175], v[200:203], v[132:135], v[160:175]
    ds_read_b64_tr_b16 v[196:197], v6 offset:27648
    ds_read_b64_tr_b16 v[198:199], v6 offset:27904
    v_mfma_f32_32x32x16_bf16 v[176:191], v[132:135], v[204:207], v[176:191]
    s_waitcnt lgkmcnt(4)
    v_mfma_f32_32x32x16_bf16 v[160:175], v[208:211], v[136:139], v[160:175]
    v_mfma_f32_32x32x16_bf16 v[176:191], v[136:139], v[212:215], v[176:191]
    s_waitcnt lgkmcnt(0)
    v_mfma_f32_32x32x16_bf16 v[160:175], v[192:195], v[140:143], v[160:175]
    v_mfma_f32_32x32x16_bf16 v[176:191], v[140:143], v[196:199], v[176:191]
    v_mfma_f32_32x32x16_bf16 v[160:175], v[232:235], v[28:31], v[160:175]
    v_mfma_f32_32x32x16_bf16 v[176:191], v[28:31], v[236:239], v[176:191]
    v_mov_b32 v22, v21
    s_nop 9
    v_pk_mul_f32 v[160:161], v[160:161], v[22:23] op_sel_hi:[1,0]
    v_pk_mul_f32 v[162:163], v[162:163], v[22:23] op_sel_hi:[1,0]
    v_pk_mul_f32 v[164:165], v[164:165], v[22:23] op_sel_hi:[1,0]
    v_pk_mul_f32 v[166:167], v[166:167], v[22:23] op_sel_hi:[1,0]
    v_pk_mul_f32 v[168:169], v[168:169], v[22:23] op_sel_hi:[1,0]
    v_pk_mul_f32 v[170:171], v[170:171], v[22:23] op_sel_hi:[1,0]
    v_pk_mul_f32 v[172:173], v[172:173], v[22:23] op_sel_hi:[1,0]
    v_pk_mul_f32 v[174:175], v[174:175], v[22:23] op_sel_hi:[1,0]
    v_cvt_pk_bf16_f32 v216, v160, v161
    v_cvt_pk_bf16_f32 v217, v162, v163
    v_cvt_pk_bf16_f32 v218, v164, v165
    v_cvt_pk_bf16_f32 v219, v166, v167
    v_cvt_pk_bf16_f32 v220, v168, v169
    v_cvt_pk_bf16_f32 v221, v170, v171
    v_cvt_pk_bf16_f32 v222, v172, v173
    v_cvt_pk_bf16_f32 v223, v174, v175
    v_cndmask_b32 v222, v222, 0, s[96:97]
    v_cndmask_b32 v223, v223, 0, s[96:97]
    buffer_store_dwordx4 v[216:219], v1, s[8:11], s53 offen offset:0 sc1
    buffer_store_dwordx4 v[220:223], v1, s[8:11], s53 offen offset:1024 sc1
    v_pk_mul_f32 v[176:177], v[176:177], v[240:241]
    v_pk_mul_f32 v[178:179], v[178:179], v[242:243]
    v_pk_mul_f32 v[180:181], v[180:181], v[244:245]
    v_pk_mul_f32 v[182:183], v[182:183], v[246:247]
    v_pk_mul_f32 v[184:185], v[184:185], v[248:249]
    v_pk_mul_f32 v[186:187], v[186:187], v[250:251]
    v_pk_mul_f32 v[188:189], v[188:189], v[252:253]
    v_pk_mul_f32 v[190:191], v[190:191], v[254:255]
    v_cvt_pk_bf16_f32 v224, v176, v177
    v_cndmask_b32 v224, v224, v8, s[98:99]
    v_cvt_pk_bf16_f32 v225, v178, v179
    v_cndmask_b32 v225, v225, v8, s[98:99]
    v_cvt_pk_bf16_f32 v226, v180, v181
    v_cndmask_b32 v226, v226, v8, s[98:99]
    v_cvt_pk_bf16_f32 v227, v182, v183
    v_cndmask_b32 v227, v227, v8, s[98:99]
    v_cvt_pk_bf16_f32 v228, v184, v185
    v_cndmask_b32 v228, v228, v8, s[98:99]
    v_cvt_pk_bf16_f32 v229, v186, v187
    v_cndmask_b32 v229, v229, v8, s[98:99]
    v_cvt_pk_bf16_f32 v230, v188, v189
    v_cndmask_b32 v230, v230, v8, s[98:99]
    v_cvt_pk_bf16_f32 v231, v190, v191
    v_cndmask_b32 v231, v231, v8, s[98:99]
    buffer_store_dwordx4 v[224:227], v1, s[8:11], s53 offen offset:2048 sc1
    buffer_store_dwordx4 v[228:231], v1, s[8:11], s53 offen offset:3072 sc1
    ds_write_b128 v12, v[216:219] offset:32768
    ds_write_b128 v12, v[220:223] offset:33792
    ds_write_b128 v12, v[224:227] offset:34816
    ds_write_b128 v12, v[228:231] offset:35840
    s_waitcnt vmcnt(4)
    ds_read_b64_tr_b16 v[160:161], v26 offset:0
    ds_read_b64_tr_b16 v[162:163], v26 offset:256
    ds_read_b64_tr_b16 v[164:165], v26 offset:1024
    ds_read_b64_tr_b16 v[166:167], v26 offset:1280
    ds_read_b64_tr_b16 v[168:169], v26 offset:2048
    ds_read_b64_tr_b16 v[170:171], v26 offset:2304
    ds_read_b64_tr_b16 v[172:173], v26 offset:3072
    ds_read_b64_tr_b16 v[174:175], v26 offset:3328
    ds_read_b64_tr_b16 v[176:177], v26 offset:4096
    ds_read_b64_tr_b16 v[178:179], v26 offset:4352
    ds_read_b64_tr_b16 v[180:181], v26 offset:5120
    ds_read_b64_tr_b16 v[182:183], v26 offset:5376
    ds_read_b64_tr_b16 v[184:185], v26 offset:6144
    ds_read_b64_tr_b16 v[186:187], v26 offset:6400
    s_waitcnt lgkmcnt(13)
    v_dot2_f32_bf16 v17, v160, v8, v17
    v_dot2_f32_bf16 v17, v161, v8, v17
    s_waitcnt lgkmcnt(12)
    v_dot2_f32_bf16 v17, v162, v8, v17
    v_dot2_f32_bf16 v17, v163, v8, v17
    s_waitcnt lgkmcnt(11)
    v_dot2_f32_bf16 v17, v164, v8, v17
    v_dot2_f32_bf16 v17, v165, v8, v17
    s_waitcnt lgkmcnt(10)
    v_dot2_f32_bf16 v17, v166, v8, v17
    v_dot2_f32_bf16 v17, v167, v8, v17
    s_waitcnt lgkmcnt(9)
    v_dot2_f32_bf16 v17, v168, v8, v17
    v_dot2_f32_bf16 v17, v169, v8, v17
    s_waitcnt lgkmcnt(8)
    v_dot2_f32_bf16 v17, v170, v8, v17
    v_dot2_f32_bf16 v17, v171, v8, v17
    s_waitcnt lgkmcnt(7)
    v_dot2_f32_bf16 v17, v172, v8, v17
    v_dot2_f32_bf16 v17, v173, v8, v17
    s_waitcnt lgkmcnt(6)
    v_dot2_f32_bf16 v17, v174, v8, v17
    v_dot2_f32_bf16 v17, v175, v8, v17
    s_waitcnt lgkmcnt(5)
    v_dot2_f32_bf16 v17, v176, v8, v17
    v_dot2_f32_bf16 v17, v177, v8, v17
    s_waitcnt lgkmcnt(4)
    v_dot2_f32_bf16 v17, v178, v8, v17
    v_dot2_f32_bf16 v17, v179, v8, v17
    s_waitcnt lgkmcnt(3)
    v_dot2_f32_bf16 v17, v180, v8, v17
    v_dot2_f32_bf16 v17, v181, v8, v17
    s_waitcnt lgkmcnt(2)
    v_dot2_f32_bf16 v17, v182, v8, v17
    v_dot2_f32_bf16 v17, v183, v8, v17
    s_waitcnt lgkmcnt(1)
    v_dot2_f32_bf16 v17, v184, v8, v17
    v_dot2_f32_bf16 v17, v185, v8, v17
    s_waitcnt lgkmcnt(0)
    v_dot2_f32_bf16 v17, v186, v8, v17
    v_dot2_f32_bf16 v17, v187, v8, v17
    s_nop 2
    v_mov_b32 v22, v17
    s_nop 1
    v_permlane32_swap_b32 v17, v22
    v_add_f32 v17, v17, v22
    s_mul_i32 s48, s3, 384
    s_add_u32 s48, s48, 162304
    v_lshlrev_b32 v25, 2, v3
    v_add_u32 v24, s48, v25
    ds_write_b32 v24, v17 offset:0
    v_mov_b32 v18, 1
    s_waitcnt vmcnt(0)
    s_mov_b64 exec, 1
    buffer_store_dword v18, v11, s[8:11], s52 offen sc1
    s_mov_b64 exec, -1
    v_min_u32 v19, 15, v2
    v_lshlrev_b32 v19, 7, v19
    s_add_u32 s0, s101, 0
    buffer_load_dword v0, v19, s[8:11], s0 offen sc1
    v_min_u32 v19, 1, v2
    v_lshlrev_b32 v19, 7, v19
    s_add_u32 s0, s1, 0
    buffer_load_dword v0, v19, s[8:11], s0 offen sc1
    v_min_u32 v19, 15, v2
    v_lshlrev_b32 v19, 7, v19
    s_add_u32 s0, s100, 0
    buffer_load_dword v0, v19, s[8:11], s0 offen sc1
    s_waitcnt lgkmcnt(0)
    s_barrier
    v_and_b32 v7, 15, v2
    v_lshlrev_b32 v7, 4, v7
    buffer_load_dword v15, v7, s[16:19], 0 offen sc1
    ds_read_b64_tr_b16 v[160:161], v9
    ds_read_b64_tr_b16 v[162:163], v9 offset:512
    s_add_u32 s48, s82, s83
    v_add_u32 v9, s48, v9
    ds_read_b64_tr_b16 v[164:165], v9
    ds_read_b64_tr_b16 v[166:167], v9 offset:512
    s_sub_u32 s48, s82, s83
    v_add_u32 v9, s48, v9
    ds_read_b64_tr_b16 v[168:169], v9
    ds_read_b64_tr_b16 v[170:171], v9 offset:512
    s_add_u32 s48, s82, s83
    v_add_u32 v9, s48, v9
    ds_read_b64_tr_b16 v[172:173], v9
    ds_read_b64_tr_b16 v[174:175], v9 offset:512
    s_sub_u32 s48, s82, s83
    v_add_u32 v9, s48, v9
    ds_read_b64_tr_b16 v[176:177], v9
    ds_read_b64_tr_b16 v[178:179], v9 offset:512
    s_add_u32 s48, s82, s83
    v_add_u32 v9, s48, v9
    ds_read_b64_tr_b16 v[180:181], v9
    ds_read_b64_tr_b16 v[182:183], v9 offset:512
    s_sub_u32 s48, s82, s83
    v_add_u32 v9, s48, v9
    ds_read_b64_tr_b16 v[184:185], v9
    ds_read_b64_tr_b16 v[186:187], v9 offset:512
    s_add_u32 s48, s82, s83
    v_add_u32 v9, s48, v9
    ds_read_b64_tr_b16 v[188:189], v9
    ds_read_b64_tr_b16 v[190:191], v9 offset:512
    s_sub_u32 s48, s82, s83
    v_add_u32 v9, s48, v9
    v_mov_b32 v23, 0
    s_waitcnt lgkmcnt(12)
    v_cndmask_b32 v166, v166, 0, s[80:81]
    v_cndmask_b32 v167, v167, 0, s[80:81]
    s_waitcnt lgkmcnt(8)
    v_cndmask_b32 v174, v174, 0, s[80:81]
    v_cndmask_b32 v175, v175, 0, s[80:81]
    s_waitcnt lgkmcnt(4)
    v_cndmask_b32 v182, v182, 0, s[80:81]
    v_cndmask_b32 v183, v183, 0, s[80:81]
    s_waitcnt lgkmcnt(0)
    v_cndmask_b32 v190, v190, 0, s[80:81]
    v_cndmask_b32 v191, v191, 0, s[80:81]
    buffer_store_dwordx4 v[160:163], v1, s[8:11], s89 offen offset:0 sc1
    buffer_store_dwordx4 v[164:167], v1, s[8:11], s89 offen offset:1024 sc1
    v_dot2_f32_bf16 v23, v160, v8, v23
    v_dot2_f32_bf16 v23, v161, v8, v23
    v_dot2_f32_bf16 v23, v162, v8, v23
    v_dot2_f32_bf16 v23, v163, v8, v23
    v_dot2_f32_bf16 v23, v164, v8, v23
    v_dot2_f32_bf16 v23, v165, v8, v23
    v_dot2_f32_bf16 v23, v166, v8, v23
    v_dot2_f32_bf16 v23, v167, v8, v23
    v_dot2_f32_bf16 v23, v168, v8, v23
    v_dot2_f32_bf16 v23, v169, v8, v23
    v_dot2_f32_bf16 v23, v170, v8, v23
    v_dot2_f32_bf16 v23, v171, v8, v23
    v_dot2_f32_bf16 v23, v172, v8, v23
    v_dot2_f32_bf16 v23, v173, v8, v23
    v_dot2_f32_bf16 v23, v174, v8, v23
    v_dot2_f32_bf16 v23, v175, v8, v23
    v_dot2_f32_bf16 v23, v176, v8, v23
    v_dot2_f32_bf16 v23, v177, v8, v23
    v_dot2_f32_bf16 v23, v178, v8, v23
    v_dot2_f32_bf16 v23, v179, v8, v23
    v_dot2_f32_bf16 v23, v180, v8, v23
    v_dot2_f32_bf16 v23, v181, v8, v23
    v_dot2_f32_bf16 v23, v182, v8, v23
    v_dot2_f32_bf16 v23, v183, v8, v23
    v_dot2_f32_bf16 v23, v184, v8, v23
    v_dot2_f32_bf16 v23, v185, v8, v23
    v_dot2_f32_bf16 v23, v186, v8, v23
    v_dot2_f32_bf16 v23, v187, v8, v23
    s_nop 2
    v_mov_b32 v22, v23
    s_nop 1
    v_permlane32_swap_b32 v23, v22
    v_add_f32 v23, v23, v22
    v_lshlrev_b32 v25, 2, v3
    buffer_store_dword v23, v25, s[8:11], s90 offen sc1
    v_add_u32 v14, 152576, v1
    ds_read_b64_tr_b16 v[192:193], v5 offset:0
    ds_read_b64_tr_b16 v[194:195], v5 offset:256
    ds_read_b64_tr_b16 v[196:197], v5 offset:1024
    ds_read_b64_tr_b16 v[198:199], v5 offset:1280
    ds_read_b64_tr_b16 v[200:201], v5 offset:2048
    ds_read_b64_tr_b16 v[202:203], v5 offset:2304
    ds_read_b64_tr_b16 v[204:205], v5 offset:3072
    ds_read_b64_tr_b16 v[206:207], v5 offset:3328
    ds_read_b64_tr_b16 v[208:209], v5 offset:4096
    ds_read_b64_tr_b16 v[210:211], v5 offset:4352
    s_waitcnt lgkmcnt(6)
    v_mfma_f32_32x32x16_bf16 v[144:159], v[192:195], v[32:35], 0
    ds_read_b64_tr_b16 v[212:213], v5 offset:5120
    ds_read_b64_tr_b16 v[214:215], v5 offset:5376
    buffer_store_dwordx4 v[168:171], v1, s[8:11], s89 offen offset:2048 sc1
    v_mfma_f32_32x32x16_bf16 v[144:159], v[196:199], v[36:39], v[144:159]
    ds_read_b32 v244, v10 offset:0
    ds_read_b32 v245, v10 offset:384
    ds_read_b32 v246, v10 offset:768
    ds_read_b64_tr_b16 v[192:193], v5 offset:6144
    ds_read_b64_tr_b16 v[194:195], v5 offset:6400
    s_waitcnt lgkmcnt(9)
    v_mfma_f32_32x32x16_bf16 v[144:159], v[200:203], v[40:43], v[144:159]
    ds_read_b32 v247, v10 offset:1152
    s_nop 0
    s_nop 0
    s_nop 0
    ds_read_b64_tr_b16 v[196:197], v5 offset:7168
    ds_read_b64_tr_b16 v[198:199], v5 offset:7424
    v_mfma_f32_32x32x16_bf16 v[144:159], v[204:207], v[44:47], v[144:159]
    s_nop 0
    ds_read_b64_tr_b16 v[200:201], v5 offset:8192
    ds_read_b64_tr_b16 v[202:203], v5 offset:8448
    buffer_store_dwordx4 v[172:175], v1, s[8:11], s89 offen offset:3072 sc1
    s_waitcnt lgkmcnt(10)
    v_mfma_f32_32x32x16_bf16 v[144:159], v[208:211], v[48:51], v[144:159]
    s_nop 0
    s_nop 0
    s_waitcnt lgkmcnt(8)
    v_add_f32 v244, v244, v245
    ds_read_b64_tr_b16 v[204:205], v5 offset:9216
    ds_read_b64_tr_b16 v[206:207], v5 offset:9472
    v_mfma_f32_32x32x16_bf16 v[144:159], v[212:215], v[52:55], v[144:159]
    s_waitcnt lgkmcnt(6)
    v_add_f32 v246, v246, v247
    v_add_f32 v244, v244, v246
    ds_read_b64_tr_b16 v[208:209], v5 offset:10240
    ds_read_b64_tr_b16 v[210:211], v5 offset:10496
    s_waitcnt lgkmcnt(6)
    v_mfma_f32_32x32x16_bf16 v[144:159], v[192:195], v[56:59], v[144:159]
    v_cndmask_b32 v244, v244, 0, s[74:75]
    ds_read_b64_tr_b16 v[212:213], v5 offset:11264
    ds_read_b64_tr_b16 v[214:215], v5 offset:11520
    s_add_u32 s89, s89, 4096
    buffer_store_dwordx4 v[176:179], v1, s[8:11], s89 offen offset:0 sc1
    v_mfma_f32_32x32x16_bf16 v[144:159], v[196:199], v[60:63], v[144:159]
    v_cvt_pk_bf16_f32 v22, v244, v244
    v_and_b32 v22, 0xffff0000, v22
    v_sub_f32 v244, v244, v22
    ds_read_b64_tr_b16 v[192:193], v5 offset:12288
    ds_read_b64_tr_b16 v[194:195], v5 offset:12544
    s_waitcnt lgkmcnt(6)
    v_mfma_f32_32x32x16_bf16 v[144:159], v[200:203], v[64:67], v[144:159]
    v_cvt_pk_bf16_f32 v24, v244, v244
    v_and_b32 v24, 0xffff0000, v24
    v_sub_f32 v244, v244, v24
    v_lshrrev_b32 v22, 16, v22
    ds_read_b64_tr_b16 v[196:197], v5 offset:13312
    ds_read_b64_tr_b16 v[198:199], v5 offset:13568
    v_mfma_f32_32x32x16_bf16 v[144:159], v[204:207], v[68:71], v[144:159]
    v_or_b32 v240, v22, v24
    ds_read_b64_tr_b16 v[200:201], v5 offset:14336
    ds_read_b64_tr_b16 v[202:203], v5 offset:14592
    buffer_store_dwordx4 v[180:183], v1, s[8:11], s89 offen offset:1024 sc1
    s_waitcnt lgkmcnt(6)
    v_mfma_f32_32x32x16_bf16 v[144:159], v[208:211], v[72:75], v[144:159]
    v_cvt_pk_bf16_f32 v241, v244, 0
    v_mov_b32 v242, 0
    v_mov_b32 v243, 0
    ds_read_b64_tr_b16 v[204:205], v5 offset:15360
    ds_read_b64_tr_b16 v[206:207], v5 offset:15616
    v_mfma_f32_32x32x16_bf16 v[144:159], v[212:215], v[76:79], v[144:159]
    ds_read_b64_tr_b16 v[208:209], v5 offset:16384
    ds_read_b64_tr_b16 v[210:211], v5 offset:16640
    s_waitcnt lgkmcnt(6)
    v_mfma_f32_32x32x16_bf16 v[144:159], v[192:195], v[80:83], v[144:159]
    ds_read_b64_tr_b16 v[212:213], v5 offset:17408
    ds_read_b64_tr_b16 v[214:215], v5 offset:17664
    buffer_store_dwordx4 v[184:187], v1, s[8:11], s89 offen offset:2048 sc1
    v_mfma_f32_32x32x16_bf16 v[144:159], v[196:199], v[84:87], v[144:159]
    ds_read_b64_tr_b16 v[192:193], v5 offset:18432
    ds_read_b64_tr_b16 v[194:195], v5 offset:18688
    s_waitcnt lgkmcnt(6)
    v_mfma_f32_32x32x16_bf16 v[144:159], v[200:203], v[88:91], v[144:159]
    ds_write_b128 v14, v[240:243]
    v_add_u32 v14, 1024, v14
    ds_read_b64_tr_b16 v[196:197], v5 offset:19456
    ds_read_b64_tr_b16 v[198:199], v5 offset:19712
    v_mfma_f32_32x32x16_bf16 v[144:159], v[204:207], v[92:95], v[144:159]
    s_cmp_ge_u32 s4, 7
    ds_read_b64_tr_b16 v[200:201], v5 offset:20480
    ds_read_b64_tr_b16 v[202:203], v5 offset:20736
    buffer_store_dwordx4 v[188:191], v1, s[8:11], s84 offen offset:3072 sc1
    s_waitcnt lgkmcnt(7)
    v_mfma_f32_32x32x16_bf16 v[144:159], v[208:211], v[96:99], v[144:159]
    s_cselect_b32 s48, 1, 0
    s_cmp_ge_u32 s4, 14
    s_cselect_b32 s48, 2, s48
    s_mul_i32 s49, s48, 7
    ds_read_b64_tr_b16 v[204:205], v5 offset:21504
    ds_read_b64_tr_b16 v[206:207], v5 offset:21760
    v_mfma_f32_32x32x16_bf16 v[144:159], v[212:215], v[100:103], v[144:159]
    s_sub_u32 s49, s4, s49
    s_mul_i32 s48, s48, 28672
    s_lshl_b32 s49, s49, 10
    ds_read_b64_tr_b16 v[208:209], v5 offset:22528
    ds_read_b64_tr_b16 v[210:211], v5 offset:22784
    s_waitcnt lgkmcnt(6)
    v_mfma_f32_32x32x16_bf16 v[144:159], v[192:195], v[104:107], v[144:159]
    s_add_u32 s48, s48, s49
    v_add_u32 v23, s48, v26
    ds_read_b64_tr_b16 v[248:249], v23
    ds_read_b64_tr_b16 v[250:251], v23 offset:256
    ds_read_b64_tr_b16 v[212:213], v5 offset:23552
    ds_read_b64_tr_b16 v[214:215], v5 offset:23808
    v_mfma_f32_32x32x16_bf16 v[144:159], v[196:199], v[108:111], v[144:159]
    s_mul_i32 s50, s5, 86016
    s_add_u32 s50, s50, s26
    s_add_u32 s50, s50, 1110016
    ds_read_b64_tr_b16 v[192:193], v5 offset:24576
    ds_read_b64_tr_b16 v[194:195], v5 offset:24832
    s_waitcnt lgkmcnt(8)
    v_mfma_f32_32x32x16_bf16 v[144:159], v[200:203], v[112:115], v[144:159]
    s_add_u32 s51, s50, s48
    s_min_u32 s49, s4, 4
    s_lshl_b32 s49, s49, 10
    s_add_u32 s49, s49, 59392
    ds_read_b64_tr_b16 v[196:197], v5 offset:25600
    ds_read_b64_tr_b16 v[198:199], v5 offset:25856
    v_mfma_f32_32x32x16_bf16 v[144:159], v[204:207], v[116:119], v[144:159]
    v_add_u32 v23, s49, v26
    ds_read_b64_tr_b16 v[252:253], v23
    ds_read_b64_tr_b16 v[254:255], v23 offset:256
    ds_read_b64_tr_b16 v[200:201], v5 offset:26624
    ds_read_b64_tr_b16 v[202:203], v5 offset:26880
    s_waitcnt lgkmcnt(8)
    v_mfma_f32_32x32x16_bf16 v[144:159], v[208:211], v[120:123], v[144:159]
    s_add_u32 s50, s50, s49
    s_cmp_gt_u32 s4, 4
    s_cselect_b32 s50, 536870912, s50
    s_nop 0
    ds_read_b64_tr_b16 v[204:205], v5 offset:27648
    ds_read_b64_tr_b16 v[206:207], v5 offset:27904
    v_mfma_f32_32x32x16_bf16 v[144:159], v[212:215], v[124:127], v[144:159]
    s_nop 0
    v_cndmask_b32 v248, v248, 0, s[72:73]
    v_cndmask_b32 v249, v249, 0, s[72:73]
    v_cndmask_b32 v250, v250, 0, s[72:73]
    v_cndmask_b32 v251, v251, 0, s[72:73]
    s_waitcnt lgkmcnt(6)
    v_mfma_f32_32x32x16_bf16 v[144:159], v[192:195], v[128:131], v[144:159]
    s_waitcnt lgkmcnt(5)
    v_cndmask_b32 v252, v252, 0, s[72:73]
    v_cndmask_b32 v253, v253, 0, s[72:73]
    s_waitcnt lgkmcnt(4)
    v_cndmask_b32 v254, v254, 0, s[72:73]
    v_cndmask_b32 v255, v255, 0, s[72:73]
    v_mfma_f32_32x32x16_bf16 v[144:159], v[196:199], v[132:135], v[144:159]
    buffer_store_dwordx4 v[248:251], v1, s[8:11], s51 offen sc1
    buffer_store_dwordx4 v[252:255], v1, s[8:11], s50 offen sc1
    s_waitcnt lgkmcnt(0)
    v_mfma_f32_32x32x16_bf16 v[144:159], v[200:203], v[136:139], v[144:159]
    v_mfma_f32_32x32x16_bf16 v[144:159], v[204:207], v[140:143], v[144:159]
    v_mfma_f32_32x32x16_bf16 v[144:159], v[240:243], v[28:31], v[144:159]
    s_waitcnt vmcnt(11)
    v_mov_b32 v18, v15
    v_lshlrev_b32 v5, 3, v3
    v_mul_u32_u24 v6, 1792, v4
    v_add_u32 v6, v6, v5
    v_lshl_or_b32 v5, v4, 2, v5
    v_add_u32 v7, 57344, v1
    v_min_u32 v9, 13, v2
    v_lshlrev_b32 v9, 2, v9
    v_add_u32 v14, 57344, v1
    v_add_u32 v15, 114688, v1
    v_add_u32 v16, 143360, v1
    v_mov_b32 v26, 4048155338
    v_and_b32 v10, 3, v2
    v_lshlrev_b32 v10, 2, v10
    v_bfe_u32 v22, v2, 2, 1
    v_lshl_or_b32 v10, v22, 7, v10
    s_lshl_b32 s49, s3, 4
    v_add_u32 v10, s49, v10
    v_lshlrev_b32 v22, 2, v4
    v_sub_u32 v22, v3, v22
    v_cmp_ge_i32 s[64:65], v22, 0
    v_cmp_ge_i32 s[66:67], v22, 1
    v_cmp_ge_i32 s[68:69], v22, 2
    v_cmp_ge_i32 s[70:71], v22, 3
    v_cmp_ge_i32 s[72:73], v22, 8
    v_cmp_ge_i32 s[74:75], v22, 9
    v_cmp_ge_i32 s[76:77], v22, 10
    v_cmp_ge_i32 s[78:79], v22, 11
    v_cmp_ge_i32 s[80:81], v22, 16
    v_cmp_ge_i32 s[82:83], v22, 17
    v_cmp_ge_i32 s[84:85], v22, 18
    v_cmp_ge_i32 s[86:87], v22, 19
    v_cmp_ge_i32 s[88:89], v22, 24
    v_cmp_ge_i32 s[90:91], v22, 25
    v_cmp_ge_i32 s[92:93], v22, 26
    v_cmp_ge_i32 s[94:95], v22, 27
    v_mul_f32 v22, 1049335798, v21
    v_pk_mul_f32 v[144:145], v[144:145], v[22:23] op_sel_hi:[1,0]
    v_pk_mul_f32 v[146:147], v[146:147], v[22:23] op_sel_hi:[1,0]
    v_pk_mul_f32 v[148:149], v[148:149], v[22:23] op_sel_hi:[1,0]
    v_pk_mul_f32 v[150:151], v[150:151], v[22:23] op_sel_hi:[1,0]
    v_pk_mul_f32 v[152:153], v[152:153], v[22:23] op_sel_hi:[1,0]
    v_pk_mul_f32 v[154:155], v[154:155], v[22:23] op_sel_hi:[1,0]
    v_pk_mul_f32 v[156:157], v[156:157], v[22:23] op_sel_hi:[1,0]
    v_pk_mul_f32 v[158:159], v[158:159], v[22:23] op_sel_hi:[1,0]
    v_cvt_pk_bf16_f32 v232, v144, v145
    v_cvt_pk_bf16_f32 v233, v146, v147
    v_cvt_pk_bf16_f32 v234, v148, v149
    v_cvt_pk_bf16_f32 v235, v150, v151
    v_cvt_pk_bf16_f32 v236, v152, v153
    v_cvt_pk_bf16_f32 v237, v154, v155
    v_cvt_pk_bf16_f32 v238, v156, v157
    v_cvt_pk_bf16_f32 v239, v158, v159
    v_mov_b32 v23, 0x3f80
    v_cndmask_b32 v238, v238, v23, s[96:97]
    v_cndmask_b32 v239, v239, 0, s[96:97]
    v_and_b32 v23, 15, v2
    v_lshlrev_b32 v23, 4, v23
    s_mov_b32 s47, 0
    v_and_b32 v22, 0xff, v18
    v_cmp_gt_u32 vcc, 16, v22
    s_nop 1
    s_cbranch_vccz ggood_3
gpoll_1:
    buffer_load_dword v18, v23, s[16:19], 0 offen sc1
    s_add_u32 s47, s47, 1
    s_cmp_gt_u32 s47, 400000
    s_cbranch_scc1 gdone_2
    s_waitcnt vmcnt(0)
    v_and_b32 v22, 0xff, v18
    v_cmp_gt_u32 vcc, 16, v22
    s_nop 1
    s_cbranch_vccz ggood_3
    s_sleep 24
    s_branch gpoll_1
ggood_3:
    s_getreg_b32 s48, hwreg(HW_REG_XCC_ID, 0, 4)
    s_mul_i32 s49, s48, s48
    s_lshl_b32 s49, s49, 20
    s_lshl_b32 s48, s48, 12
    s_or_b32 s48, s48, s49
    s_or_b32 s48, s48, 16
    v_readlane_b32 s49, v18, s4
    s_nop 3
    s_cmp_eq_u32 s48, s49
    s_cselect_b32 s45, 1, 0
gdone_2:
    s_waitcnt vmcnt(0)
    s_barrier
    s_cmp_lg_u32 s3, 0
    s_cbranch_scc1 sk_4
    s_lshl_b32 s48, s2, 7
    s_add_u32 s48, s48, 65536
    v_mov_b32 v18, 1
    s_mov_b64 exec, 1
    buffer_store_dword v18, v11, s[8:11], s48 offen sc1
    s_mov_b64 exec, -1
sk_4:
    s_cmp_eq_u32 s45, 0
    s_cbranch_scc1 SLOW_entry
    v_mfma_f32_32x32x16_bf16 v[32:47], v[216:219], v[232:235], 0
    v_mfma_f32_32x32x16_bf16 v[32:47], v[220:223], v[236:239], v[32:47]
    v_add_u32 v28, 28672, v12
    ds_read_b128 v[96:99], v28
    ds_read_b128 v[100:103], v28 offset:1024
    s_mul_i32 s48, s3, s3
    s_mul_i32 s63, s3, 30
    s_lshl_b32 s48, s48, 1
    s_sub_u32 s63, s63, s48
    s_lshl_b32 s63, s63, 10
    s_sub_u32 s0, s25, s26
    v_mov_b32 v104, v224
    v_mov_b32 v105, v225
    v_mov_b32 v106, v226
    v_mov_b32 v107, v227
    v_mov_b32 v108, v228
    v_mov_b32 v109, v229
    v_mov_b32 v110, v230
    v_mov_b32 v111, v231
    v_mov_b32 v64, 0
    v_mov_b32 v65, 0
    v_mov_b32 v66, 0
    v_mov_b32 v67, 0
    v_mov_b32 v68, 0
    v_mov_b32 v69, 0
    v_mov_b32 v70, 0
    v_mov_b32 v71, 0
    v_mov_b32 v72, 0
    v_mov_b32 v73, 0
    v_mov_b32 v74, 0
    v_mov_b32 v75, 0
    v_mov_b32 v76, 0
    v_mov_b32 v77, 0
    v_mov_b32 v78, 0
    v_mov_b32 v79, 0
    v_cndmask_b32 v32, v26, v32, s[64:65]
    v_cndmask_b32 v33, v26, v33, s[66:67]
    v_cndmask_b32 v34, v26, v34, s[68:69]
    v_cndmask_b32 v35, v26, v35, s[70:71]
    v_cndmask_b32 v36, v26, v36, s[72:73]
    v_cndmask_b32 v37, v26, v37, s[74:75]
    v_cndmask_b32 v38, v26, v38, s[76:77]
    v_cndmask_b32 v39, v26, v39, s[78:79]
    v_cndmask_b32 v40, v26, v40, s[80:81]
    v_cndmask_b32 v41, v26, v41, s[82:83]
    v_cndmask_b32 v42, v26, v42, s[84:85]
    v_cndmask_b32 v43, v26, v43, s[86:87]
    v_cndmask_b32 v44, v26, v44, s[88:89]
    v_cndmask_b32 v45, v26, v45, s[90:91]
    v_cndmask_b32 v46, v26, v46, s[92:93]
    v_cndmask_b32 v47, v26, v47, s[94:95]
    v_max_f32 v27, v32, v33
    v_max3_f32 v27, v34, v35, v27
    v_max3_f32 v27, v36, v37, v27
    v_max3_f32 v27, v38, v39, v27
    v_max3_f32 v27, v40, v41, v27
    v_max3_f32 v27, v42, v43, v27
    v_max3_f32 v27, v44, v45, v27
    v_max3_f32 v27, v46, v47, v27
    v_mov_b32 v23, v27
    s_nop 1
    v_permlane32_swap_b32 v27, v23
    v_max_f32 v27, v27, v23
    v_sub_f32 v80, 0, v27
    v_sub_f32 v81, 0, v27
    v_pk_add_f32 v[32:33], v[32:33], v[80:81]
    v_pk_add_f32 v[34:35], v[34:35], v[80:81]
    v_pk_add_f32 v[36:37], v[36:37], v[80:81]
    v_pk_add_f32 v[38:39], v[38:39], v[80:81]
    v_pk_add_f32 v[40:41], v[40:41], v[80:81]
    v_pk_add_f32 v[42:43], v[42:43], v[80:81]
    v_pk_add_f32 v[44:45], v[44:45], v[80:81]
    v_pk_add_f32 v[46:47], v[46:47], v[80:81]
    v_pk_mov_b32 v[82:83], v[80:81], v[80:81] op_sel:[0,1]
    v_pk_mov_b32 v[84:85], v[80:81], v[80:81] op_sel:[0,1]
    v_pk_mov_b32 v[86:87], v[80:81], v[80:81] op_sel:[0,1]
    v_pk_mov_b32 v[88:89], v[80:81], v[80:81] op_sel:[0,1]
    v_pk_mov_b32 v[90:91], v[80:81], v[80:81] op_sel:[0,1]
    v_pk_mov_b32 v[92:93], v[80:81], v[80:81] op_sel:[0,1]
    v_pk_mov_b32 v[94:95], v[80:81], v[80:81] op_sel:[0,1]
    v_exp_f32 v32, v32
    v_exp_f32 v33, v33
    v_exp_f32 v34, v34
    v_exp_f32 v35, v35
    v_exp_f32 v36, v36
    v_exp_f32 v37, v37
    v_exp_f32 v38, v38
    v_exp_f32 v39, v39
    v_exp_f32 v40, v40
    v_exp_f32 v41, v41
    v_exp_f32 v42, v42
    v_exp_f32 v43, v43
    v_exp_f32 v44, v44
    v_exp_f32 v45, v45
    v_exp_f32 v46, v46
    v_exp_f32 v47, v47
    v_cvt_pk_bf16_f32 v48, v32, v33
    v_cvt_pk_bf16_f32 v49, v34, v35
    v_cvt_pk_bf16_f32 v50, v36, v37
    v_cvt_pk_bf16_f32 v51, v38, v39
    v_cvt_pk_bf16_f32 v52, v40, v41
    v_cvt_pk_bf16_f32 v53, v42, v43
    v_cvt_pk_bf16_f32 v54, v44, v45
    v_cvt_pk_bf16_f32 v55, v46, v47
    s_lshl_b32 s50, s4, 2
    s_lshl_b32 s51, s3, 1
    s_add_u32 s50, s50, s51
    s_sub_i32 s50, s50, 8
    s_lshl_b32 s53, s3, 13
    s_add_u32 s53, s53, 86016
    s_cmp_lt_i32 s50, 0
    s_cbranch_scc1 A_fill_5
    s_lshl_b32 s48, s5, 6
    s_add_u32 s48, s48, s50
    s_lshl_b32 s52, s48, 2
    s_add_u32 s52, s52, 32768
    s_lshl_b32 s60, s48, 12
    s_add_u32 s60, s60, s37
    v_and_b32 v22, 1, v2
    v_lshlrev_b32 v22, 2, v22
    s_mov_b32 s47, 0
poll_7:
    buffer_load_dword v18, v22, s[8:11], s52 offen sc1
    s_add_u32 s47, s47, 1
    s_cmp_gt_u32 s47, 400000
    s_cbranch_scc1 polled_8
    s_waitcnt vmcnt(0)
    v_cmp_gt_u32 vcc, s44, v18
    s_nop 1
    s_cbranch_vccnz poll_7
polled_8:
    s_waitcnt vmcnt(0)
    s_add_u32 m0, s53, 0
    s_add_u32 s24, s60, 0
    buffer_load_dwordx4 v1, s[8:11], s24 offen offset:0 lds
    buffer_load_dwordx4 v1, s[8:11], s24 offen offset:1024 lds
    buffer_load_dwordx4 v1, s[8:11], s24 offen offset:2048 lds
    buffer_load_dwordx4 v1, s[8:11], s24 offen offset:3072 lds
    s_add_u32 m0, s53, 4096
    s_add_u32 s24, s60, 4096
    buffer_load_dwordx4 v1, s[8:11], s24 offen offset:0 lds
    buffer_load_dwordx4 v1, s[8:11], s24 offen offset:1024 lds
    buffer_load_dwordx4 v1, s[8:11], s24 offen offset:2048 lds
    buffer_load_dwordx4 v1, s[8:11], s24 offen offset:3072 lds
A_join_6:
    s_mov_b32 s62, s3
    s_waitcnt lgkmcnt(0)
    s_cmp_eq_u32 s62, 0
    s_cbranch_scc1 att1e_10
att1_9:
    s_nop 1
    v_mfma_f32_32x32x16_bf16 v[32:47], v[96:99], v[232:235], v[80:95]
    v_mfma_f32_32x32x16_bf16 v[32:47], v[100:103], v[236:239], v[32:47]
    v_mfma_f32_32x32x16_bf16 v[64:79], v[104:107], v[48:51], v[64:79]
    v_mfma_f32_32x32x16_bf16 v[64:79], v[108:111], v[52:55], v[64:79]
    ds_read_b128 v[104:107], v28 offset:2048
    ds_read_b128 v[108:111], v28 offset:3072
    v_subrev_u32 v28, 4096, v28
    ds_read_b128 v[96:99], v28
    ds_read_b128 v[100:103], v28 offset:1024
    s_nop 4
    v_exp_f32 v32, v32
    v_exp_f32 v33, v33
    v_exp_f32 v34, v34
    v_exp_f32 v35, v35
    v_cvt_pk_bf16_f32 v48, v32, v33
    v_exp_f32 v36, v36
    v_exp_f32 v37, v37
    v_cvt_pk_bf16_f32 v49, v34, v35
    v_exp_f32 v38, v38
    v_exp_f32 v39, v39
    v_cvt_pk_bf16_f32 v50, v36, v37
    v_exp_f32 v40, v40
    v_exp_f32 v41, v41
    v_cvt_pk_bf16_f32 v51, v38, v39
    v_exp_f32 v42, v42
    v_exp_f32 v43, v43
    v_cvt_pk_bf16_f32 v52, v40, v41
    v_exp_f32 v44, v44
    v_exp_f32 v45, v45
    v_cvt_pk_bf16_f32 v53, v42, v43
    v_exp_f32 v46, v46
    v_exp_f32 v47, v47
    v_cvt_pk_bf16_f32 v54, v44, v45
    v_cvt_pk_bf16_f32 v55, v46, v47
    s_sub_u32 s62, s62, 1
    s_cmp_lg_u32 s62, 0
    s_waitcnt lgkmcnt(0)
    s_cbranch_scc1 att1_9
att1e_10:
    s_mul_i32 s48, s5, 7
    s_add_u32 s49, s48, 6
    s_and_b32 s48, s48, -4
    s_or_b32 s49, s49, 3
    v_add_u32 v22, s48, v2
    v_min_u32 v22, s49, v22
    s_lshr_b32 s50, s54, 1
    s_lshl_b32 s48, s50, 3
    s_add_u32 s48, s48, 112
    v_and_b32 v23, 7, v2
    v_add_u32 v23, s48, v23
    v_cmp_le_u32 vcc, 16, v2
    s_lshl_b32 s48, s50, 1
    s_add_u32 s48, s48, 168
    v_cndmask_b32 v22, v22, v23, vcc
    v_and_b32 v23, 1, v2
    v_add_u32 v23, s48, v23
    v_cmp_le_u32 vcc, 24, v2
    v_bfe_u32 v24, v2, 1, 3
    v_and_b32 v25, 1, v2
    v_cndmask_b32 v22, v22, v23, vcc
    v_lshl_add_u32 v24, v25, 7, v24
    s_lshl_b32 s48, s5, 3
    v_add_u32 v24, s48, v24
    v_cndmask_b32 v22, v22, v24, s[96:97]
    v_lshlrev_b32 v22, 7, v22
    s_mov_b32 s48, 65536
    s_mov_b32 s47, 0
poll_13:
    buffer_load_dword v18, v22, s[8:11], s48 offen sc1
    s_add_u32 s47, s47, 1
    s_cmp_gt_u32 s47, 400000
    s_cbranch_scc1 polled_14
    s_waitcnt vmcnt(0)
    v_cmp_gt_u32 vcc, 1, v18
    s_nop 1
    s_cbranch_vccnz poll_13
polled_14:
    s_waitcnt vmcnt(0)
wready_12:
    s_waitcnt vmcnt(0)
    s_barrier
    ds_read_b128 v[96:99], v28
    ds_read_b128 v[100:103], v28 offset:1024
    s_sub_u32 s62, 7, s3
    s_add_u32 s50, s31, 0
    buffer_load_dwordx4 v[128:131], v1, s[8:11], s50 offen offset:0
    buffer_load_dwordx4 v[132:135], v1, s[8:11], s50 offen offset:1024
    buffer_load_dwordx4 v[136:139], v1, s[8:11], s50 offen offset:2048
    buffer_load_dwordx4 v[140:143], v1, s[8:11], s50 offen offset:3072
    s_add_u32 s50, s31, 4096
    buffer_load_dwordx4 v[144:147], v1, s[8:11], s50 offen offset:0
    buffer_load_dwordx4 v[148:151], v1, s[8:11], s50 offen offset:1024
    buffer_load_dwordx4 v[152:155], v1, s[8:11], s50 offen offset:2048
    buffer_load_dwordx4 v[156:159], v1, s[8:11], s50 offen offset:3072
    s_add_u32 s50, s32, 0
    buffer_load_dwordx4 v[160:163], v1, s[8:11], s50 offen offset:0
    buffer_load_dwordx4 v[164:167], v1, s[8:11], s50 offen offset:1024
    buffer_load_dwordx4 v[168:171], v1, s[8:11], s50 offen offset:2048
    buffer_load_dwordx4 v[172:175], v1, s[8:11], s50 offen offset:3072
    s_add_u32 s50, s32, 4096
    buffer_load_dwordx4 v[176:179], v1, s[8:11], s50 offen offset:0
    buffer_load_dwordx4 v[180:183], v1, s[8:11], s50 offen offset:1024
    buffer_load_dwordx4 v[184:187], v1, s[8:11], s50 offen offset:2048
    buffer_load_dwordx4 v[188:191], v1, s[8:11], s50 offen offset:3072
    v_lshlrev_b32 v22, 2, v3
    v_lshl_add_u32 v22, v4, 9, v22
    s_mul_i32 s48, s5, 7
    s_add_u32 s48, s48, s3
    s_lshl_b32 s48, s48, 7
    s_add_u32 s48, s48, 131072
    s_add_u32 s49, s48, 0
    buffer_load_dword v112, v22, s[8:11], s49 offen
    s_add_u32 s49, s48, 14336
    buffer_load_dword v113, v22, s[8:11], s49 offen
    s_add_u32 s49, s48, 28672
    buffer_load_dword v114, v22, s[8:11], s49 offen
    s_add_u32 s49, s48, 43008
    buffer_load_dword v115, v22, s[8:11], s49 offen
    s_waitcnt lgkmcnt(0)
att2_11:
    s_nop 1
    v_mfma_f32_32x32x16_bf16 v[32:47], v[96:99], v[232:235], v[80:95]
    v_mfma_f32_32x32x16_bf16 v[32:47], v[100:103], v[236:239], v[32:47]
    v_mfma_f32_32x32x16_bf16 v[64:79], v[104:107], v[48:51], v[64:79]
    v_mfma_f32_32x32x16_bf16 v[64:79], v[108:111], v[52:55], v[64:79]
    ds_read_b128 v[104:107], v28 offset:2048
    ds_read_b128 v[108:111], v28 offset:3072
    v_subrev_u32 v28, 4096, v28
    ds_read_b128 v[96:99], v28
    ds_read_b128 v[100:103], v28 offset:1024
    s_min_u32 m0, s63, 81920
    s_add_u32 s24, s0, m0
    buffer_load_dwordx4 v1, s[8:11], s24 offen offset:0 lds
    buffer_load_dwordx4 v1, s[8:11], s24 offen offset:1024 lds
    buffer_load_dwordx4 v1, s[8:11], s24 offen offset:2048 lds
    buffer_load_dwordx4 v1, s[8:11], s24 offen offset:3072 lds
    s_add_u32 s63, s63, 4096
    v_exp_f32 v32, v32
    v_exp_f32 v33, v33
    v_exp_f32 v34, v34
    v_exp_f32 v35, v35
    v_cvt_pk_bf16_f32 v48, v32, v33
    v_exp_f32 v36, v36
    v_exp_f32 v37, v37
    v_cvt_pk_bf16_f32 v49, v34, v35
    v_exp_f32 v38, v38
    v_exp_f32 v39, v39
    v_cvt_pk_bf16_f32 v50, v36, v37
    v_exp_f32 v40, v40
    v_exp_f32 v41, v41
    v_cvt_pk_bf16_f32 v51, v38, v39
    v_exp_f32 v42, v42
    v_exp_f32 v43, v43
    v_cvt_pk_bf16_f32 v52, v40, v41
    v_exp_f32 v44, v44
    v_exp_f32 v45, v45
    v_cvt_pk_bf16_f32 v53, v42, v43
    v_exp_f32 v46, v46
    v_exp_f32 v47, v47
    v_cvt_pk_bf16_f32 v54, v44, v45
    v_cvt_pk_bf16_f32 v55, v46, v47
    s_sub_u32 s62, s62, 1
    s_cmp_lg_u32 s62, 0
    s_waitcnt lgkmcnt(0)
    s_cbranch_scc1 att2_11
    s_nop 1
    v_mfma_f32_32x32x16_bf16 v[32:47], v[96:99], v[232:235], v[80:95]
    v_mfma_f32_32x32x16_bf16 v[32:47], v[100:103], v[236:239], v[32:47]
    v_mfma_f32_32x32x16_bf16 v[64:79], v[104:107], v[48:51], v[64:79]
    v_mfma_f32_32x32x16_bf16 v[64:79], v[108:111], v[52:55], v[64:79]
    ds_read_b128 v[104:107], v28 offset:2048
    ds_read_b128 v[108:111], v28 offset:3072
    v_subrev_u32 v28, 4096, v28
    s_nop 6
    v_cndmask_b32 v32, v32, v26, s[64:65]
    v_cndmask_b32 v33, v33, v26, s[66:67]
    v_cndmask_b32 v34, v34, v26, s[68:69]
    v_cndmask_b32 v35, v35, v26, s[70:71]
    v_cndmask_b32 v36, v36, v26, s[72:73]
    v_cndmask_b32 v37, v37, v26, s[74:75]
    v_cndmask_b32 v38, v38, v26, s[76:77]
    v_cndmask_b32 v39, v39, v26, s[78:79]
    v_cndmask_b32 v40, v40, v26, s[80:81]
    v_cndmask_b32 v41, v41, v26, s[82:83]
    v_cndmask_b32 v42, v42, v26, s[84:85]
    v_cndmask_b32 v43, v43, v26, s[86:87]
    v_cndmask_b32 v44, v44, v26, s[88:89]
    v_cndmask_b32 v45, v45, v26, s[90:91]
    v_cndmask_b32 v46, v46, v26, s[92:93]
    v_cndmask_b32 v47, v47, v26, s[94:95]
    v_exp_f32 v32, v32
    v_exp_f32 v33, v33
    v_exp_f32 v34, v34
    v_exp_f32 v35, v35
    v_cvt_pk_bf16_f32 v48, v32, v33
    v_exp_f32 v36, v36
    v_exp_f32 v37, v37
    v_cvt_pk_bf16_f32 v49, v34, v35
    v_exp_f32 v38, v38
    v_exp_f32 v39, v39
    v_cvt_pk_bf16_f32 v50, v36, v37
    v_exp_f32 v40, v40
    v_exp_f32 v41, v41
    v_cvt_pk_bf16_f32 v51, v38, v39
    v_exp_f32 v42, v42
    v_exp_f32 v43, v43
    v_cvt_pk_bf16_f32 v52, v40, v41
    v_exp_f32 v44, v44
    v_exp_f32 v45, v45
    v_cvt_pk_bf16_f32 v53, v42, v43
    v_exp_f32 v46, v46
    v_exp_f32 v47, v47
    v_cvt_pk_bf16_f32 v54, v44, v45
    v_cvt_pk_bf16_f32 v55, v46, v47
    s_waitcnt lgkmcnt(1)
    v_mfma_f32_32x32x16_bf16 v[64:79], v[104:107], v[48:51], v[64:79]
    s_waitcnt lgkmcnt(0)
    v_mfma_f32_32x32x16_bf16 v[64:79], v[108:111], v[52:55], v[64:79]
    s_lshl_b32 s52, s6, 7
    s_lshl_b32 s49, s5, 2
    s_add_u32 s52, s52, s49
    s_add_u32 s52, s52, 8192
    s_mov_b32 s48, 1602224128
    s_nop 6
    v_mov_b32 v22, v76
    v_mov_b32 v23, v76
    s_nop 1
    v_permlane32_swap_b32 v22, v23
    v_cmp_nge_f32 vcc, s48, v23
    s_nop 1
    s_cbranch_vccnz att_fb_16
att_ok_15:
    s_nop 1
    v_rcp_f32 v22, v23
    s_nop 0
    v_pk_mul_f32 v[64:65], v[64:65], v[22:23] op_sel_hi:[1,0]
    v_pk_mul_f32 v[66:67], v[66:67], v[22:23] op_sel_hi:[1,0]
    v_pk_mul_f32 v[68:69], v[68:69], v[22:23] op_sel_hi:[1,0]
    v_pk_mul_f32 v[70:71], v[70:71], v[22:23] op_sel_hi:[1,0]
    v_pk_mul_f32 v[72:73], v[72:73], v[22:23] op_sel_hi:[1,0]
    v_pk_mul_f32 v[74:75], v[74:75], v[22:23] op_sel_hi:[1,0]
    v_pk_mul_f32 v[76:77], v[76:77], v[22:23] op_sel_hi:[1,0]
    v_pk_mul_f32 v[78:79], v[78:79], v[22:23] op_sel_hi:[1,0]
    v_cvt_pk_bf16_f32 v64, v64, v65
    v_cvt_pk_bf16_f32 v65, v66, v67
    v_cvt_pk_bf16_f32 v66, v68, v69
    v_cvt_pk_bf16_f32 v67, v70, v71
    v_cvt_pk_bf16_f32 v68, v72, v73
    v_cvt_pk_bf16_f32 v69, v74, v75
    v_cvt_pk_bf16_f32 v70, v76, v77
    v_cvt_pk_bf16_f32 v71, v78, v79
    buffer_store_dwordx4 v[64:67], v1, s[8:11], s100 offen
    buffer_store_dwordx4 v[68:71], v1, s[8:11], s100 offen offset:1024
    v_mov_b32 v18, s44
    s_waitcnt vmcnt(0)
    s_mov_b64 exec, 1
    buffer_store_dword v18, v11, s[8:11], s52 offen
    s_mov_b64 exec, -1
    s_cmp_eq_u32 s46, 0
    s_cbranch_scc1 p3_skip_23
    v_mul_u32_u24 v22, 896, v3
    v_lshl_add_u32 v22, v4, 4, v22
    s_mul_i32 s48, s55, 28672
    s_lshl_b32 s49, s54, 6
    s_add_u32 s48, s48, s49
    buffer_load_dwordx4 v[96:99], v22, s[20:23], s48 offen
    buffer_load_dwordx4 v[100:103], v22, s[20:23], s48 offen offset:32
p3_res_26:
    s_and_b32 s52, s55, -2
    s_lshl_b32 s52, s52, 7
    s_add_u32 s52, s52, 8192
    s_lshl_b32 s49, s3, 19
    s_add_u32 s49, s49, s38
    s_lshl_b32 s50, s55, 11
    s_add_u32 s50, s50, s49
    s_lshl_b32 s51, s57, 11
    s_add_u32 s51, s51, s49
    s_mul_i32 s48, s3, 12288
    s_add_u32 s48, s48, 86016
    v_add_u32 v25, s48, v1
    s_lshl_b32 s60, s55, 7
    s_lshl_b32 s49, s54, 2
    s_add_u32 s60, s60, s49
    s_add_u32 s60, s60, 16384
    s_barrier
    s_waitcnt vmcnt(1)
    v_lshlrev_b32 v32, 16, v96
    v_and_b32 v33, 0xffff0000, v96
    v_lshlrev_b32 v34, 16, v97
    v_and_b32 v35, 0xffff0000, v97
    v_lshlrev_b32 v36, 16, v98
    v_and_b32 v37, 0xffff0000, v98
    v_lshlrev_b32 v38, 16, v99
    v_and_b32 v39, 0xffff0000, v99
    s_waitcnt vmcnt(0)
    v_lshlrev_b32 v40, 16, v100
    v_and_b32 v41, 0xffff0000, v100
    v_lshlrev_b32 v42, 16, v101
    v_and_b32 v43, 0xffff0000, v101
    v_lshlrev_b32 v44, 16, v102
    v_and_b32 v45, 0xffff0000, v102
    v_lshlrev_b32 v46, 16, v103
    v_and_b32 v47, 0xffff0000, v103
    s_mov_b32 s47, 0
poll_27:
    buffer_load_dword v18, v10, s[8:11], s52 offen sc1
    s_add_u32 s47, s47, 1
    s_cmp_gt_u32 s47, 400000
    s_cbranch_scc1 polled_28
    s_waitcnt vmcnt(0)
    v_cmp_gt_u32 vcc, s44, v18
    s_nop 1
    s_cbranch_vccnz poll_27
polled_28:
    s_waitcnt vmcnt(0)
    buffer_load_dwordx4 v[224:227], v1, s[8:11], s51 offen offset:0 sc1
    buffer_load_dwordx4 v[228:231], v1, s[8:11], s51 offen offset:1024 sc1
    s_add_u32 s51, s51, 131072
    buffer_load_dwordx4 v[232:235], v1, s[8:11], s51 offen offset:0 sc1
    buffer_load_dwordx4 v[236:239], v1, s[8:11], s51 offen offset:1024 sc1
    s_add_u32 s51, s51, 131072
    buffer_load_dwordx4 v[240:243], v1, s[8:11], s51 offen offset:0 sc1
    buffer_load_dwordx4 v[244:247], v1, s[8:11], s51 offen offset:1024 sc1
    s_add_u32 s51, s51, 131072
    buffer_load_dwordx4 v[248:251], v1, s[8:11], s51 offen offset:0 sc1
    buffer_load_dwordx4 v[252:255], v1, s[8:11], s51 offen offset:1024 sc1
    buffer_load_dwordx4 v[192:195], v1, s[8:11], s50 offen offset:0 sc1
    buffer_load_dwordx4 v[196:199], v1, s[8:11], s50 offen offset:1024 sc1
    s_add_u32 s50, s50, 131072
    buffer_load_dwordx4 v[200:203], v1, s[8:11], s50 offen offset:0 sc1
    buffer_load_dwordx4 v[204:207], v1, s[8:11], s50 offen offset:1024 sc1
    s_add_u32 s50, s50, 131072
    buffer_load_dwordx4 v[208:211], v1, s[8:11], s50 offen offset:0 sc1
    buffer_load_dwordx4 v[212:215], v1, s[8:11], s50 offen offset:1024 sc1
    s_add_u32 s50, s50, 131072
    buffer_load_dwordx4 v[216:219], v1, s[8:11], s50 offen offset:0 sc1
    buffer_load_dwordx4 v[220:223], v1, s[8:11], s50 offen offset:1024 sc1
    s_waitcnt vmcnt(15)
    v_mfma_f32_32x32x16_bf16 v[64:79], v[128:131], v[224:227], 0
    v_mfma_f32_32x32x16_bf16 v[80:95], v[160:163], v[224:227], 0
    s_waitcnt vmcnt(14)
    v_mfma_f32_32x32x16_bf16 v[64:79], v[132:135], v[228:231], v[64:79]
    s_add_u32 s63, s29, 0
    buffer_load_dwordx4 a[0:3], v1, s[8:11], s63 offen offset:0
    buffer_load_dwordx4 a[4:7], v1, s[8:11], s63 offen offset:1024
    buffer_load_dwordx4 a[8:11], v1, s[8:11], s63 offen offset:2048
    buffer_load_dwordx4 a[12:15], v1, s[8:11], s63 offen offset:3072
    v_mfma_f32_32x32x16_bf16 v[80:95], v[164:167], v[228:231], v[80:95]
    s_add_u32 s63, s29, 4096
    buffer_load_dwordx4 a[16:19], v1, s[8:11], s63 offen offset:0
    buffer_load_dwordx4 a[20:23], v1, s[8:11], s63 offen offset:1024
    buffer_load_dwordx4 a[24:27], v1, s[8:11], s63 offen offset:2048
    buffer_load_dwordx4 a[28:31], v1, s[8:11], s63 offen offset:3072
    s_waitcnt vmcnt(21)
    v_mfma_f32_32x32x16_bf16 v[64:79], v[136:139], v[232:235], v[64:79]
    s_add_u32 s63, s29, 8192
    buffer_load_dwordx4 a[32:35], v1, s[8:11], s63 offen offset:0
    buffer_load_dwordx4 a[36:39], v1, s[8:11], s63 offen offset:1024
    buffer_load_dwordx4 a[40:43], v1, s[8:11], s63 offen offset:2048
    buffer_load_dwordx4 a[44:47], v1, s[8:11], s63 offen offset:3072
    v_mfma_f32_32x32x16_bf16 v[80:95], v[168:171], v[232:235], v[80:95]
    s_add_u32 s63, s29, 12288
    buffer_load_dwordx4 a[48:51], v1, s[8:11], s63 offen offset:0
    buffer_load_dwordx4 a[52:55], v1, s[8:11], s63 offen offset:1024
    buffer_load_dwordx4 a[56:59], v1, s[8:11], s63 offen offset:2048
    buffer_load_dwordx4 a[60:63], v1, s[8:11], s63 offen offset:3072
    s_waitcnt vmcnt(28)
    v_mfma_f32_32x32x16_bf16 v[64:79], v[140:143], v[236:239], v[64:79]
    s_add_u32 s63, s29, 16384
    buffer_load_dwordx4 a[64:67], v1, s[8:11], s63 offen offset:0
    buffer_load_dwordx4 a[68:71], v1, s[8:11], s63 offen offset:1024
    buffer_load_dwordx4 a[72:75], v1, s[8:11], s63 offen offset:2048
    buffer_load_dwordx4 a[76:79], v1, s[8:11], s63 offen offset:3072
    v_mfma_f32_32x32x16_bf16 v[80:95], v[172:175], v[236:239], v[80:95]
    s_add_u32 s63, s29, 20480
    buffer_load_dwordx4 a[80:83], v1, s[8:11], s63 offen offset:0
    buffer_load_dwordx4 a[84:87], v1, s[8:11], s63 offen offset:1024
    buffer_load_dwordx4 a[88:91], v1, s[8:11], s63 offen offset:2048
    buffer_load_dwordx4 a[92:95], v1, s[8:11], s63 offen offset:3072
    s_waitcnt vmcnt(35)
    v_mfma_f32_32x32x16_bf16 v[64:79], v[144:147], v[240:243], v[64:79]
    v_mfma_f32_32x32x16_bf16 v[80:95], v[176:179], v[240:243], v[80:95]
    s_waitcnt vmcnt(34)
    v_mfma_f32_32x32x16_bf16 v[64:79], v[148:151], v[244:247], v[64:79]
    v_mfma_f32_32x32x16_bf16 v[80:95], v[180:183], v[244:247], v[80:95]
    s_waitcnt vmcnt(33)
    v_mfma_f32_32x32x16_bf16 v[64:79], v[152:155], v[248:251], v[64:79]
    v_mfma_f32_32x32x16_bf16 v[80:95], v[184:187], v[248:251], v[80:95]
    s_waitcnt vmcnt(32)
    v_mfma_f32_32x32x16_bf16 v[64:79], v[156:159], v[252:255], v[64:79]
    v_mfma_f32_32x32x16_bf16 v[80:95], v[188:191], v[252:255], v[80:95]
    s_waitcnt vmcnt(31)
    v_mfma_f32_32x32x16_bf16 v[48:63], v[160:163], v[192:195], 0
    s_waitcnt vmcnt(30)
    v_mfma_f32_32x32x16_bf16 v[48:63], v[164:167], v[196:199], v[48:63]
    s_waitcnt vmcnt(29)
    v_mfma_f32_32x32x16_bf16 v[48:63], v[168:171], v[200:203], v[48:63]
    s_xor_b32 s48, s3, 2
    s_mul_i32 s48, s48, 12288
    s_add_u32 s48, s48, 90112
    v_add_u32 v23, s48, v1
    s_nop 0
    ds_write_b128 v23, v[64:67] offset:0
    s_waitcnt vmcnt(28)
    v_mfma_f32_32x32x16_bf16 v[48:63], v[172:175], v[204:207], v[48:63]
    ds_write_b128 v23, v[68:71] offset:1024
    ds_write_b128 v23, v[72:75] offset:2048
    ds_write_b128 v23, v[76:79] offset:3072
    s_waitcnt vmcnt(27)
    v_mfma_f32_32x32x16_bf16 v[48:63], v[176:179], v[208:211], v[48:63]
    s_xor_b32 s48, s3, 3
    s_mul_i32 s48, s48, 12288
    s_add_u32 s48, s48, 94208
    v_add_u32 v24, s48, v1
    ds_write_b128 v24, v[80:83] offset:0
    s_waitcnt vmcnt(26)
    v_mfma_f32_32x32x16_bf16 v[48:63], v[180:183], v[212:215], v[48:63]
    ds_write_b128 v24, v[84:87] offset:1024
    ds_write_b128 v24, v[88:91] offset:2048
    ds_write_b128 v24, v[92:95] offset:3072
    s_waitcnt vmcnt(25)
    v_mfma_f32_32x32x16_bf16 v[48:63], v[184:187], v[216:219], v[48:63]
    s_waitcnt vmcnt(24)
    v_mfma_f32_32x32x16_bf16 v[48:63], v[188:191], v[220:223], v[48:63]
    v_mfma_f32_32x32x16_bf16 v[32:47], v[128:131], v[192:195], v[32:47]
    v_mfma_f32_32x32x16_bf16 v[32:47], v[132:135], v[196:199], v[32:47]
    v_mfma_f32_32x32x16_bf16 v[32:47], v[136:139], v[200:203], v[32:47]
    s_xor_b32 s48, s3, 1
    s_mul_i32 s48, s48, 12288
    s_add_u32 s48, s48, 86016
    v_add_u32 v22, s48, v1
    s_nop 4
    ds_write_b128 v22, v[48:51] offset:0
    v_mfma_f32_32x32x16_bf16 v[32:47], v[140:143], v[204:207], v[32:47]
    ds_write_b128 v22, v[52:55] offset:1024
    ds_write_b128 v22, v[56:59] offset:2048
    ds_write_b128 v22, v[60:63] offset:3072
    v_mfma_f32_32x32x16_bf16 v[32:47], v[144:147], v[208:211], v[32:47]
    v_mfma_f32_32x32x16_bf16 v[32:47], v[148:151], v[212:215], v[32:47]
    v_mfma_f32_32x32x16_bf16 v[32:47], v[152:155], v[216:219], v[32:47]
    v_mfma_f32_32x32x16_bf16 v[32:47], v[156:159], v[220:223], v[32:47]
    s_waitcnt lgkmcnt(0)
    s_barrier
    ds_read_b128 v[48:51], v25 offset:0
    ds_read_b128 v[64:67], v25 offset:4096
    ds_read_b128 v[80:83], v25 offset:8192
    ds_read_b128 v[52:55], v25 offset:1024
    ds_read_b128 v[68:71], v25 offset:5120
    ds_read_b128 v[84:87], v25 offset:9216
    ds_read_b128 v[56:59], v25 offset:2048
    ds_read_b128 v[72:75], v25 offset:6144
    ds_read_b128 v[88:91], v25 offset:10240
    ds_read_b128 v[60:63], v25 offset:3072
    ds_read_b128 v[76:79], v25 offset:7168
    ds_read_b128 v[92:95], v25 offset:11264
    s_waitcnt lgkmcnt(9)
    v_pk_add_f32 v[48:49], v[48:49], v[64:65]
    v_pk_add_f32 v[32:33], v[32:33], v[80:81]
    v_pk_add_f32 v[50:51], v[50:51], v[66:67]
    v_pk_add_f32 v[34:35], v[34:35], v[82:83]
    v_pk_add_f32 v[32:33], v[32:33], v[48:49]
    v_pk_add_f32 v[34:35], v[34:35], v[50:51]
    v_cvt_pk_bf16_f32 v96, v32, v33
    v_cvt_pk_bf16_f32 v97, v34, v35
    s_waitcnt lgkmcnt(6)
    v_pk_add_f32 v[52:53], v[52:53], v[68:69]
    v_pk_add_f32 v[36:37], v[36:37], v[84:85]
    v_pk_add_f32 v[54:55], v[54:55], v[70:71]
    v_pk_add_f32 v[38:39], v[38:39], v[86:87]
    v_pk_add_f32 v[36:37], v[36:37], v[52:53]
    v_pk_add_f32 v[38:39], v[38:39], v[54:55]
    v_cvt_pk_bf16_f32 v98, v36, v37
    v_cvt_pk_bf16_f32 v99, v38, v39
    buffer_store_dwordx4 v[96:99], v1, s[8:11], s101 offen
    s_waitcnt lgkmcnt(3)
    v_pk_add_f32 v[56:57], v[56:57], v[72:73]
    v_pk_add_f32 v[40:41], v[40:41], v[88:89]
    v_pk_add_f32 v[58:59], v[58:59], v[74:75]
    v_pk_add_f32 v[42:43], v[42:43], v[90:91]
    v_pk_add_f32 v[40:41], v[40:41], v[56:57]
    v_pk_add_f32 v[42:43], v[42:43], v[58:59]
    v_cvt_pk_bf16_f32 v100, v40, v41
    v_cvt_pk_bf16_f32 v101, v42, v43
    s_waitcnt lgkmcnt(0)
    v_pk_add_f32 v[60:61], v[60:61], v[76:77]
    v_pk_add_f32 v[44:45], v[44:45], v[92:93]
    v_pk_add_f32 v[62:63], v[62:63], v[78:79]
    v_pk_add_f32 v[46:47], v[46:47], v[94:95]
    v_pk_add_f32 v[44:45], v[44:45], v[60:61]
    v_pk_add_f32 v[46:47], v[46:47], v[62:63]
    v_cvt_pk_bf16_f32 v102, v44, v45
    v_cvt_pk_bf16_f32 v103, v46, v47
    buffer_store_dwordx4 v[100:103], v1, s[8:11], s101 offen offset:1024
    v_mov_b32 v22, 0
    v_mov_b32 v23, 0
    v_dot2_f32_bf16 v22, v96, v8, v22
    v_dot2_f32_bf16 v23, v96, v96, v23
    v_dot2_f32_bf16 v22, v97, v8, v22
    v_dot2_f32_bf16 v23, v97, v97, v23
    v_dot2_f32_bf16 v22, v98, v8, v22
    v_dot2_f32_bf16 v23, v98, v98, v23
    v_dot2_f32_bf16 v22, v99, v8, v22
    v_dot2_f32_bf16 v23, v99, v99, v23
    v_dot2_f32_bf16 v22, v100, v8, v22
    v_dot2_f32_bf16 v23, v100, v100, v23
    v_dot2_f32_bf16 v22, v101, v8, v22
    v_dot2_f32_bf16 v23, v101, v101, v23
    v_dot2_f32_bf16 v22, v102, v8, v22
    v_dot2_f32_bf16 v23, v102, v102, v23
    v_dot2_f32_bf16 v22, v103, v8, v22
    v_dot2_f32_bf16 v23, v103, v103, v23
    s_nop 2
    v_permlane32_swap_b32 v22, v23
    v_add_f32 v22, v22, v23
    buffer_store_dword v22, v5, s[8:11], s1 offen
    v_mov_b32 v18, s44
    s_waitcnt vmcnt(0)
    s_mov_b64 exec, 1
    buffer_store_dword v18, v11, s[8:11], s60 offen
    s_mov_b64 exec, -1
p3_join_24:
    s_lshl_b32 s52, s6, 7
    s_add_u32 s52, s52, 16384
    s_mul_i32 s51, s6, 28672
    s_add_u32 s51, s51, s39
    s_waitcnt vmcnt(0)
    v_add_f32 v112, v112, v113
    v_add_f32 v114, v114, v115
    v_add_f32 v112, v112, v114
    v_cvt_pk_bf16_f32 v23, v112, v112
    v_and_b32 v23, 0xffff0000, v23
    v_sub_f32 v112, v112, v23
    v_cvt_pk_bf16_f32 v24, v112, v112
    v_and_b32 v24, 0xffff0000, v24
    v_sub_f32 v112, v112, v24
    v_lshrrev_b32 v23, 16, v23
    v_or_b32 v116, v23, v24
    v_cvt_pk_bf16_f32 v117, v112, 0
    v_mov_b32 v118, 0
    v_mov_b32 v119, 0
    v_mov_b32 v120, 0
    v_mov_b32 v121, 0
    v_mov_b32 v122, 0
    v_mov_b32 v123, 0
    s_lshl_b32 s48, s3, 10
    s_add_u32 s48, s48, 144384
    v_lshlrev_b32 v22, 4, v3
    v_lshl_add_u32 v22, v4, 12, v22
    v_add_u32 v22, s48, v22
    ds_write_b128 v22, v[116:119]
    ds_write_b128 v22, v[120:123] offset:512
    s_waitcnt lgkmcnt(0)
    s_barrier
    ds_read_b128 v[192:195], v1 offset:0
    ds_read_b128 v[196:199], v1 offset:28672
    ds_read_b128 v[200:203], v1 offset:1024
    ds_read_b128 v[204:207], v1 offset:29696
    ds_read_b128 v[208:211], v1 offset:2048
    ds_read_b128 v[212:215], v1 offset:30720
    s_mov_b32 s47, 0
poll_29:
    buffer_load_dword v18, v9, s[8:11], s52 offen sc1
    s_add_u32 s47, s47, 1
    s_cmp_gt_u32 s47, 400000
    s_cbranch_scc1 polled_30
    s_waitcnt vmcnt(0)
    v_cmp_gt_u32 vcc, s44, v18
    s_nop 1
    s_cbranch_vccnz poll_29
polled_30:
    s_waitcnt vmcnt(0)
    s_add_u32 s50, s51, 0
    buffer_load_dwordx4 v[32:35], v1, s[8:11], s50 offen offset:0 sc1
    buffer_load_dwordx4 v[36:39], v1, s[8:11], s50 offen offset:1024 sc1
    buffer_load_dwordx4 v[40:43], v1, s[8:11], s50 offen offset:2048 sc1
    buffer_load_dwordx4 v[44:47], v1, s[8:11], s50 offen offset:3072 sc1
    s_mul_i32 s48, s6, 3584
    s_add_u32 s48, s48, s40
    buffer_load_dwordx2 v[224:225], v6, s[8:11], s48 offen offset:0 sc1
    buffer_load_dwordx2 v[226:227], v6, s[8:11], s48 offen offset:256 sc1
    buffer_load_dwordx2 v[228:229], v6, s[8:11], s48 offen offset:512 sc1
    buffer_load_dwordx2 v[230:231], v6, s[8:11], s48 offen offset:768 sc1
    buffer_load_dwordx2 v[232:233], v6, s[8:11], s48 offen offset:1024 sc1
    buffer_load_dwordx2 v[234:235], v6, s[8:11], s48 offen offset:1280 sc1
    buffer_load_dwordx2 v[236:237], v6, s[8:11], s48 offen offset:1536 sc1
    s_add_u32 s50, s51, 4096
    buffer_load_dwordx4 v[48:51], v1, s[8:11], s50 offen offset:0 sc1
    buffer_load_dwordx4 v[52:55], v1, s[8:11], s50 offen offset:1024 sc1
    buffer_load_dwordx4 v[56:59], v1, s[8:11], s50 offen offset:2048 sc1
    buffer_load_dwordx4 v[60:63], v1, s[8:11], s50 offen offset:3072 sc1
    s_add_u32 s50, s51, 8192
    buffer_load_dwordx4 v[64:67], v1, s[8:11], s50 offen offset:0 sc1
    buffer_load_dwordx4 v[68:71], v1, s[8:11], s50 offen offset:1024 sc1
    ds_read_b128 v[216:219], v1 offset:3072
    buffer_load_dwordx4 v[72:75], v1, s[8:11], s50 offen offset:2048 sc1
    s_waitcnt lgkmcnt(5)
    s_waitcnt vmcnt(17)
    v_mfma_f32_32x32x16_bf16 v[144:159], v[192:195], v[32:35], 0
    ds_read_b128 v[220:223], v1 offset:31744
    v_mfma_f32_32x32x16_bf16 v[160:175], v[196:199], v[32:35], 0
    ds_read_b128 v[192:195], v1 offset:4096
    buffer_load_dwordx4 v[76:79], v1, s[8:11], s50 offen offset:3072 sc1
    s_waitcnt lgkmcnt(5)
    s_waitcnt vmcnt(17)
    v_mfma_f32_32x32x16_bf16 v[144:159], v[200:203], v[36:39], v[144:159]
    ds_read_b128 v[196:199], v1 offset:32768
    v_mfma_f32_32x32x16_bf16 v[160:175], v[204:207], v[36:39], v[160:175]
    ds_read_b128 v[200:203], v1 offset:5120
    s_add_u32 s50, s51, 12288
    buffer_load_dwordx4 v[80:83], v1, s[8:11], s50 offen offset:0 sc1
    s_waitcnt lgkmcnt(5)
    s_waitcnt vmcnt(17)
    v_mfma_f32_32x32x16_bf16 v[144:159], v[208:211], v[40:43], v[144:159]
    ds_read_b128 v[204:207], v1 offset:33792
    v_mfma_f32_32x32x16_bf16 v[160:175], v[212:215], v[40:43], v[160:175]
    ds_read_b128 v[208:211], v1 offset:6144
    buffer_load_dwordx4 v[84:87], v1, s[8:11], s50 offen offset:1024 sc1
    s_waitcnt lgkmcnt(5)
    s_waitcnt vmcnt(17)
    v_mfma_f32_32x32x16_bf16 v[144:159], v[216:219], v[44:47], v[144:159]
    s_waitcnt vmcnt(15)
    v_add_f32 v224, v224, v226
    v_add_f32 v225, v225, v227
    s_waitcnt vmcnt(14)
    v_add_f32 v224, v224, v228
    ds_read_b128 v[212:215], v1 offset:34816
    v_mfma_f32_32x32x16_bf16 v[160:175], v[220:223], v[44:47], v[160:175]
    v_add_f32 v225, v225, v229
    s_waitcnt vmcnt(13)
    v_add_f32 v224, v224, v230
    ds_read_b128 v[216:219], v1 offset:7168
    buffer_load_dwordx4 v[88:91], v1, s[8:11], s50 offen offset:2048 sc1
    s_waitcnt lgkmcnt(5)
    s_waitcnt vmcnt(10)
    v_mfma_f32_32x32x16_bf16 v[144:159], v[192:195], v[48:51], v[144:159]
    v_add_f32 v225, v225, v231
    v_add_f32 v224, v224, v232
    v_add_f32 v225, v225, v233
    v_add_f32 v224, v224, v234
    v_add_f32 v225, v225, v235
    ds_read_b128 v[220:223], v1 offset:35840
    v_mfma_f32_32x32x16_bf16 v[160:175], v[196:199], v[48:51], v[160:175]
    v_add_f32 v224, v224, v236
    v_add_f32 v225, v225, v237
    ds_read_b128 v[192:195], v1 offset:8192
    buffer_load_dwordx4 v[92:95], v1, s[8:11], s50 offen offset:3072 sc1
    s_waitcnt lgkmcnt(5)
    s_waitcnt vmcnt(10)
    v_mfma_f32_32x32x16_bf16 v[144:159], v[200:203], v[52:55], v[144:159]
    v_mov_b32 v22, v224
    v_mov_b32 v23, v225
    s_nop 0
    v_permlane32_swap_b32 v224, v22
    v_permlane32_swap_b32 v225, v23
    ds_read_b128 v[196:199], v1 offset:36864
    v_mfma_f32_32x32x16_bf16 v[160:175], v[204:207], v[52:55], v[160:175]
    v_add_f32 v224, v224, v22
    ds_read_b128 v[200:203], v1 offset:9216
    s_add_u32 s50, s51, 16384
    buffer_load_dwordx4 v[96:99], v1, s[8:11], s50 offen offset:0 sc1
    s_waitcnt lgkmcnt(5)
    s_waitcnt vmcnt(10)
    v_mfma_f32_32x32x16_bf16 v[144:159], v[208:211], v[56:59], v[144:159]
    v_add_f32 v225, v225, v23
    v_mul_f32 v224, 3138537765, v224
    v_mul_f32 v225, 991054117, v225
    v_fma_f32 v225, -v224, v224, v225
    v_max_f32 v225, 0, v225
    ds_read_b128 v[204:207], v1 offset:37888
    v_mfma_f32_32x32x16_bf16 v[160:175], v[212:215], v[56:59], v[160:175]
    v_cvt_pk_bf16_f32 v20, v224, v224
    v_cvt_pk_bf16_f32 v23, v225, v225
    ds_read_b128 v[208:211], v1 offset:10240
    buffer_load_dwordx4 v[100:103], v1, s[8:11], s50 offen offset:1024 sc1
    s_waitcnt lgkmcnt(5)
    s_waitcnt vmcnt(10)
    v_mfma_f32_32x32x16_bf16 v[144:159], v[216:219], v[60:63], v[144:159]
    v_and_b32 v23, 0xffff0000, v23
    v_add_f32 v23, 925353388, v23
    v_cvt_pk_bf16_f32 v23, v23, v23
    v_and_b32 v23, 0xffff0000, v23
    ds_read_b128 v[212:215], v1 offset:38912
    v_mfma_f32_32x32x16_bf16 v[160:175], v[220:223], v[60:63], v[160:175]
    v_sqrt_f32 v23, v23
    ds_read_b128 v[216:219], v1 offset:11264
    buffer_load_dwordx4 v[104:107], v1, s[8:11], s50 offen offset:2048 sc1
    s_waitcnt lgkmcnt(5)
    s_waitcnt vmcnt(10)
    v_mfma_f32_32x32x16_bf16 v[144:159], v[192:195], v[64:67], v[144:159]
    v_cvt_pk_bf16_f32 v23, v23, v23
    v_and_b32 v23, 0xffff0000, v23
    v_rcp_f32 v21, v23
    v_mov_b32 v28, v20
    ds_read_b128 v[220:223], v1 offset:39936
    v_mfma_f32_32x32x16_bf16 v[160:175], v[196:199], v[64:67], v[160:175]
    v_mov_b32 v29, v20
    v_mov_b32 v30, v20
    ds_read_b128 v[192:195], v1 offset:12288
    buffer_load_dwordx4 v[108:111], v1, s[8:11], s50 offen offset:3072 sc1
    s_waitcnt lgkmcnt(5)
    s_waitcnt vmcnt(10)
    v_mfma_f32_32x32x16_bf16 v[144:159], v[200:203], v[68:71], v[144:159]
    v_mov_b32 v31, v20
    v_mul_f32 v17, 3216550459, v21
    s_lshl_b32 s33, s6, 7
    s_lshl_b32 s49, s5, 2
    s_add_u32 s33, s33, s49
    ds_read_b128 v[196:199], v1 offset:40960
    v_mfma_f32_32x32x16_bf16 v[160:175], v[204:207], v[68:71], v[160:175]
    s_add_u32 s33, s33, 24576
    ds_read_b128 v[200:203], v1 offset:13312
    s_add_u32 s50, s51, 20480
    buffer_load_dwordx4 v[112:115], v1, s[8:11], s50 offen offset:0 sc1
    s_waitcnt lgkmcnt(5)
    s_waitcnt vmcnt(10)
    v_mfma_f32_32x32x16_bf16 v[144:159], v[208:211], v[72:75], v[144:159]
    s_and_b32 s34, s55, -2
    s_lshl_b32 s34, s34, 7
    s_add_u32 s34, s34, 24576
    s_mul_i32 s49, s3, 28672
    s_add_u32 s49, s49, s41
    ds_read_b128 v[204:207], v1 offset:41984
    v_mfma_f32_32x32x16_bf16 v[160:175], v[212:215], v[72:75], v[160:175]
    s_mul_i32 s35, s55, 114688
    s_add_u32 s35, s35, s49
    ds_read_b128 v[208:211], v1 offset:14336
    buffer_load_dwordx4 v[116:119], v1, s[8:11], s50 offen offset:1024 sc1
    s_waitcnt lgkmcnt(5)
    s_waitcnt vmcnt(10)
    v_mfma_f32_32x32x16_bf16 v[144:159], v[216:219], v[76:79], v[144:159]
    s_mul_i32 s36, s57, 114688
    s_add_u32 s36, s36, s49
    ds_read_b128 v[212:215], v1 offset:43008
    v_mfma_f32_32x32x16_bf16 v[160:175], v[220:223], v[76:79], v[160:175]
    ds_read_b128 v[216:219], v1 offset:15360
    buffer_load_dwordx4 v[120:123], v1, s[8:11], s50 offen offset:2048 sc1
    s_waitcnt lgkmcnt(5)
    s_waitcnt vmcnt(10)
    v_mfma_f32_32x32x16_bf16 v[144:159], v[192:195], v[80:83], v[144:159]
    s_mul_i32 s101, s55, 28
    s_lshl_b32 s49, s54, 1
    s_add_u32 s101, s101, s49
    s_lshl_b32 s101, s101, 10
    s_add_u32 s101, s101, s42
    s_mul_i32 s1, s55, 14
    s_add_u32 s1, s1, s54
    s_lshl_b32 s1, s1, 8
    s_add_u32 s1, s1, s43
    ds_read_b128 v[220:223], v1 offset:44032
    v_mfma_f32_32x32x16_bf16 v[160:175], v[196:199], v[80:83], v[160:175]
    ds_read_b128 v[192:195], v1 offset:16384
    buffer_load_dwordx4 v[124:127], v1, s[8:11], s50 offen offset:3072 sc1
    s_waitcnt lgkmcnt(5)
    s_waitcnt vmcnt(10)
    v_mfma_f32_32x32x16_bf16 v[144:159], v[200:203], v[84:87], v[144:159]
    ds_read_b128 v[196:199], v1 offset:45056
    v_mfma_f32_32x32x16_bf16 v[160:175], v[204:207], v[84:87], v[160:175]
    ds_read_b128 v[200:203], v1 offset:17408
    s_add_u32 s50, s51, 24576
    buffer_load_dwordx4 v[128:131], v1, s[8:11], s50 offen offset:0 sc1
    s_waitcnt lgkmcnt(5)
    s_waitcnt vmcnt(10)
    v_mfma_f32_32x32x16_bf16 v[144:159], v[208:211], v[88:91], v[144:159]
    ds_read_b128 v[204:207], v1 offset:46080
    v_mfma_f32_32x32x16_bf16 v[160:175], v[212:215], v[88:91], v[160:175]
    ds_read_b128 v[208:211], v1 offset:18432
    buffer_load_dwordx4 v[132:135], v1, s[8:11], s50 offen offset:1024 sc1
    s_waitcnt lgkmcnt(5)
    s_waitcnt vmcnt(10)
    v_mfma_f32_32x32x16_bf16 v[144:159], v[216:219], v[92:95], v[144:159]
    ds_read_b128 v[212:215], v1 offset:47104
    v_mfma_f32_32x32x16_bf16 v[160:175], v[220:223], v[92:95], v[160:175]
    ds_read_b128 v[216:219], v1 offset:19456
    buffer_load_dwordx4 v[136:139], v1, s[8:11], s50 offen offset:2048 sc1
    s_waitcnt lgkmcnt(5)
    s_waitcnt vmcnt(10)
    v_mfma_f32_32x32x16_bf16 v[144:159], v[192:195], v[96:99], v[144:159]
    ds_read_b128 v[220:223], v1 offset:48128
    v_mfma_f32_32x32x16_bf16 v[160:175], v[196:199], v[96:99], v[160:175]
    ds_read_b128 v[192:195], v1 offset:20480
    buffer_load_dwordx4 v[140:143], v1, s[8:11], s50 offen offset:3072 sc1
    s_waitcnt lgkmcnt(5)
    s_waitcnt vmcnt(10)
    v_mfma_f32_32x32x16_bf16 v[144:159], v[200:203], v[100:103], v[144:159]
    ds_read_b128 v[196:199], v1 offset:49152
    v_mfma_f32_32x32x16_bf16 v[160:175], v[204:207], v[100:103], v[160:175]
    ds_read_b128 v[200:203], v1 offset:21504
    s_waitcnt lgkmcnt(5)
    s_waitcnt vmcnt(9)
    v_mfma_f32_32x32x16_bf16 v[144:159], v[208:211], v[104:107], v[144:159]
    s_add_u32 m0, s26, 86016
    s_add_u32 s24, s25, 86016
    buffer_load_dwordx4 v1, s[8:11], s24 offen offset:0 lds
    ds_read_b128 v[204:207], v1 offset:50176
    v_mfma_f32_32x32x16_bf16 v[160:175], v[212:215], v[104:107], v[160:175]
    buffer_load_dwordx4 v1, s[8:11], s24 offen offset:1024 lds
    ds_read_b128 v[208:211], v1 offset:22528
    s_waitcnt lgkmcnt(5)
    s_waitcnt vmcnt(10)
    v_mfma_f32_32x32x16_bf16 v[144:159], v[216:219], v[108:111], v[144:159]
    ds_read_b128 v[212:215], v1 offset:51200
    v_mfma_f32_32x32x16_bf16 v[160:175], v[220:223], v[108:111], v[160:175]
    buffer_load_dwordx4 v1, s[8:11], s24 offen offset:2048 lds
    ds_read_b128 v[216:219], v1 offset:23552
    s_waitcnt lgkmcnt(5)
    s_waitcnt vmcnt(10)
    v_mfma_f32_32x32x16_bf16 v[144:159], v[192:195], v[112:115], v[144:159]
    buffer_load_dwordx4 v1, s[8:11], s24 offen offset:3072 lds
    ds_read_b128 v[220:223], v1 offset:52224
    v_mfma_f32_32x32x16_bf16 v[160:175], v[196:199], v[112:115], v[160:175]
    ds_read_b128 v[192:195], v1 offset:24576
    s_waitcnt lgkmcnt(5)
    s_waitcnt vmcnt(10)
    v_mfma_f32_32x32x16_bf16 v[144:159], v[200:203], v[116:119], v[144:159]
    s_add_u32 m0, s26, 90112
    s_add_u32 s24, s25, 90112
    buffer_load_dwordx4 v1, s[8:11], s24 offen offset:0 lds
    ds_read_b128 v[196:199], v1 offset:53248
    v_mfma_f32_32x32x16_bf16 v[160:175], v[204:207], v[116:119], v[160:175]
    buffer_load_dwordx4 v1, s[8:11], s24 offen offset:1024 lds
    ds_read_b128 v[200:203], v1 offset:25600
    s_waitcnt lgkmcnt(5)
    s_waitcnt vmcnt(11)
    v_mfma_f32_32x32x16_bf16 v[144:159], v[208:211], v[120:123], v[144:159]
    ds_read_b128 v[204:207], v1 offset:54272
    v_mfma_f32_32x32x16_bf16 v[160:175], v[212:215], v[120:123], v[160:175]
    buffer_load_dwordx4 v1, s[8:11], s24 offen offset:2048 lds
    ds_read_b128 v[208:211], v1 offset:26624
    s_waitcnt lgkmcnt(5)
    s_waitcnt vmcnt(11)
    v_mfma_f32_32x32x16_bf16 v[144:159], v[216:219], v[124:127], v[144:159]
    s_add_u32 m0, s26, 114688
    s_add_u32 s24, s25, 114688
    buffer_load_dwordx4 v1, s[8:11], s24 offen offset:0 lds
    ds_read_b128 v[212:215], v1 offset:55296
    v_mfma_f32_32x32x16_bf16 v[160:175], v[220:223], v[124:127], v[160:175]
    ds_read_b128 v[216:219], v1 offset:27648
    s_waitcnt lgkmcnt(5)
    s_waitcnt vmcnt(11)
    v_mfma_f32_32x32x16_bf16 v[144:159], v[192:195], v[128:131], v[144:159]
    buffer_load_dwordx4 v1, s[8:11], s24 offen offset:1024 lds
    ds_read_b128 v[220:223], v1 offset:56320
    v_mfma_f32_32x32x16_bf16 v[160:175], v[196:199], v[128:131], v[160:175]
    buffer_load_dwordx4 v1, s[8:11], s24 offen offset:2048 lds
    ds_read_b128 v[192:195], v16 offset:1024
    s_waitcnt lgkmcnt(5)
    s_waitcnt vmcnt(12)
    v_mfma_f32_32x32x16_bf16 v[144:159], v[200:203], v[132:135], v[144:159]
    ds_read_b128 v[196:199], v16 offset:2048
    v_mfma_f32_32x32x16_bf16 v[160:175], v[204:207], v[132:135], v[160:175]
    buffer_load_dwordx4 v1, s[8:11], s24 offen offset:3072 lds
    ds_read_b128 v[200:203], v14 offset:0
    s_waitcnt lgkmcnt(5)
    s_waitcnt vmcnt(12)
    v_mfma_f32_32x32x16_bf16 v[144:159], v[208:211], v[136:139], v[144:159]
    s_add_u32 m0, s26, 118784
    s_add_u32 s24, s25, 118784
    buffer_load_dwordx4 v1, s[8:11], s24 offen offset:0 lds
    ds_read_b128 v[204:207], v14 offset:1024
    v_mfma_f32_32x32x16_bf16 v[160:175], v[212:215], v[136:139], v[160:175]
    ds_read_b128 v[208:211], v14 offset:2048
    s_waitcnt lgkmcnt(5)
    s_waitcnt vmcnt(12)
    v_mfma_f32_32x32x16_bf16 v[144:159], v[216:219], v[140:143], v[144:159]
    buffer_load_dwordx4 v1, s[8:11], s24 offen offset:1024 lds
    ds_read_b128 v[212:215], v14 offset:3072
    v_mfma_f32_32x32x16_bf16 v[160:175], v[220:223], v[140:143], v[160:175]
    buffer_load_dwordx4 v1, s[8:11], s24 offen offset:2048 lds
    ds_read_b128 v[216:219], v14 offset:4096
    s_waitcnt lgkmcnt(5)
    v_mfma_f32_32x32x16_bf16 v[144:159], v[192:195], v[28:31], v[144:159]
    ds_read_b128 v[220:223], v14 offset:5120
    v_mfma_f32_32x32x16_bf16 v[160:175], v[196:199], v[28:31], v[160:175]
    ds_read_b128 v[192:195], v14 offset:6144
    s_waitcnt lgkmcnt(5)
    v_mfma_f32_32x32x16_bf16 v[176:191], v[200:203], v[32:35], 0
    ds_read_b128 v[196:199], v14 offset:7168
    v_mfma_f32_32x32x16_bf16 v[176:191], v[204:207], v[36:39], v[176:191]
    s_nop 4
    v_mul_f32 v224, v17, v144
    ds_read_b128 v[200:203], v14 offset:8192
    s_waitcnt lgkmcnt(5)
    v_mfma_f32_32x32x16_bf16 v[176:191], v[208:211], v[40:43], v[176:191]
    v_mul_f32 v225, v17, v145
    v_mul_f32 v226, v17, v146
    v_mul_f32 v227, v17, v147
    v_mul_f32 v228, v17, v148
    v_mul_f32 v229, v17, v149
    ds_read_b128 v[204:207], v14 offset:9216
    v_mfma_f32_32x32x16_bf16 v[176:191], v[212:215], v[44:47], v[176:191]
    v_mul_f32 v230, v17, v150
    v_mul_f32 v231, v17, v151
    v_exp_f32 v224, v224
    ds_read_b128 v[208:211], v14 offset:10240
    s_waitcnt lgkmcnt(5)
    v_mfma_f32_32x32x16_bf16 v[176:191], v[216:219], v[48:51], v[176:191]
    v_mul_f32 v144, v144, v152
    v_exp_f32 v225, v225
    v_mul_f32 v145, v145, v153
    ds_read_b128 v[212:215], v14 offset:11264
    v_mfma_f32_32x32x16_bf16 v[176:191], v[220:223], v[52:55], v[176:191]
    v_exp_f32 v226, v226
    v_mul_f32 v146, v146, v154
    ds_read_b128 v[216:219], v14 offset:12288
    s_waitcnt lgkmcnt(5)
    v_mfma_f32_32x32x16_bf16 v[176:191], v[192:195], v[56:59], v[176:191]
    v_exp_f32 v227, v227
    v_mul_f32 v147, v147, v155
    v_exp_f32 v228, v228
    ds_read_b128 v[220:223], v14 offset:13312
    v_mfma_f32_32x32x16_bf16 v[176:191], v[196:199], v[60:63], v[176:191]
    v_mul_f32 v148, v148, v156
    v_exp_f32 v229, v229
    v_mul_f32 v149, v149, v157
    ds_read_b128 v[192:195], v14 offset:14336
    s_waitcnt lgkmcnt(5)
    v_mfma_f32_32x32x16_bf16 v[176:191], v[200:203], v[64:67], v[176:191]
    v_exp_f32 v230, v230
    v_mul_f32 v150, v150, v158
    v_exp_f32 v231, v231
    ds_read_b128 v[196:199], v14 offset:15360
    v_mfma_f32_32x32x16_bf16 v[176:191], v[204:207], v[68:71], v[176:191]
    v_mul_f32 v151, v151, v159
    v_add_f32 v224, 1.0, v224
    v_add_f32 v225, 1.0, v225
    v_add_f32 v226, 1.0, v226
    ds_read_b128 v[200:203], v14 offset:16384
    s_waitcnt lgkmcnt(5)
    v_mfma_f32_32x32x16_bf16 v[176:191], v[208:211], v[72:75], v[176:191]
    v_add_f32 v227, 1.0, v227
    v_add_f32 v228, 1.0, v228
    v_add_f32 v229, 1.0, v229
    v_add_f32 v230, 1.0, v230
    v_add_f32 v231, 1.0, v231
    ds_read_b128 v[204:207], v14 offset:17408
    v_mfma_f32_32x32x16_bf16 v[176:191], v[212:215], v[76:79], v[176:191]
    v_rcp_f32 v224, v224
    v_rcp_f32 v225, v225
    ds_read_b128 v[208:211], v14 offset:18432
    s_waitcnt lgkmcnt(5)
    v_mfma_f32_32x32x16_bf16 v[176:191], v[216:219], v[80:83], v[176:191]
    v_mul_f32 v144, v144, v224
    v_rcp_f32 v226, v226
    v_mul_f32 v145, v145, v225
    ds_read_b128 v[212:215], v14 offset:19456
    v_mfma_f32_32x32x16_bf16 v[176:191], v[220:223], v[84:87], v[176:191]
    v_rcp_f32 v227, v227
    v_mul_f32 v146, v146, v226
    ds_read_b128 v[216:219], v14 offset:20480
    s_waitcnt lgkmcnt(5)
    v_mfma_f32_32x32x16_bf16 v[176:191], v[192:195], v[88:91], v[176:191]
    v_rcp_f32 v228, v228
    v_mul_f32 v147, v147, v227
    v_rcp_f32 v229, v229
    ds_read_b128 v[220:223], v14 offset:21504
    v_mfma_f32_32x32x16_bf16 v[176:191], v[196:199], v[92:95], v[176:191]
    v_mul_f32 v148, v148, v228
    v_rcp_f32 v230, v230
    v_mul_f32 v149, v149, v229
    ds_read_b128 v[192:195], v14 offset:22528
    s_waitcnt lgkmcnt(5)
    v_mfma_f32_32x32x16_bf16 v[176:191], v[200:203], v[96:99], v[176:191]
    v_rcp_f32 v231, v231
    v_mul_f32 v150, v150, v230
    v_mul_f32 v151, v151, v231
    v_cvt_pk_bf16_f32 v240, v144, v145
    ds_read_b128 v[196:199], v14 offset:23552
    v_mfma_f32_32x32x16_bf16 v[176:191], v[204:207], v[100:103], v[176:191]
    v_cvt_pk_bf16_f32 v241, v146, v147
    v_cvt_pk_bf16_f32 v242, v148, v149
    v_cvt_pk_bf16_f32 v243, v150, v151
    ds_read_b128 v[200:203], v14 offset:24576
    s_waitcnt lgkmcnt(5)
    v_mfma_f32_32x32x16_bf16 v[176:191], v[208:211], v[104:107], v[176:191]
    buffer_store_dwordx4 v[240:243], v1, s[8:11], s61 offen offset:0 sc1
    v_mul_f32 v232, v17, v160
    ds_read_b128 v[204:207], v14 offset:25600
    v_mfma_f32_32x32x16_bf16 v[176:191], v[212:215], v[108:111], v[176:191]
    v_mul_f32 v233, v17, v161
    v_mul_f32 v234, v17, v162
    v_mul_f32 v235, v17, v163
    v_mul_f32 v236, v17, v164
    ds_read_b128 v[208:211], v14 offset:26624
    s_waitcnt lgkmcnt(5)
    v_mfma_f32_32x32x16_bf16 v[176:191], v[216:219], v[112:115], v[176:191]
    v_mul_f32 v237, v17, v165
    v_mul_f32 v238, v17, v166
    v_mul_f32 v239, v17, v167
    v_exp_f32 v232, v232
    ds_read_b128 v[212:215], v14 offset:27648
    v_mfma_f32_32x32x16_bf16 v[176:191], v[220:223], v[116:119], v[176:191]
    v_mul_f32 v160, v160, v168
    v_exp_f32 v233, v233
    v_mul_f32 v161, v161, v169
    ds_read_b128 v[216:219], v16 offset:3072
    s_waitcnt lgkmcnt(5)
    v_mfma_f32_32x32x16_bf16 v[176:191], v[192:195], v[120:123], v[176:191]
    s_waitcnt vmcnt(1)
    s_waitcnt lgkmcnt(0)
    s_barrier
    ds_read_b128 v[220:223], v14 offset:28672
    v_mfma_f32_32x32x16_bf16 v[176:191], v[196:199], v[124:127], v[176:191]
    v_exp_f32 v234, v234
    v_mul_f32 v162, v162, v170
    ds_read_b128 v[192:195], v14 offset:29696
    v_mfma_f32_32x32x16_bf16 v[176:191], v[200:203], v[128:131], v[176:191]
    v_exp_f32 v235, v235
    v_mul_f32 v163, v163, v171
    v_exp_f32 v236, v236
    ds_read_b128 v[196:199], v14 offset:30720
    v_mfma_f32_32x32x16_bf16 v[176:191], v[204:207], v[132:135], v[176:191]
    v_mul_f32 v164, v164, v172
    v_exp_f32 v237, v237
    v_mul_f32 v165, v165, v173
    ds_read_b128 v[200:203], v14 offset:31744
    v_mfma_f32_32x32x16_bf16 v[176:191], v[208:211], v[136:139], v[176:191]
    v_exp_f32 v238, v238
    v_mul_f32 v166, v166, v174
    v_exp_f32 v239, v239
    ds_read_b128 v[204:207], v14 offset:32768
    v_mfma_f32_32x32x16_bf16 v[176:191], v[212:215], v[140:143], v[176:191]
    v_mul_f32 v167, v167, v175
    v_add_f32 v232, 1.0, v232
    v_add_f32 v233, 1.0, v233
    v_add_f32 v234, 1.0, v234
    ds_read_b128 v[208:211], v14 offset:33792
    s_waitcnt lgkmcnt(5)
    v_mfma_f32_32x32x16_bf16 v[176:191], v[216:219], v[28:31], v[176:191]
    v_add_f32 v235, 1.0, v235
    v_add_f32 v236, 1.0, v236
    v_add_f32 v237, 1.0, v237
    v_add_f32 v238, 1.0, v238
    v_add_f32 v239, 1.0, v239
    ds_read_b128 v[212:215], v14 offset:34816
    v_mfma_f32_32x32x16_bf16 v[144:159], v[220:223], v[32:35], 0
    v_rcp_f32 v232, v232
    v_rcp_f32 v233, v233
    ds_read_b128 v[216:219], v14 offset:35840
    s_waitcnt lgkmcnt(5)
    v_mfma_f32_32x32x16_bf16 v[144:159], v[192:195], v[36:39], v[144:159]
    v_mul_f32 v160, v160, v232
    v_rcp_f32 v234, v234
    v_mul_f32 v161, v161, v233
    ds_read_b128 v[220:223], v14 offset:36864
    v_mfma_f32_32x32x16_bf16 v[144:159], v[196:199], v[40:43], v[144:159]
    v_rcp_f32 v235, v235
    v_mul_f32 v162, v162, v234
    ds_read_b128 v[192:195], v14 offset:37888
    s_waitcnt lgkmcnt(5)
    v_mfma_f32_32x32x16_bf16 v[144:159], v[200:203], v[44:47], v[144:159]
    v_rcp_f32 v236, v236
    v_mul_f32 v163, v163, v235
    v_rcp_f32 v237, v237
    ds_read_b128 v[196:199], v14 offset:38912
    v_mfma_f32_32x32x16_bf16 v[144:159], v[204:207], v[48:51], v[144:159]
    v_mul_f32 v164, v164, v236
    v_rcp_f32 v238, v238
    v_mul_f32 v165, v165, v237
    ds_read_b128 v[200:203], v14 offset:39936
    s_waitcnt lgkmcnt(5)
    v_mfma_f32_32x32x16_bf16 v[144:159], v[208:211], v[52:55], v[144:159]
    v_rcp_f32 v239, v239
    v_mul_f32 v166, v166, v238
    v_mul_f32 v167, v167, v239
    v_cvt_pk_bf16_f32 v244, v160, v161
    ds_read_b128 v[204:207], v14 offset:40960
    v_mfma_f32_32x32x16_bf16 v[144:159], v[212:215], v[56:59], v[144:159]
    v_cvt_pk_bf16_f32 v245, v162, v163
    v_cvt_pk_bf16_f32 v246, v164, v165
    v_cvt_pk_bf16_f32 v247, v166, v167
    ds_read_b128 v[208:211], v14 offset:41984
    s_waitcnt lgkmcnt(5)
    v_mfma_f32_32x32x16_bf16 v[144:159], v[216:219], v[60:63], v[144:159]
    buffer_store_dwordx4 v[244:247], v1, s[8:11], s61 offen offset:1024 sc1
    v_mul_f32 v224, v17, v176
    ds_read_b128 v[212:215], v14 offset:43008
    v_mfma_f32_32x32x16_bf16 v[144:159], v[220:223], v[64:67], v[144:159]
    v_mul_f32 v225, v17, v177
    v_mul_f32 v226, v17, v178
    s_add_u32 m0, s26, 0
    s_add_u32 s24, s25, 143360
    ds_read_b128 v[216:219], v14 offset:44032
    s_waitcnt lgkmcnt(5)
    v_mfma_f32_32x32x16_bf16 v[144:159], v[192:195], v[68:71], v[144:159]
    buffer_load_dwordx4 v1, s[8:11], s24 offen offset:0 lds
    v_mul_f32 v227, v17, v179
    v_mul_f32 v228, v17, v180
    v_mul_f32 v229, v17, v181
    buffer_load_dwordx4 v1, s[8:11], s24 offen offset:1024 lds
    ds_read_b128 v[220:223], v14 offset:45056
    v_mfma_f32_32x32x16_bf16 v[144:159], v[196:199], v[72:75], v[144:159]
    v_mul_f32 v230, v17, v182
    v_mul_f32 v231, v17, v183
    v_exp_f32 v224, v224
    ds_read_b128 v[192:195], v14 offset:46080
    s_waitcnt lgkmcnt(5)
    v_mfma_f32_32x32x16_bf16 v[144:159], v[200:203], v[76:79], v[144:159]
    buffer_load_dwordx4 v1, s[8:11], s24 offen offset:2048 lds
    v_mul_f32 v176, v176, v184
    v_exp_f32 v225, v225
    v_mul_f32 v177, v177, v185
    ds_read_b128 v[196:199], v14 offset:47104
    v_mfma_f32_32x32x16_bf16 v[144:159], v[204:207], v[80:83], v[144:159]
    buffer_load_dwordx4 v1, s[8:11], s24 offen offset:3072 lds
    v_exp_f32 v226, v226
    v_mul_f32 v178, v178, v186
    ds_read_b128 v[200:203], v14 offset:48128
    s_waitcnt lgkmcnt(5)
    v_mfma_f32_32x32x16_bf16 v[144:159], v[208:211], v[84:87], v[144:159]
    v_exp_f32 v227, v227
    s_add_u32 m0, s26, 4096
    s_add_u32 s24, s25, 147456
    buffer_load_dwordx4 v1, s[8:11], s24 offen offset:0 lds
    ds_read_b128 v[204:207], v14 offset:49152
    v_mfma_f32_32x32x16_bf16 v[144:159], v[212:215], v[88:91], v[144:159]
    v_mul_f32 v179, v179, v187
    v_exp_f32 v228, v228
    v_mul_f32 v180, v180, v188
    ds_read_b128 v[208:211], v14 offset:50176
    s_waitcnt lgkmcnt(5)
    v_mfma_f32_32x32x16_bf16 v[144:159], v[216:219], v[92:95], v[144:159]
    buffer_load_dwordx4 v1, s[8:11], s24 offen offset:1024 lds
    v_exp_f32 v229, v229
    v_mul_f32 v181, v181, v189
    ds_read_b128 v[212:215], v14 offset:51200
    v_mfma_f32_32x32x16_bf16 v[144:159], v[220:223], v[96:99], v[144:159]
    v_exp_f32 v230, v230
    buffer_load_dwordx4 v1, s[8:11], s24 offen offset:2048 lds
    v_mul_f32 v182, v182, v190
    ds_read_b128 v[216:219], v14 offset:52224
    s_waitcnt lgkmcnt(5)
    v_mfma_f32_32x32x16_bf16 v[144:159], v[192:195], v[100:103], v[144:159]
    v_exp_f32 v231, v231
    v_mul_f32 v183, v183, v191
    s_add_u32 m0, s26, 28672
    s_add_u32 s24, s25, 172032
    ds_read_b128 v[220:223], v14 offset:53248
    v_mfma_f32_32x32x16_bf16 v[144:159], v[196:199], v[104:107], v[144:159]
    buffer_load_dwordx4 v1, s[8:11], s24 offen offset:0 lds
    v_add_f32 v224, 1.0, v224
    v_add_f32 v225, 1.0, v225
    v_add_f32 v226, 1.0, v226
    ds_read_b128 v[192:195], v14 offset:54272
    s_waitcnt lgkmcnt(5)
    v_mfma_f32_32x32x16_bf16 v[144:159], v[200:203], v[108:111], v[144:159]
    buffer_load_dwordx4 v1, s[8:11], s24 offen offset:1024 lds
    v_add_f32 v227, 1.0, v227
    v_add_f32 v228, 1.0, v228
    v_add_f32 v229, 1.0, v229
    buffer_load_dwordx4 v1, s[8:11], s24 offen offset:2048 lds
    ds_read_b128 v[196:199], v14 offset:55296
    v_mfma_f32_32x32x16_bf16 v[144:159], v[204:207], v[112:115], v[144:159]
    v_add_f32 v230, 1.0, v230
    v_add_f32 v231, 1.0, v231
    v_rcp_f32 v224, v224
    ds_read_b128 v[200:203], v14 offset:56320
    s_waitcnt lgkmcnt(5)
    v_mfma_f32_32x32x16_bf16 v[144:159], v[208:211], v[116:119], v[144:159]
    buffer_load_dwordx4 v1, s[8:11], s24 offen offset:3072 lds
    v_rcp_f32 v225, v225
    v_mul_f32 v176, v176, v224
    ds_read_b128 v[204:207], v16 offset:4096
    v_mfma_f32_32x32x16_bf16 v[144:159], v[212:215], v[120:123], v[144:159]
    v_rcp_f32 v226, v226
    s_add_u32 m0, s26, 32768
    s_add_u32 s24, s25, 176128
    ds_read_b128 v[208:211], v15 offset:0
    s_waitcnt lgkmcnt(5)
    v_mfma_f32_32x32x16_bf16 v[144:159], v[216:219], v[124:127], v[144:159]
    buffer_load_dwordx4 v1, s[8:11], s24 offen offset:0 lds
    v_mul_f32 v177, v177, v225
    v_rcp_f32 v227, v227
    v_mul_f32 v178, v178, v226
    ds_read_b128 v[212:215], v15 offset:1024
    v_mfma_f32_32x32x16_bf16 v[144:159], v[220:223], v[128:131], v[144:159]
    buffer_load_dwordx4 v1, s[8:11], s24 offen offset:1024 lds
    v_rcp_f32 v228, v228
    v_mul_f32 v179, v179, v227
    ds_read_b128 v[216:219], v15 offset:2048
    s_waitcnt lgkmcnt(5)
    v_mfma_f32_32x32x16_bf16 v[144:159], v[192:195], v[132:135], v[144:159]
    v_rcp_f32 v229, v229
    buffer_load_dwordx4 v1, s[8:11], s24 offen offset:2048 lds
    v_mul_f32 v180, v180, v228
    ds_read_b128 v[220:223], v15 offset:3072
    v_mfma_f32_32x32x16_bf16 v[144:159], v[196:199], v[136:139], v[144:159]
    v_rcp_f32 v230, v230
    v_mul_f32 v181, v181, v229
    ds_read_b128 v[192:195], v15 offset:4096
    s_waitcnt lgkmcnt(5)
    v_mfma_f32_32x32x16_bf16 v[144:159], v[200:203], v[140:143], v[144:159]
    ds_read_b128 v[196:199], v15 offset:5120
    v_mfma_f32_32x32x16_bf16 v[144:159], v[204:207], v[28:31], v[144:159]
    v_rcp_f32 v231, v231
    v_mul_f32 v182, v182, v230
    v_mul_f32 v183, v183, v231
    ds_read_b128 v[200:203], v15 offset:6144
    s_waitcnt lgkmcnt(5)
    v_mfma_f32_32x32x16_bf16 v[160:175], v[208:211], v[32:35], 0
    v_cvt_pk_bf16_f32 v240, v176, v177
    v_cvt_pk_bf16_f32 v241, v178, v179
    v_cvt_pk_bf16_f32 v242, v180, v181
    v_cvt_pk_bf16_f32 v243, v182, v183
    ds_read_b128 v[204:207], v15 offset:7168
    v_mfma_f32_32x32x16_bf16 v[160:175], v[212:215], v[36:39], v[160:175]
    buffer_store_dwordx4 v[240:243], v1, s[8:11], s61 offen offset:2048 sc1
    ds_read_b128 v[208:211], v15 offset:8192
    s_waitcnt lgkmcnt(5)
    v_mfma_f32_32x32x16_bf16 v[160:175], v[216:219], v[40:43], v[160:175]
    v_mul_f32 v232, v17, v144
    v_mul_f32 v233, v17, v145
    v_mul_f32 v234, v17, v146
    s_add_u32 s63, s29, 24576
    buffer_load_dwordx4 a[96:99], v1, s[8:11], s63 offen offset:0
    ds_read_b128 v[212:215], v15 offset:9216
    v_mfma_f32_32x32x16_bf16 v[160:175], v[220:223], v[44:47], v[160:175]
    v_mul_f32 v235, v17, v147
    v_mul_f32 v236, v17, v148
    v_mul_f32 v237, v17, v149
    buffer_load_dwordx4 a[100:103], v1, s[8:11], s63 offen offset:1024
    ds_read_b128 v[216:219], v15 offset:10240
    s_waitcnt lgkmcnt(5)
    v_mfma_f32_32x32x16_bf16 v[160:175], v[192:195], v[48:51], v[160:175]
    v_mul_f32 v238, v17, v150
    v_mul_f32 v239, v17, v151
    v_exp_f32 v232, v232
    buffer_load_dwordx4 a[104:107], v1, s[8:11], s63 offen offset:2048
    ds_read_b128 v[220:223], v15 offset:11264
    v_mfma_f32_32x32x16_bf16 v[160:175], v[196:199], v[52:55], v[160:175]
    v_mul_f32 v144, v144, v152
    v_exp_f32 v233, v233
    v_mul_f32 v145, v145, v153
    ds_read_b128 v[192:195], v15 offset:12288
    s_waitcnt lgkmcnt(5)
    v_mfma_f32_32x32x16_bf16 v[160:175], v[200:203], v[56:59], v[160:175]
    buffer_load_dwordx4 a[108:111], v1, s[8:11], s63 offen offset:3072
    v_exp_f32 v234, v234
    v_mul_f32 v146, v146, v154
    ds_read_b128 v[196:199], v15 offset:13312
    v_mfma_f32_32x32x16_bf16 v[160:175], v[204:207], v[60:63], v[160:175]
    v_exp_f32 v235, v235
    s_add_u32 s63, s30, 0
    buffer_load_dwordx4 a[112:115], v1, s[8:11], s63 offen offset:0
    ds_read_b128 v[200:203], v15 offset:14336
    s_waitcnt lgkmcnt(5)
    v_mfma_f32_32x32x16_bf16 v[160:175], v[208:211], v[64:67], v[160:175]
    v_mul_f32 v147, v147, v155
    v_exp_f32 v236, v236
    v_mul_f32 v148, v148, v156
    buffer_load_dwordx4 a[116:119], v1, s[8:11], s63 offen offset:1024
    ds_read_b128 v[204:207], v15 offset:15360
    v_mfma_f32_32x32x16_bf16 v[160:175], v[212:215], v[68:71], v[160:175]
    v_exp_f32 v237, v237
    v_mul_f32 v149, v149, v157
    ds_read_b128 v[208:211], v15 offset:16384
    s_waitcnt lgkmcnt(5)
    v_mfma_f32_32x32x16_bf16 v[160:175], v[216:219], v[72:75], v[160:175]
    v_exp_f32 v238, v238
    buffer_load_dwordx4 a[120:123], v1, s[8:11], s63 offen offset:2048
    v_mul_f32 v150, v150, v158
    ds_read_b128 v[212:215], v15 offset:17408
    v_mfma_f32_32x32x16_bf16 v[160:175], v[220:223], v[76:79], v[160:175]
    v_exp_f32 v239, v239
    v_mul_f32 v151, v151, v159
    buffer_load_dwordx4 a[124:127], v1, s[8:11], s63 offen offset:3072
    ds_read_b128 v[216:219], v15 offset:18432
    s_waitcnt lgkmcnt(5)
    v_mfma_f32_32x32x16_bf16 v[160:175], v[192:195], v[80:83], v[160:175]
    v_add_f32 v232, 1.0, v232
    v_add_f32 v233, 1.0, v233
    v_add_f32 v234, 1.0, v234
    s_add_u32 s63, s30, 4096
    buffer_load_dwordx4 a[128:131], v1, s[8:11], s63 offen offset:0
    ds_read_b128 v[220:223], v15 offset:19456
    v_mfma_f32_32x32x16_bf16 v[160:175], v[196:199], v[84:87], v[160:175]
    v_add_f32 v235, 1.0, v235
    v_add_f32 v236, 1.0, v236
    v_add_f32 v237, 1.0, v237
    buffer_load_dwordx4 a[132:135], v1, s[8:11], s63 offen offset:1024
    ds_read_b128 v[192:195], v15 offset:20480
    s_waitcnt lgkmcnt(5)
    v_mfma_f32_32x32x16_bf16 v[160:175], v[200:203], v[88:91], v[160:175]
    v_add_f32 v238, 1.0, v238
    v_add_f32 v239, 1.0, v239
    v_rcp_f32 v232, v232
    buffer_load_dwordx4 a[136:139], v1, s[8:11], s63 offen offset:2048
    ds_read_b128 v[196:199], v15 offset:21504
    v_mfma_f32_32x32x16_bf16 v[160:175], v[204:207], v[92:95], v[160:175]
    v_rcp_f32 v233, v233
    v_mul_f32 v144, v144, v232
    ds_read_b128 v[200:203], v15 offset:22528
    s_waitcnt lgkmcnt(5)
    v_mfma_f32_32x32x16_bf16 v[160:175], v[208:211], v[96:99], v[160:175]
    v_rcp_f32 v234, v234
    buffer_load_dwordx4 a[140:143], v1, s[8:11], s63 offen offset:3072
    v_mul_f32 v145, v145, v233
    ds_read_b128 v[204:207], v15 offset:23552
    v_mfma_f32_32x32x16_bf16 v[160:175], v[212:215], v[100:103], v[160:175]
    v_rcp_f32 v235, v235
    v_mul_f32 v146, v146, v234
    ds_read_b128 v[208:211], v15 offset:24576
    s_waitcnt lgkmcnt(5)
    v_mfma_f32_32x32x16_bf16 v[160:175], v[216:219], v[104:107], v[160:175]
    s_add_u32 s63, s30, 8192
    buffer_load_dwordx4 a[144:147], v1, s[8:11], s63 offen offset:0
    v_rcp_f32 v236, v236
    v_mul_f32 v147, v147, v235
    ds_read_b128 v[212:215], v15 offset:25600
    v_mfma_f32_32x32x16_bf16 v[160:175], v[220:223], v[108:111], v[160:175]
    v_rcp_f32 v237, v237
    buffer_load_dwordx4 a[148:151], v1, s[8:11], s63 offen offset:1024
    v_mul_f32 v148, v148, v236
    ds_read_b128 v[216:219], v15 offset:26624
    s_waitcnt lgkmcnt(5)
    v_mfma_f32_32x32x16_bf16 v[160:175], v[192:195], v[112:115], v[160:175]
    v_rcp_f32 v238, v238
    v_mul_f32 v149, v149, v237
    buffer_load_dwordx4 a[152:155], v1, s[8:11], s63 offen offset:2048
    ds_read_b128 v[220:223], v15 offset:27648
    v_mfma_f32_32x32x16_bf16 v[160:175], v[196:199], v[116:119], v[160:175]
    v_rcp_f32 v239, v239
    v_mul_f32 v150, v150, v238
    v_mul_f32 v151, v151, v239
    ds_read_b128 v[192:195], v16 offset:5120
    s_waitcnt lgkmcnt(5)
    v_mfma_f32_32x32x16_bf16 v[160:175], v[200:203], v[120:123], v[160:175]
    buffer_load_dwordx4 a[156:159], v1, s[8:11], s63 offen offset:3072
    s_waitcnt vmcnt(17)
    s_waitcnt lgkmcnt(0)
    s_barrier
    ds_read_b128 v[196:199], v1 offset:0
    v_mfma_f32_32x32x16_bf16 v[160:175], v[204:207], v[124:127], v[160:175]
    v_cvt_pk_bf16_f32 v244, v144, v145
    v_cvt_pk_bf16_f32 v245, v146, v147
    v_cvt_pk_bf16_f32 v246, v148, v149
    v_cvt_pk_bf16_f32 v247, v150, v151
    ds_read_b128 v[200:203], v1 offset:1024
    v_mfma_f32_32x32x16_bf16 v[160:175], v[208:211], v[128:131], v[160:175]
    buffer_store_dwordx4 v[244:247], v1, s[8:11], s61 offen offset:3072 sc1
    ds_read_b128 v[204:207], v1 offset:2048
    v_mfma_f32_32x32x16_bf16 v[160:175], v[212:215], v[132:135], v[160:175]
    ds_read_b128 v[208:211], v1 offset:3072
    v_mfma_f32_32x32x16_bf16 v[160:175], v[216:219], v[136:139], v[160:175]
    ds_read_b128 v[212:215], v1 offset:4096
    v_mfma_f32_32x32x16_bf16 v[160:175], v[220:223], v[140:143], v[160:175]
    ds_read_b128 v[216:219], v1 offset:5120
    s_waitcnt lgkmcnt(5)
    v_mfma_f32_32x32x16_bf16 v[160:175], v[192:195], v[28:31], v[160:175]
    ds_read_b128 v[220:223], v1 offset:6144
    v_mfma_f32_32x32x16_bf16 v[176:191], v[196:199], v[32:35], 0
    ds_read_b128 v[192:195], v1 offset:7168
    s_waitcnt lgkmcnt(5)
    v_mfma_f32_32x32x16_bf16 v[176:191], v[200:203], v[36:39], v[176:191]
    ds_read_b128 v[196:199], v1 offset:8192
    v_mfma_f32_32x32x16_bf16 v[176:191], v[204:207], v[40:43], v[176:191]
    s_nop 4
    v_mul_f32 v224, v17, v160
    ds_read_b128 v[200:203], v1 offset:9216
    s_waitcnt lgkmcnt(5)
    v_mfma_f32_32x32x16_bf16 v[176:191], v[208:211], v[44:47], v[176:191]
    s_add_u32 s63, s30, 12288
    buffer_load_dwordx4 a[160:163], v1, s[8:11], s63 offen offset:0
    v_mul_f32 v225, v17, v161
    buffer_load_dwordx4 a[164:167], v1, s[8:11], s63 offen offset:1024
    v_mul_f32 v226, v17, v162
    ds_read_b128 v[204:207], v1 offset:10240
    v_mfma_f32_32x32x16_bf16 v[176:191], v[212:215], v[48:51], v[176:191]
    buffer_load_dwordx4 a[168:171], v1, s[8:11], s63 offen offset:2048
    v_mul_f32 v227, v17, v163
    buffer_load_dwordx4 a[172:175], v1, s[8:11], s63 offen offset:3072
    v_mul_f32 v228, v17, v164
    ds_read_b128 v[208:211], v1 offset:11264
    s_waitcnt lgkmcnt(5)
    v_mfma_f32_32x32x16_bf16 v[176:191], v[216:219], v[52:55], v[176:191]
    s_add_u32 s63, s30, 16384
    buffer_load_dwordx4 a[176:179], v1, s[8:11], s63 offen offset:0
    v_mul_f32 v229, v17, v165
    buffer_load_dwordx4 a[180:183], v1, s[8:11], s63 offen offset:1024
    v_mul_f32 v230, v17, v166
    ds_read_b128 v[212:215], v1 offset:12288
    v_mfma_f32_32x32x16_bf16 v[176:191], v[220:223], v[56:59], v[176:191]
    buffer_load_dwordx4 a[184:187], v1, s[8:11], s63 offen offset:2048
    v_mul_f32 v231, v17, v167
    buffer_load_dwordx4 a[188:191], v1, s[8:11], s63 offen offset:3072
    ds_read_b128 v[216:219], v1 offset:13312
    s_waitcnt lgkmcnt(5)
    v_mfma_f32_32x32x16_bf16 v[176:191], v[192:195], v[60:63], v[176:191]
    v_exp_f32 v224, v224
    s_add_u32 s63, s30, 20480
    buffer_load_dwordx4 a[192:195], v1, s[8:11], s63 offen offset:0
    v_mul_f32 v160, v160, v168
    ds_read_b128 v[220:223], v1 offset:14336
    v_mfma_f32_32x32x16_bf16 v[176:191], v[196:199], v[64:67], v[176:191]
    buffer_load_dwordx4 a[196:199], v1, s[8:11], s63 offen offset:1024
    v_exp_f32 v225, v225
    buffer_load_dwordx4 a[200:203], v1, s[8:11], s63 offen offset:2048
    ds_read_b128 v[192:195], v1 offset:15360
    s_waitcnt lgkmcnt(5)
    v_mfma_f32_32x32x16_bf16 v[176:191], v[200:203], v[68:71], v[176:191]
    v_mul_f32 v161, v161, v169
    buffer_load_dwordx4 a[204:207], v1, s[8:11], s63 offen offset:3072
    v_exp_f32 v226, v226
    ds_read_b128 v[196:199], v1 offset:16384
    v_mfma_f32_32x32x16_bf16 v[176:191], v[204:207], v[72:75], v[176:191]
    s_add_u32 s63, s30, 24576
    buffer_load_dwordx4 a[208:211], v1, s[8:11], s63 offen offset:0
    v_mul_f32 v162, v162, v170
    buffer_load_dwordx4 a[212:215], v1, s[8:11], s63 offen offset:1024
    ds_read_b128 v[200:203], v1 offset:17408
    s_waitcnt lgkmcnt(5)
    v_mfma_f32_32x32x16_bf16 v[176:191], v[208:211], v[76:79], v[176:191]
    v_exp_f32 v227, v227
    buffer_load_dwordx4 a[216:219], v1, s[8:11], s63 offen offset:2048
    v_mul_f32 v163, v163, v171
    buffer_load_dwordx4 a[220:223], v1, s[8:11], s63 offen offset:3072
    ds_read_b128 v[204:207], v1 offset:18432
    v_mfma_f32_32x32x16_bf16 v[176:191], v[212:215], v[80:83], v[176:191]
    v_exp_f32 v228, v228
    ds_read_b128 v[208:211], v1 offset:19456
    s_waitcnt lgkmcnt(5)
    v_mfma_f32_32x32x16_bf16 v[176:191], v[216:219], v[84:87], v[176:191]
    v_min_u32 v19, 1, v2
    v_lshlrev_b32 v19, 7, v19
    s_add_u32 s0, s1, 0
    buffer_load_dword v0, v19, s[8:11], s0 offen sc1
    v_mul_f32 v164, v164, v172
    ds_read_b128 v[212:215], v1 offset:20480
    v_mfma_f32_32x32x16_bf16 v[176:191], v[220:223], v[88:91], v[176:191]
    v_exp_f32 v229, v229
    v_mul_f32 v165, v165, v173
    ds_read_b128 v[216:219], v1 offset:21504
    s_waitcnt lgkmcnt(5)
    v_mfma_f32_32x32x16_bf16 v[176:191], v[192:195], v[92:95], v[176:191]
    v_exp_f32 v230, v230
    v_mul_f32 v166, v166, v174
    v_exp_f32 v231, v231
    ds_read_b128 v[220:223], v1 offset:22528
    v_mfma_f32_32x32x16_bf16 v[176:191], v[196:199], v[96:99], v[176:191]
    v_mul_f32 v167, v167, v175
    v_add_f32 v224, 1.0, v224
    v_add_f32 v225, 1.0, v225
    v_add_f32 v226, 1.0, v226
    ds_read_b128 v[192:195], v1 offset:23552
    s_waitcnt lgkmcnt(5)
    v_mfma_f32_32x32x16_bf16 v[176:191], v[200:203], v[100:103], v[176:191]
    v_add_f32 v227, 1.0, v227
    v_add_f32 v228, 1.0, v228
    v_add_f32 v229, 1.0, v229
    ds_read_b128 v[196:199], v1 offset:24576
    v_mfma_f32_32x32x16_bf16 v[176:191], v[204:207], v[104:107], v[176:191]
    v_mov_b32 v18, 1
    s_waitcnt vmcnt(17)
    s_mov_b64 exec, 1
    buffer_store_dword v18, v11, s[8:11], s33 offen
    s_mov_b64 exec, -1
    ds_read_b128 v[200:203], v1 offset:25600
    s_waitcnt lgkmcnt(5)
    v_mfma_f32_32x32x16_bf16 v[176:191], v[208:211], v[108:111], v[176:191]
    v_add_f32 v230, 1.0, v230
    v_add_f32 v231, 1.0, v231
    v_rcp_f32 v224, v224
    ds_read_b128 v[204:207], v1 offset:26624
    v_mfma_f32_32x32x16_bf16 v[176:191], v[212:215], v[112:115], v[176:191]
    v_rcp_f32 v225, v225
    v_mul_f32 v160, v160, v224
    ds_read_b128 v[208:211], v1 offset:27648
    s_waitcnt lgkmcnt(5)
    v_mfma_f32_32x32x16_bf16 v[176:191], v[216:219], v[116:119], v[176:191]
    v_rcp_f32 v226, v226
    v_mul_f32 v161, v161, v225
    v_rcp_f32 v227, v227
    ds_read_b128 v[212:215], v16 offset:6144
    v_mfma_f32_32x32x16_bf16 v[176:191], v[220:223], v[120:123], v[176:191]
    v_mul_f32 v162, v162, v226
    v_rcp_f32 v228, v228
    v_mul_f32 v163, v163, v227
    ds_read_b128 v[216:219], v1 offset:28672
    s_waitcnt lgkmcnt(5)
    v_mfma_f32_32x32x16_bf16 v[176:191], v[192:195], v[124:127], v[176:191]
    v_rcp_f32 v229, v229
    v_mul_f32 v164, v164, v228
    v_rcp_f32 v230, v230
    ds_read_b128 v[220:223], v1 offset:29696
    v_mfma_f32_32x32x16_bf16 v[176:191], v[196:199], v[128:131], v[176:191]
    v_mul_f32 v165, v165, v229
    v_rcp_f32 v231, v231
    v_mul_f32 v166, v166, v230
    ds_read_b128 v[192:195], v1 offset:30720
    s_waitcnt lgkmcnt(5)
    v_mfma_f32_32x32x16_bf16 v[176:191], v[200:203], v[132:135], v[176:191]
    v_mul_f32 v167, v167, v231
    v_cvt_pk_bf16_f32 v240, v160, v161
    v_cvt_pk_bf16_f32 v241, v162, v163
    v_cvt_pk_bf16_f32 v242, v164, v165
    v_cvt_pk_bf16_f32 v243, v166, v167
    ds_read_b128 v[196:199], v1 offset:31744
    v_mfma_f32_32x32x16_bf16 v[176:191], v[204:207], v[136:139], v[176:191]
    s_add_u32 s61, s61, 4096
    buffer_store_dwordx4 v[240:243], v1, s[8:11], s61 offen offset:0 sc1
    ds_read_b128 v[200:203], v1 offset:32768
    s_waitcnt lgkmcnt(5)
    v_mfma_f32_32x32x16_bf16 v[176:191], v[208:211], v[140:143], v[176:191]
    ds_read_b128 v[204:207], v1 offset:33792
    v_mfma_f32_32x32x16_bf16 v[176:191], v[212:215], v[28:31], v[176:191]
    ds_read_b128 v[208:211], v1 offset:34816
    s_waitcnt lgkmcnt(5)
    v_mfma_f32_32x32x16_bf16 v[144:159], v[216:219], v[32:35], 0
    ds_read_b128 v[212:215], v1 offset:35840
    v_mfma_f32_32x32x16_bf16 v[144:159], v[220:223], v[36:39], v[144:159]
    ds_read_b128 v[216:219], v1 offset:36864
    s_waitcnt lgkmcnt(5)
    v_mfma_f32_32x32x16_bf16 v[144:159], v[192:195], v[40:43], v[144:159]
    s_nop 3
    v_mul_f32 v232, v17, v176
    ds_read_b128 v[220:223], v1 offset:37888
    v_mfma_f32_32x32x16_bf16 v[144:159], v[196:199], v[44:47], v[144:159]
    v_mul_f32 v233, v17, v177
    v_mul_f32 v234, v17, v178
    v_mul_f32 v235, v17, v179
    v_mul_f32 v236, v17, v180
    ds_read_b128 v[192:195], v1 offset:38912
    s_waitcnt lgkmcnt(5)
    v_mfma_f32_32x32x16_bf16 v[144:159], v[200:203], v[48:51], v[144:159]
    v_mul_f32 v237, v17, v181
    v_mul_f32 v238, v17, v182
    v_mul_f32 v239, v17, v183
    v_exp_f32 v232, v232
    ds_read_b128 v[196:199], v1 offset:39936
    v_mfma_f32_32x32x16_bf16 v[144:159], v[204:207], v[52:55], v[144:159]
    v_mul_f32 v176, v176, v184
    v_exp_f32 v233, v233
    v_mul_f32 v177, v177, v185
    ds_read_b128 v[200:203], v1 offset:40960
    s_waitcnt lgkmcnt(5)
    v_mfma_f32_32x32x16_bf16 v[144:159], v[208:211], v[56:59], v[144:159]
    v_exp_f32 v234, v234
    v_mul_f32 v178, v178, v186
    v_exp_f32 v235, v235
    ds_read_b128 v[204:207], v1 offset:41984
    v_mfma_f32_32x32x16_bf16 v[144:159], v[212:215], v[60:63], v[144:159]
    v_mul_f32 v179, v179, v187
    v_exp_f32 v236, v236
    ds_read_b128 v[208:211], v1 offset:43008
    buffer_load_dword v19, v10, s[8:11], s34 offen sc1
    s_waitcnt lgkmcnt(5)
    v_mfma_f32_32x32x16_bf16 v[144:159], v[216:219], v[64:67], v[144:159]
    v_mul_f32 v180, v180, v188
    v_exp_f32 v237, v237
    v_mul_f32 v181, v181, v189
    ds_read_b128 v[212:215], v1 offset:44032
    v_mfma_f32_32x32x16_bf16 v[144:159], v[220:223], v[68:71], v[144:159]
    v_exp_f32 v238, v238
    v_mul_f32 v182, v182, v190
    ds_read_b128 v[216:219], v1 offset:45056
    s_waitcnt lgkmcnt(5)
    v_mfma_f32_32x32x16_bf16 v[144:159], v[192:195], v[72:75], v[144:159]
    v_exp_f32 v239, v239
    v_mul_f32 v183, v183, v191
    v_add_f32 v232, 1.0, v232
    v_add_f32 v233, 1.0, v233
    ds_read_b128 v[220:223], v1 offset:46080
    v_mfma_f32_32x32x16_bf16 v[144:159], v[196:199], v[76:79], v[144:159]
    v_add_f32 v234, 1.0, v234
    v_add_f32 v235, 1.0, v235
    v_add_f32 v236, 1.0, v236
    v_add_f32 v237, 1.0, v237
    ds_read_b128 v[192:195], v1 offset:47104
    s_waitcnt lgkmcnt(5)
    v_mfma_f32_32x32x16_bf16 v[144:159], v[200:203], v[80:83], v[144:159]
    v_add_f32 v238, 1.0, v238
    v_add_f32 v239, 1.0, v239
    v_rcp_f32 v232, v232
    ds_read_b128 v[196:199], v1 offset:48128
    v_mfma_f32_32x32x16_bf16 v[144:159], v[204:207], v[84:87], v[144:159]
    v_rcp_f32 v233, v233
    v_mul_f32 v176, v176, v232
    ds_read_b128 v[200:203], v1 offset:49152
    s_waitcnt lgkmcnt(5)
    v_mfma_f32_32x32x16_bf16 v[144:159], v[208:211], v[88:91], v[144:159]
    v_rcp_f32 v234, v234
    v_mul_f32 v177, v177, v233
    v_rcp_f32 v235, v235
    ds_read_b128 v[204:207], v1 offset:50176
    v_mfma_f32_32x32x16_bf16 v[144:159], v[212:215], v[92:95], v[144:159]
    v_mul_f32 v178, v178, v234
    v_rcp_f32 v236, v236
    v_mul_f32 v179, v179, v235
    ds_read_b128 v[208:211], v1 offset:51200
    s_waitcnt lgkmcnt(5)
    v_mfma_f32_32x32x16_bf16 v[144:159], v[216:219], v[96:99], v[144:159]
    v_rcp_f32 v237, v237
    v_mul_f32 v180, v180, v236
    v_rcp_f32 v238, v238
    ds_read_b128 v[212:215], v1 offset:52224
    v_mfma_f32_32x32x16_bf16 v[144:159], v[220:223], v[100:103], v[144:159]
    ds_read_b128 v[216:219], v1 offset:53248
    s_waitcnt vmcnt(0)
    v_cmp_gt_u32 vcc, 1, v19
    s_nop 1
    s_cbranch_vccnz hwait_32
hok_31:
    s_add_u32 s48, s36, 0
    buffer_load_dwordx4 v[100:103], v1, s[8:11], s48 offen sc1
    s_add_u32 s48, s35, 0
    buffer_load_dwordx4 v[96:99], v1, s[8:11], s48 offen sc1
    s_waitcnt lgkmcnt(5)
    v_mfma_f32_32x32x16_bf16 v[144:159], v[192:195], v[104:107], v[144:159]
    v_mul_f32 v181, v181, v237
    v_rcp_f32 v239, v239
    v_mul_f32 v182, v182, v238
    v_mul_f32 v183, v183, v239
    ds_read_b128 v[220:223], v1 offset:54272
    v_mfma_f32_32x32x16_bf16 v[144:159], v[196:199], v[108:111], v[144:159]
    ds_read_b128 v[192:195], v1 offset:55296
    s_add_u32 s48, s36, 1024
    buffer_load_dwordx4 v[108:111], v1, s[8:11], s48 offen sc1
    s_add_u32 s48, s35, 1024
    buffer_load_dwordx4 v[104:107], v1, s[8:11], s48 offen sc1
    s_waitcnt lgkmcnt(5)
    v_mfma_f32_32x32x16_bf16 v[144:159], v[200:203], v[112:115], v[144:159]
    v_cvt_pk_bf16_f32 v244, v176, v177
    v_cvt_pk_bf16_f32 v245, v178, v179
    v_cvt_pk_bf16_f32 v246, v180, v181
    v_cvt_pk_bf16_f32 v247, v182, v183
    buffer_store_dwordx4 v[244:247], v1, s[8:11], s61 offen offset:1024 sc1
    ds_read_b128 v[196:199], v1 offset:56320
    v_mfma_f32_32x32x16_bf16 v[144:159], v[204:207], v[116:119], v[144:159]
    ds_read_b128 v[200:203], v16 offset:7168
    s_add_u32 s48, s36, 2048
    buffer_load_dwordx4 v[116:119], v1, s[8:11], s48 offen sc1
    s_add_u32 s48, s35, 2048
    buffer_load_dwordx4 v[112:115], v1, s[8:11], s48 offen sc1
    s_waitcnt lgkmcnt(5)
    v_mfma_f32_32x32x16_bf16 v[144:159], v[208:211], v[120:123], v[144:159]
    v_mfma_f32_32x32x16_bf16 v[144:159], v[212:215], v[124:127], v[144:159]
    s_add_u32 s48, s36, 3072
    buffer_load_dwordx4 v[124:127], v1, s[8:11], s48 offen sc1
    s_add_u32 s48, s35, 3072
    buffer_load_dwordx4 v[120:123], v1, s[8:11], s48 offen sc1
    s_waitcnt lgkmcnt(3)
    v_mfma_f32_32x32x16_bf16 v[144:159], v[216:219], v[128:131], v[144:159]
    v_mfma_f32_32x32x16_bf16 v[144:159], v[220:223], v[132:135], v[144:159]
    s_add_u32 s48, s36, 7168
    buffer_load_dwordx4 v[132:135], v1, s[8:11], s48 offen sc1
    s_add_u32 s48, s35, 7168
    buffer_load_dwordx4 v[128:131], v1, s[8:11], s48 offen sc1
    s_waitcnt lgkmcnt(1)
    v_mfma_f32_32x32x16_bf16 v[144:159], v[192:195], v[136:139], v[144:159]
    v_mfma_f32_32x32x16_bf16 v[144:159], v[196:199], v[140:143], v[144:159]
    s_add_u32 s48, s36, 8192
    buffer_load_dwordx4 v[140:143], v1, s[8:11], s48 offen sc1
    s_add_u32 s48, s35, 8192
    buffer_load_dwordx4 v[136:139], v1, s[8:11], s48 offen sc1
    s_waitcnt lgkmcnt(0)
    v_mfma_f32_32x32x16_bf16 v[144:159], v[200:203], v[28:31], v[144:159]
    v_mov_b32 v18, 2
    s_waitcnt vmcnt(8)
    s_mov_b64 exec, 1
    buffer_store_dword v18, v11, s[8:11], s33 offen
    s_mov_b64 exec, -1
    s_cmp_eq_u32 s46, 0
    s_cbranch_scc1 p5_skip_35
    s_add_u32 s48, s36, 9216
    buffer_load_dwordx4 v[164:167], v1, s[8:11], s48 offen sc1
    s_add_u32 s48, s35, 9216
    buffer_load_dwordx4 v[160:163], v1, s[8:11], s48 offen sc1
    v_mfma_f32_32x32x16_bf16 v[64:79], a[0:3], v[100:103], 0
    v_mul_f32 v224, v17, v144
    v_mul_f32 v225, v17, v145
    v_mul_f32 v226, v17, v146
    v_mul_f32 v227, v17, v147
    v_mul_f32 v228, v17, v148
    v_mul_f32 v229, v17, v149
    v_mfma_f32_32x32x16_bf16 v[80:95], a[112:115], v[100:103], 0
    v_mul_f32 v230, v17, v150
    v_mul_f32 v231, v17, v151
    v_exp_f32 v224, v224
    v_mul_f32 v144, v144, v152
    v_mfma_f32_32x32x16_bf16 v[48:63], a[112:115], v[96:99], 0
    v_exp_f32 v225, v225
    v_mul_f32 v145, v145, v153
    v_exp_f32 v226, v226
    v_mul_f32 v146, v146, v154
    v_mfma_f32_32x32x16_bf16 v[32:47], a[0:3], v[96:99], 0
    s_add_u32 s48, s36, 10240
    buffer_load_dwordx4 v[172:175], v1, s[8:11], s48 offen sc1
    s_add_u32 s48, s35, 10240
    buffer_load_dwordx4 v[168:171], v1, s[8:11], s48 offen sc1
    v_mfma_f32_32x32x16_bf16 v[64:79], a[4:7], v[108:111], v[64:79]
    v_exp_f32 v227, v227
    v_mul_f32 v147, v147, v155
    v_exp_f32 v228, v228
    v_mul_f32 v148, v148, v156
    v_mfma_f32_32x32x16_bf16 v[80:95], a[116:119], v[108:111], v[80:95]
    v_exp_f32 v229, v229
    v_mul_f32 v149, v149, v157
    v_exp_f32 v230, v230
    v_mfma_f32_32x32x16_bf16 v[48:63], a[116:119], v[104:107], v[48:63]
    v_mul_f32 v150, v150, v158
    v_exp_f32 v231, v231
    v_mul_f32 v151, v151, v159
    v_add_f32 v224, 1.0, v224
    v_add_f32 v225, 1.0, v225
    v_mfma_f32_32x32x16_bf16 v[32:47], a[4:7], v[104:107], v[32:47]
    v_add_f32 v226, 1.0, v226
    s_add_u32 s48, s36, 14336
    buffer_load_dwordx4 v[180:183], v1, s[8:11], s48 offen sc1
    s_add_u32 s48, s35, 14336
    buffer_load_dwordx4 v[176:179], v1, s[8:11], s48 offen sc1
    s_waitcnt vmcnt(14)
    v_mfma_f32_32x32x16_bf16 v[64:79], a[8:11], v[116:119], v[64:79]
    v_add_f32 v227, 1.0, v227
    v_add_f32 v228, 1.0, v228
    v_add_f32 v229, 1.0, v229
    v_add_f32 v230, 1.0, v230
    v_add_f32 v231, 1.0, v231
    v_mfma_f32_32x32x16_bf16 v[80:95], a[120:123], v[116:119], v[80:95]
    v_rcp_f32 v224, v224
    v_rcp_f32 v225, v225
    v_mul_f32 v144, v144, v224
    s_waitcnt vmcnt(13)
    v_mfma_f32_32x32x16_bf16 v[48:63], a[120:123], v[112:115], v[48:63]
    v_rcp_f32 v226, v226
    v_mul_f32 v145, v145, v225
    v_rcp_f32 v227, v227
    v_mul_f32 v146, v146, v226
    v_mfma_f32_32x32x16_bf16 v[32:47], a[8:11], v[112:115], v[32:47]
    s_add_u32 s48, s36, 15360
    buffer_load_dwordx4 v[188:191], v1, s[8:11], s48 offen sc1
    s_add_u32 s48, s35, 15360
    buffer_load_dwordx4 v[184:187], v1, s[8:11], s48 offen sc1
    s_waitcnt vmcnt(14)
    v_mfma_f32_32x32x16_bf16 v[64:79], a[12:15], v[124:127], v[64:79]
    v_rcp_f32 v228, v228
    v_mul_f32 v147, v147, v227
    v_rcp_f32 v229, v229
    v_mul_f32 v148, v148, v228
    v_mfma_f32_32x32x16_bf16 v[80:95], a[124:127], v[124:127], v[80:95]
    v_rcp_f32 v230, v230
    v_mul_f32 v149, v149, v229
    v_rcp_f32 v231, v231
    s_waitcnt vmcnt(13)
    v_mfma_f32_32x32x16_bf16 v[48:63], a[124:127], v[120:123], v[48:63]
    v_mul_f32 v150, v150, v230
    v_mul_f32 v151, v151, v231
    v_cvt_pk_bf16_f32 v240, v144, v145
    v_cvt_pk_bf16_f32 v241, v146, v147
    v_cvt_pk_bf16_f32 v242, v148, v149
    v_cvt_pk_bf16_f32 v243, v150, v151
    v_mfma_f32_32x32x16_bf16 v[32:47], a[12:15], v[120:123], v[32:47]
    s_add_u32 s48, s36, 16384
    buffer_load_dwordx4 v[196:199], v1, s[8:11], s48 offen sc1
    s_add_u32 s48, s35, 16384
    buffer_load_dwordx4 v[192:195], v1, s[8:11], s48 offen sc1
    s_waitcnt vmcnt(14)
    v_mfma_f32_32x32x16_bf16 v[64:79], a[28:31], v[132:135], v[64:79]
    buffer_store_dwordx4 v[240:243], v1, s[8:11], s61 offen offset:2048 sc1
    v_mfma_f32_32x32x16_bf16 v[80:95], a[140:143], v[132:135], v[80:95]
    s_waitcnt vmcnt(14)
    v_mfma_f32_32x32x16_bf16 v[48:63], a[140:143], v[128:131], v[48:63]
    v_mfma_f32_32x32x16_bf16 v[32:47], a[28:31], v[128:131], v[32:47]
    s_add_u32 s48, s36, 17408
    buffer_load_dwordx4 v[204:207], v1, s[8:11], s48 offen sc1
    s_add_u32 s48, s35, 17408
    buffer_load_dwordx4 v[200:203], v1, s[8:11], s48 offen sc1
    s_waitcnt vmcnt(15)
    v_mfma_f32_32x32x16_bf16 v[64:79], a[32:35], v[140:143], v[64:79]
    v_mfma_f32_32x32x16_bf16 v[80:95], a[144:147], v[140:143], v[80:95]
    s_waitcnt vmcnt(14)
    v_mfma_f32_32x32x16_bf16 v[48:63], a[144:147], v[136:139], v[48:63]
    v_mfma_f32_32x32x16_bf16 v[32:47], a[32:35], v[136:139], v[32:47]
    s_add_u32 s48, s36, 21504
    buffer_load_dwordx4 v[212:215], v1, s[8:11], s48 offen sc1
    s_add_u32 s48, s35, 21504
    buffer_load_dwordx4 v[208:211], v1, s[8:11], s48 offen sc1
    buffer_load_dword v19, v10, s[8:11], s34 offen sc1
    s_waitcnt vmcnt(15)
    v_mfma_f32_32x32x16_bf16 v[64:79], a[36:39], v[164:167], v[64:79]
    v_mfma_f32_32x32x16_bf16 v[80:95], a[148:151], v[164:167], v[80:95]
    s_waitcnt vmcnt(14)
    v_mfma_f32_32x32x16_bf16 v[48:63], a[148:151], v[160:163], v[48:63]
    v_mov_b32 v18, 3
    s_waitcnt vmcnt(5)
    s_mov_b64 exec, 1
    buffer_store_dword v18, v11, s[8:11], s33 offen
    s_mov_b64 exec, -1
    v_mfma_f32_32x32x16_bf16 v[32:47], a[36:39], v[160:163], v[32:47]
    s_add_u32 s48, s36, 22528
    buffer_load_dwordx4 v[220:223], v1, s[8:11], s48 offen sc1
    s_add_u32 s48, s35, 22528
    buffer_load_dwordx4 v[216:219], v1, s[8:11], s48 offen sc1
    v_mfma_f32_32x32x16_bf16 v[64:79], a[40:43], v[172:175], v[64:79]
    s_mul_i32 s50, s55, 28
    s_lshl_b32 s49, s54, 1
    s_add_u32 s50, s50, s49
    s_lshl_b32 s50, s50, 10
    s_add_u32 s50, s50, s39
    buffer_load_dwordx4 v[232:235], v1, s[8:11], s50 offen sc1
    v_mfma_f32_32x32x16_bf16 v[80:95], a[152:155], v[172:175], v[80:95]
    buffer_load_dwordx4 v[236:239], v1, s[8:11], s50 offen offset:1024 sc1
    s_mul_i32 s51, s55, 3584
    s_add_u32 s51, s51, s40
    buffer_load_dwordx2 v[144:145], v6, s[8:11], s51 offen offset:0 sc1
    buffer_load_dwordx2 v[146:147], v6, s[8:11], s51 offen offset:256 sc1
    v_mfma_f32_32x32x16_bf16 v[48:63], a[152:155], v[168:171], v[48:63]
    buffer_load_dwordx2 v[148:149], v6, s[8:11], s51 offen offset:512 sc1
    buffer_load_dwordx2 v[150:151], v6, s[8:11], s51 offen offset:768 sc1
    buffer_load_dwordx2 v[152:153], v6, s[8:11], s51 offen offset:1024 sc1
    buffer_load_dwordx2 v[154:155], v6, s[8:11], s51 offen offset:1280 sc1
    buffer_load_dwordx2 v[156:157], v6, s[8:11], s51 offen offset:1536 sc1
    v_mfma_f32_32x32x16_bf16 v[32:47], a[40:43], v[168:171], v[32:47]
    s_add_u32 s48, s36, 23552
    buffer_load_dwordx4 v[100:103], v1, s[8:11], s48 offen sc1
    s_add_u32 s48, s35, 23552
    buffer_load_dwordx4 v[96:99], v1, s[8:11], s48 offen sc1
    v_mfma_f32_32x32x16_bf16 v[64:79], a[56:59], v[180:183], v[64:79]
    v_mfma_f32_32x32x16_bf16 v[80:95], a[168:171], v[180:183], v[80:95]
    v_mfma_f32_32x32x16_bf16 v[48:63], a[168:171], v[176:179], v[48:63]
    v_mfma_f32_32x32x16_bf16 v[32:47], a[56:59], v[176:179], v[32:47]
    s_add_u32 s48, s36, 24576
    buffer_load_dwordx4 v[108:111], v1, s[8:11], s48 offen sc1
    s_add_u32 s48, s35, 24576
    buffer_load_dwordx4 v[104:107], v1, s[8:11], s48 offen sc1
    v_mfma_f32_32x32x16_bf16 v[64:79], a[60:63], v[188:191], v[64:79]
    v_mfma_f32_32x32x16_bf16 v[80:95], a[172:175], v[188:191], v[80:95]
    v_mfma_f32_32x32x16_bf16 v[48:63], a[172:175], v[184:187], v[48:63]
    v_mfma_f32_32x32x16_bf16 v[32:47], a[60:63], v[184:187], v[32:47]
    s_waitcnt vmcnt(16)
    v_cmp_gt_u32 vcc, 2, v19
    s_nop 1
    s_cbranch_vccnz hwait_38
hok_37:
    s_add_u32 s48, s36, 4096
    buffer_load_dwordx4 v[116:119], v1, s[8:11], s48 offen sc1
    s_add_u32 s48, s35, 4096
    buffer_load_dwordx4 v[112:115], v1, s[8:11], s48 offen sc1
    v_mfma_f32_32x32x16_bf16 v[64:79], a[64:67], v[196:199], v[64:79]
    v_mfma_f32_32x32x16_bf16 v[80:95], a[176:179], v[196:199], v[80:95]
    v_mfma_f32_32x32x16_bf16 v[48:63], a[176:179], v[192:195], v[48:63]
    v_mfma_f32_32x32x16_bf16 v[32:47], a[64:67], v[192:195], v[32:47]
    s_add_u32 s48, s36, 5120
    buffer_load_dwordx4 v[124:127], v1, s[8:11], s48 offen sc1
    s_add_u32 s48, s35, 5120
    buffer_load_dwordx4 v[120:123], v1, s[8:11], s48 offen sc1
    v_mfma_f32_32x32x16_bf16 v[64:79], a[68:71], v[204:207], v[64:79]
    v_mfma_f32_32x32x16_bf16 v[80:95], a[180:183], v[204:207], v[80:95]
    v_mfma_f32_32x32x16_bf16 v[48:63], a[180:183], v[200:203], v[48:63]
    v_mfma_f32_32x32x16_bf16 v[32:47], a[68:71], v[200:203], v[32:47]
    s_add_u32 s48, s36, 11264
    buffer_load_dwordx4 v[132:135], v1, s[8:11], s48 offen sc1
    s_add_u32 s48, s35, 11264
    buffer_load_dwordx4 v[128:131], v1, s[8:11], s48 offen sc1
    v_mfma_f32_32x32x16_bf16 v[64:79], a[84:87], v[212:215], v[64:79]
    v_mfma_f32_32x32x16_bf16 v[80:95], a[196:199], v[212:215], v[80:95]
    v_mfma_f32_32x32x16_bf16 v[48:63], a[196:199], v[208:211], v[48:63]
    v_mfma_f32_32x32x16_bf16 v[32:47], a[84:87], v[208:211], v[32:47]
    s_add_u32 s48, s36, 12288
    buffer_load_dwordx4 v[140:143], v1, s[8:11], s48 offen sc1
    s_add_u32 s48, s35, 12288
    buffer_load_dwordx4 v[136:139], v1, s[8:11], s48 offen sc1
    s_waitcnt vmcnt(22)
    v_mfma_f32_32x32x16_bf16 v[64:79], a[88:91], v[220:223], v[64:79]
    s_waitcnt vmcnt(17)
    v_add_f32 v144, v144, v146
    v_add_f32 v145, v145, v147
    s_waitcnt vmcnt(16)
    v_add_f32 v144, v144, v148
    v_add_f32 v145, v145, v149
    v_mfma_f32_32x32x16_bf16 v[80:95], a[200:203], v[220:223], v[80:95]
    s_waitcnt vmcnt(15)
    v_add_f32 v144, v144, v150
    v_add_f32 v145, v145, v151
    s_waitcnt vmcnt(14)
    v_add_f32 v144, v144, v152
    v_mfma_f32_32x32x16_bf16 v[48:63], a[200:203], v[216:219], v[48:63]
    v_add_f32 v145, v145, v153
    s_waitcnt vmcnt(13)
    v_add_f32 v144, v144, v154
    v_add_f32 v145, v145, v155
    s_waitcnt vmcnt(12)
    v_add_f32 v144, v144, v156
    v_mfma_f32_32x32x16_bf16 v[32:47], a[88:91], v[216:219], v[32:47]
    s_add_u32 s48, s36, 18432
    buffer_load_dwordx4 v[164:167], v1, s[8:11], s48 offen sc1
    s_add_u32 s48, s35, 18432
    buffer_load_dwordx4 v[160:163], v1, s[8:11], s48 offen sc1
    buffer_load_dword v19, v10, s[8:11], s34 offen sc1
    s_waitcnt vmcnt(14)
    v_mfma_f32_32x32x16_bf16 v[64:79], a[92:95], v[100:103], v[64:79]
    v_add_f32 v145, v145, v157
    v_mov_b32 v22, v144
    v_mov_b32 v23, v145
    s_nop 0
    v_permlane32_swap_b32 v144, v22
    v_permlane32_swap_b32 v145, v23
    v_mfma_f32_32x32x16_bf16 v[80:95], a[204:207], v[100:103], v[80:95]
    v_add_f32 v144, v144, v22
    v_add_f32 v145, v145, v23
    v_mul_f32 v144, 3138537765, v144
    v_mul_f32 v145, 991054117, v145
    v_fma_f32 v145, -v144, v144, v145
    s_waitcnt vmcnt(13)
    v_mfma_f32_32x32x16_bf16 v[48:63], a[204:207], v[96:99], v[48:63]
    v_max_f32 v145, 0, v145
    v_cvt_pk_bf16_f32 v20, v144, v144
    v_cvt_pk_bf16_f32 v23, v145, v145
    v_and_b32 v23, 0xffff0000, v23
    v_add_f32 v23, 925353388, v23
    v_cvt_pk_bf16_f32 v23, v23, v23
    v_mfma_f32_32x32x16_bf16 v[32:47], a[92:95], v[96:99], v[32:47]
    v_and_b32 v23, 0xffff0000, v23
    s_add_u32 s48, s36, 19456
    buffer_load_dwordx4 v[172:175], v1, s[8:11], s48 offen sc1
    s_add_u32 s48, s35, 19456
    buffer_load_dwordx4 v[168:171], v1, s[8:11], s48 offen sc1
    s_waitcnt vmcnt(14)
    v_mfma_f32_32x32x16_bf16 v[64:79], a[96:99], v[108:111], v[64:79]
    v_sqrt_f32 v23, v23
    s_nop 0
    v_cvt_pk_bf16_f32 v23, v23, v23
    v_and_b32 v23, 0xffff0000, v23
    v_mfma_f32_32x32x16_bf16 v[80:95], a[208:211], v[108:111], v[80:95]
    v_rcp_f32 v21, v23
    s_nop 0
    v_mul_f32 v28, v21, v21
    v_mul_f32 v29, v21, v21
    s_waitcnt vmcnt(13)
    v_mfma_f32_32x32x16_bf16 v[48:63], a[208:211], v[104:107], v[48:63]
    v_lshlrev_b32 v240, 16, v232
    v_and_b32 v241, 0xffff0000, v232
    v_lshlrev_b32 v242, 16, v233
    v_and_b32 v243, 0xffff0000, v233
    v_lshlrev_b32 v244, 16, v234
    v_and_b32 v245, 0xffff0000, v234
    v_mfma_f32_32x32x16_bf16 v[32:47], a[96:99], v[104:107], v[32:47]
    v_lshlrev_b32 v246, 16, v235
    s_add_u32 s48, s36, 25600
    buffer_load_dwordx4 v[180:183], v1, s[8:11], s48 offen sc1
    s_add_u32 s48, s35, 25600
    buffer_load_dwordx4 v[176:179], v1, s[8:11], s48 offen sc1
    s_waitcnt vmcnt(14)
    v_mfma_f32_32x32x16_bf16 v[64:79], a[16:19], v[116:119], v[64:79]
    v_and_b32 v247, 0xffff0000, v235
    v_lshlrev_b32 v248, 16, v236
    v_and_b32 v249, 0xffff0000, v236
    v_lshlrev_b32 v250, 16, v237
    v_and_b32 v251, 0xffff0000, v237
    v_lshlrev_b32 v252, 16, v238
    v_mfma_f32_32x32x16_bf16 v[80:95], a[128:131], v[116:119], v[80:95]
    v_and_b32 v253, 0xffff0000, v238
    v_lshlrev_b32 v254, 16, v239
    v_and_b32 v255, 0xffff0000, v239
    s_waitcnt vmcnt(13)
    v_mfma_f32_32x32x16_bf16 v[48:63], a[128:131], v[112:115], v[48:63]
    s_mul_i32 s51, s3, 12288
    s_add_u32 s51, s51, 86016
    v_add_u32 v25, s51, v1
    s_lshl_b32 s53, s55, 7
    s_lshl_b32 s49, s54, 2
    s_add_u32 s53, s53, s49
    s_add_u32 s53, s53, 0
    v_mfma_f32_32x32x16_bf16 v[32:47], a[16:19], v[112:115], v[32:47]
    s_add_u32 s48, s36, 26624
    buffer_load_dwordx4 v[188:191], v1, s[8:11], s48 offen sc1
    s_add_u32 s48, s35, 26624
    buffer_load_dwordx4 v[184:187], v1, s[8:11], s48 offen sc1
    s_waitcnt vmcnt(14)
    v_mfma_f32_32x32x16_bf16 v[64:79], a[20:23], v[124:127], v[64:79]
    v_mfma_f32_32x32x16_bf16 v[80:95], a[132:135], v[124:127], v[80:95]
    s_waitcnt vmcnt(13)
    v_mfma_f32_32x32x16_bf16 v[48:63], a[132:135], v[120:123], v[48:63]
    v_mfma_f32_32x32x16_bf16 v[32:47], a[20:23], v[120:123], v[32:47]
    s_waitcnt vmcnt(6)
    v_cmp_gt_u32 vcc, 3, v19
    s_nop 1
    s_cbranch_vccnz hwait_42
hok_41:
    s_add_u32 s48, s36, 6144
    buffer_load_dwordx4 v[196:199], v1, s[8:11], s48 offen sc1
    s_add_u32 s48, s35, 6144
    buffer_load_dwordx4 v[192:195], v1, s[8:11], s48 offen sc1
    v_mfma_f32_32x32x16_bf16 v[64:79], a[44:47], v[132:135], v[64:79]
    v_mfma_f32_32x32x16_bf16 v[80:95], a[156:159], v[132:135], v[80:95]
    v_mfma_f32_32x32x16_bf16 v[48:63], a[156:159], v[128:131], v[48:63]
    v_mfma_f32_32x32x16_bf16 v[32:47], a[44:47], v[128:131], v[32:47]
    s_add_u32 s48, s36, 13312
    buffer_load_dwordx4 v[204:207], v1, s[8:11], s48 offen sc1
    s_add_u32 s48, s35, 13312
    buffer_load_dwordx4 v[200:203], v1, s[8:11], s48 offen sc1
    v_mfma_f32_32x32x16_bf16 v[64:79], a[48:51], v[140:143], v[64:79]
    v_mfma_f32_32x32x16_bf16 v[80:95], a[160:163], v[140:143], v[80:95]
    v_mfma_f32_32x32x16_bf16 v[48:63], a[160:163], v[136:139], v[48:63]
    v_mfma_f32_32x32x16_bf16 v[32:47], a[48:51], v[136:139], v[32:47]
    s_add_u32 s48, s36, 20480
    buffer_load_dwordx4 v[212:215], v1, s[8:11], s48 offen sc1
    s_add_u32 s48, s35, 20480
    buffer_load_dwordx4 v[208:211], v1, s[8:11], s48 offen sc1
    v_mfma_f32_32x32x16_bf16 v[64:79], a[72:75], v[164:167], v[64:79]
    v_mfma_f32_32x32x16_bf16 v[80:95], a[184:187], v[164:167], v[80:95]
    v_mfma_f32_32x32x16_bf16 v[48:63], a[184:187], v[160:163], v[48:63]
    v_mfma_f32_32x32x16_bf16 v[32:47], a[72:75], v[160:163], v[32:47]
    s_add_u32 s48, s36, 27648
    buffer_load_dwordx4 v[220:223], v1, s[8:11], s48 offen sc1
    s_add_u32 s48, s35, 27648
    buffer_load_dwordx4 v[216:219], v1, s[8:11], s48 offen sc1
    s_waitcnt vmcnt(13)
    v_mfma_f32_32x32x16_bf16 v[64:79], a[76:79], v[172:175], v[64:79]
    v_mfma_f32_32x32x16_bf16 v[80:95], a[188:191], v[172:175], v[80:95]
    s_waitcnt vmcnt(12)
    v_mfma_f32_32x32x16_bf16 v[48:63], a[188:191], v[168:171], v[48:63]
    s_barrier
    v_mfma_f32_32x32x16_bf16 v[32:47], a[76:79], v[168:171], v[32:47]
    s_waitcnt vmcnt(11)
    v_mfma_f32_32x32x16_bf16 v[64:79], a[100:103], v[180:183], v[64:79]
    s_add_u32 m0, s28, 0
    s_add_u32 s24, s27, 0
    buffer_load_dwordx4 v1, s[8:11], s24 offen offset:0 lds
    buffer_load_dwordx4 v1, s[8:11], s24 offen offset:1024 lds
    buffer_load_dwordx4 v1, s[8:11], s24 offen offset:2048 lds
    buffer_load_dwordx4 v1, s[8:11], s24 offen offset:3072 lds
    v_mfma_f32_32x32x16_bf16 v[80:95], a[212:215], v[180:183], v[80:95]
    s_waitcnt vmcnt(14)
    v_mfma_f32_32x32x16_bf16 v[48:63], a[212:215], v[176:179], v[48:63]
    s_add_u32 m0, s28, 4096
    s_add_u32 s24, s27, 4096
    buffer_load_dwordx4 v1, s[8:11], s24 offen offset:0 lds
    buffer_load_dwordx4 v1, s[8:11], s24 offen offset:1024 lds
    buffer_load_dwordx4 v1, s[8:11], s24 offen offset:2048 lds
    buffer_load_dwordx4 v1, s[8:11], s24 offen offset:3072 lds
    v_mfma_f32_32x32x16_bf16 v[32:47], a[100:103], v[176:179], v[32:47]
    s_waitcnt vmcnt(17)
    v_mfma_f32_32x32x16_bf16 v[64:79], a[104:107], v[188:191], v[64:79]
    s_add_u32 m0, s28, 8192
    s_add_u32 s24, s27, 8192
    buffer_load_dwordx4 v1, s[8:11], s24 offen offset:0 lds
    buffer_load_dwordx4 v1, s[8:11], s24 offen offset:1024 lds
    buffer_load_dwordx4 v1, s[8:11], s24 offen offset:2048 lds
    buffer_load_dwordx4 v1, s[8:11], s24 offen offset:3072 lds
    v_mfma_f32_32x32x16_bf16 v[80:95], a[216:219], v[188:191], v[80:95]
    s_waitcnt vmcnt(20)
    v_mfma_f32_32x32x16_bf16 v[48:63], a[216:219], v[184:187], v[48:63]
    s_add_u32 m0, s28, 12288
    s_add_u32 s24, s27, 12288
    buffer_load_dwordx4 v1, s[8:11], s24 offen offset:0 lds
    buffer_load_dwordx4 v1, s[8:11], s24 offen offset:1024 lds
    buffer_load_dwordx4 v1, s[8:11], s24 offen offset:2048 lds
    buffer_load_dwordx4 v1, s[8:11], s24 offen offset:3072 lds
    s_waitcnt vmcnt(23)
    v_mfma_f32_32x32x16_bf16 v[64:79], a[24:27], v[196:199], v[64:79]
    v_mfma_f32_32x32x16_bf16 v[80:95], a[136:139], v[196:199], v[80:95]
    s_add_u32 m0, s28, 16384
    s_add_u32 s24, s27, 16384
    buffer_load_dwordx4 v1, s[8:11], s24 offen offset:0 lds
    buffer_load_dwordx4 v1, s[8:11], s24 offen offset:1024 lds
    buffer_load_dwordx4 v1, s[8:11], s24 offen offset:2048 lds
    buffer_load_dwordx4 v1, s[8:11], s24 offen offset:3072 lds
    s_waitcnt vmcnt(26)
    v_mfma_f32_32x32x16_bf16 v[48:63], a[136:139], v[192:195], v[48:63]
    s_waitcnt vmcnt(25)
    v_mfma_f32_32x32x16_bf16 v[64:79], a[52:55], v[204:207], v[64:79]
    s_add_u32 m0, s28, 20480
    s_add_u32 s24, s27, 20480
    buffer_load_dwordx4 v1, s[8:11], s24 offen offset:0 lds
    v_mfma_f32_32x32x16_bf16 v[80:95], a[164:167], v[204:207], v[80:95]
    s_waitcnt vmcnt(25)
    v_mfma_f32_32x32x16_bf16 v[48:63], a[164:167], v[200:203], v[48:63]
    s_waitcnt vmcnt(24)
    v_mfma_f32_32x32x16_bf16 v[64:79], a[80:83], v[212:215], v[64:79]
    v_mfma_f32_32x32x16_bf16 v[80:95], a[192:195], v[212:215], v[80:95]
    s_waitcnt vmcnt(23)
    v_mfma_f32_32x32x16_bf16 v[48:63], a[192:195], v[208:211], v[48:63]
    s_waitcnt vmcnt(22)
    v_mfma_f32_32x32x16_bf16 v[64:79], a[108:111], v[220:223], v[64:79]
    v_mfma_f32_32x32x16_bf16 v[80:95], a[220:223], v[220:223], v[80:95]
    s_waitcnt vmcnt(21)
    v_mfma_f32_32x32x16_bf16 v[48:63], a[220:223], v[216:219], v[48:63]
    v_mfma_f32_32x32x16_bf16 v[32:47], a[104:107], v[184:187], v[32:47]
    s_xor_b32 s48, s3, 2
    s_mul_i32 s48, s48, 12288
    s_add_u32 s48, s48, 90112
    v_add_u32 v23, s48, v1
    s_nop 3
    ds_write_b128 v23, v[64:67] offset:0
    v_mfma_f32_32x32x16_bf16 v[32:47], a[24:27], v[192:195], v[32:47]
    ds_write_b128 v23, v[68:71] offset:1024
    ds_write_b128 v23, v[72:75] offset:2048
    ds_write_b128 v23, v[76:79] offset:3072
    v_mfma_f32_32x32x16_bf16 v[32:47], a[52:55], v[200:203], v[32:47]
    s_xor_b32 s48, s3, 3
    s_mul_i32 s48, s48, 12288
    s_add_u32 s48, s48, 94208
    v_add_u32 v24, s48, v1
    ds_write_b128 v24, v[80:83] offset:0
    v_mfma_f32_32x32x16_bf16 v[32:47], a[80:83], v[208:211], v[32:47]
    ds_write_b128 v24, v[84:87] offset:1024
    ds_write_b128 v24, v[88:91] offset:2048
    ds_write_b128 v24, v[92:95] offset:3072
    v_mfma_f32_32x32x16_bf16 v[32:47], a[108:111], v[216:219], v[32:47]
    s_xor_b32 s48, s3, 1
    s_mul_i32 s48, s48, 12288
    s_add_u32 s48, s48, 86016
    v_add_u32 v22, s48, v1
    ds_write_b128 v22, v[48:51] offset:0
    ds_write_b128 v22, v[52:55] offset:1024
    ds_write_b128 v22, v[56:59] offset:2048
    ds_write_b128 v22, v[60:63] offset:3072
    s_waitcnt lgkmcnt(0)
    s_barrier
    ds_read_b128 v[48:51], v25 offset:0
    ds_read_b128 v[64:67], v25 offset:4096
    ds_read_b128 v[80:83], v25 offset:8192
    ds_read_b128 v[52:55], v25 offset:1024
    ds_read_b128 v[68:71], v25 offset:5120
    ds_read_b128 v[84:87], v25 offset:9216
    ds_read_b128 v[56:59], v25 offset:2048
    ds_read_b128 v[72:75], v25 offset:6144
    ds_read_b128 v[88:91], v25 offset:10240
    ds_read_b128 v[60:63], v25 offset:3072
    ds_read_b128 v[76:79], v25 offset:7168
    ds_read_b128 v[92:95], v25 offset:11264
    s_waitcnt lgkmcnt(9)
    v_pk_add_f32 v[48:49], v[48:49], v[64:65]
    v_pk_add_f32 v[32:33], v[32:33], v[80:81]
    v_pk_add_f32 v[50:51], v[50:51], v[66:67]
    v_pk_add_f32 v[34:35], v[34:35], v[82:83]
    v_pk_add_f32 v[32:33], v[32:33], v[48:49]
    v_pk_add_f32 v[34:35], v[34:35], v[50:51]
    v_pk_fma_f32 v[32:33], v[32:33], v[28:29], v[240:241]
    v_pk_fma_f32 v[34:35], v[34:35], v[28:29], v[242:243]
    v_cvt_pk_bf16_f32 v232, v32, v33
    v_cvt_pk_bf16_f32 v233, v34, v35
    s_waitcnt lgkmcnt(6)
    v_pk_add_f32 v[52:53], v[52:53], v[68:69]
    v_pk_add_f32 v[36:37], v[36:37], v[84:85]
    v_pk_add_f32 v[54:55], v[54:55], v[70:71]
    v_pk_add_f32 v[38:39], v[38:39], v[86:87]
    v_pk_add_f32 v[36:37], v[36:37], v[52:53]
    v_pk_add_f32 v[38:39], v[38:39], v[54:55]
    v_pk_fma_f32 v[36:37], v[36:37], v[28:29], v[244:245]
    v_pk_fma_f32 v[38:39], v[38:39], v[28:29], v[246:247]
    v_cvt_pk_bf16_f32 v234, v36, v37
    v_cvt_pk_bf16_f32 v235, v38, v39
    s_waitcnt lgkmcnt(3)
    v_pk_add_f32 v[56:57], v[56:57], v[72:73]
    v_pk_add_f32 v[40:41], v[40:41], v[88:89]
    v_pk_add_f32 v[58:59], v[58:59], v[74:75]
    v_pk_add_f32 v[42:43], v[42:43], v[90:91]
    v_pk_add_f32 v[40:41], v[40:41], v[56:57]
    v_pk_add_f32 v[42:43], v[42:43], v[58:59]
    v_pk_fma_f32 v[40:41], v[40:41], v[28:29], v[248:249]
    v_pk_fma_f32 v[42:43], v[42:43], v[28:29], v[250:251]
    v_cvt_pk_bf16_f32 v236, v40, v41
    v_cvt_pk_bf16_f32 v237, v42, v43
    s_waitcnt lgkmcnt(0)
    v_pk_add_f32 v[60:61], v[60:61], v[76:77]
    v_pk_add_f32 v[44:45], v[44:45], v[92:93]
    v_pk_add_f32 v[62:63], v[62:63], v[78:79]
    v_pk_add_f32 v[46:47], v[46:47], v[94:95]
    v_pk_add_f32 v[44:45], v[44:45], v[60:61]
    v_pk_add_f32 v[46:47], v[46:47], v[62:63]
    v_pk_fma_f32 v[44:45], v[44:45], v[28:29], v[252:253]
    v_pk_fma_f32 v[46:47], v[46:47], v[28:29], v[254:255]
    v_cvt_pk_bf16_f32 v238, v44, v45
    v_cvt_pk_bf16_f32 v239, v46, v47
    buffer_store_dwordx4 v[232:235], v1, s[8:11], s101 offen
    buffer_store_dwordx4 v[236:239], v1, s[8:11], s101 offen offset:1024
    v_mov_b32 v22, 0
    v_mov_b32 v23, 0
    v_dot2_f32_bf16 v22, v232, v8, v22
    v_dot2_f32_bf16 v23, v232, v232, v23
    v_dot2_f32_bf16 v22, v233, v8, v22
    v_dot2_f32_bf16 v23, v233, v233, v23
    v_dot2_f32_bf16 v22, v234, v8, v22
    v_dot2_f32_bf16 v23, v234, v234, v23
    v_dot2_f32_bf16 v22, v235, v8, v22
    v_dot2_f32_bf16 v23, v235, v235, v23
    v_dot2_f32_bf16 v22, v236, v8, v22
    v_dot2_f32_bf16 v23, v236, v236, v23
    v_dot2_f32_bf16 v22, v237, v8, v22
    v_dot2_f32_bf16 v23, v237, v237, v23
    v_dot2_f32_bf16 v22, v238, v8, v22
    v_dot2_f32_bf16 v23, v238, v238, v23
    v_dot2_f32_bf16 v22, v239, v8, v22
    v_dot2_f32_bf16 v23, v239, v239, v23
    s_nop 2
    v_permlane32_swap_b32 v22, v23
    v_add_f32 v22, v22, v23
    buffer_store_dword v22, v5, s[8:11], s1 offen
    v_mov_b32 v18, 1
    s_waitcnt vmcnt(0)
    s_mov_b64 exec, 1
    buffer_store_dword v18, v11, s[8:11], s53 offen
    s_mov_b64 exec, -1
p5_join_36:
    s_waitcnt vmcnt(0) lgkmcnt(0)
    s_barrier
    s_mov_b32 s7, 1
    s_mov_b32 s44, 2
    s_mov_b32 s39, 7303168
    s_mov_b32 s42, 7303168
    s_mov_b32 s40, 192512
    s_mov_b32 s43, 421888
    s_mov_b32 s37, 15429632
    s_mov_b32 s38, 9138176
    s_mov_b32 s41, 19623936
    s_lshl_b32 s100, s5, 6
    s_add_u32 s100, s100, s6
    s_lshl_b32 s100, s100, 11
    s_add_u32 s100, s100, s38
    s_mul_i32 s61, s6, 112
    s_mul_i32 s53, s5, 7
    s_add_u32 s61, s61, s53
    s_lshl_b32 s61, s61, 10
    s_add_u32 s61, s61, s41
    s_mul_i32 s101, s55, 28
    s_lshl_b32 s49, s54, 1
    s_add_u32 s101, s101, s49
    s_lshl_b32 s101, s101, 10
    s_add_u32 s101, s101, s39
    s_mul_i32 s1, s55, 14
    s_add_u32 s1, s1, s54
    s_lshl_b32 s1, s1, 8
    s_add_u32 s1, s1, s40
    s_lshl_b32 s52, s6, 7
    s_add_u32 s52, s52, 0
    s_mul_i32 s51, s6, 28672
    s_add_u32 s51, s51, s42
    ds_read_b128 v[192:195], v1 offset:28672
    ds_read_b128 v[196:199], v7 offset:0
    ds_read_b128 v[200:203], v1 offset:0
    ds_read_b128 v[204:207], v1 offset:29696
    v_min_u32 v19, 15, v2
    v_lshlrev_b32 v19, 7, v19
    s_add_u32 s0, s100, 0
    buffer_load_dword v0, v19, s[8:11], s0 offen sc1
    s_mov_b32 s47, 0
poll_45:
    buffer_load_dword v18, v9, s[8:11], s52 offen sc1
    s_add_u32 s47, s47, 1
    s_cmp_gt_u32 s47, 400000
    s_cbranch_scc1 polled_46
    s_waitcnt vmcnt(0)
    v_cmp_gt_u32 vcc, 1, v18
    s_nop 1
    s_cbranch_vccnz poll_45
polled_46:
    s_waitcnt vmcnt(0)
    s_add_u32 s50, s51, 0
    buffer_load_dwordx4 v[32:35], v1, s[8:11], s50 offen offset:0 sc1
    buffer_load_dwordx4 v[36:39], v1, s[8:11], s50 offen offset:1024 sc1
    buffer_load_dwordx4 v[40:43], v1, s[8:11], s50 offen offset:2048 sc1
    buffer_load_dwordx4 v[44:47], v1, s[8:11], s50 offen offset:3072 sc1
    s_mul_i32 s48, s6, 3584
    s_add_u32 s48, s48, s43
    buffer_load_dwordx2 v[216:217], v6, s[8:11], s48 offen offset:0 sc1
    buffer_load_dwordx2 v[218:219], v6, s[8:11], s48 offen offset:256 sc1
    buffer_load_dwordx2 v[220:221], v6, s[8:11], s48 offen offset:512 sc1
    buffer_load_dwordx2 v[222:223], v6, s[8:11], s48 offen offset:768 sc1
    buffer_load_dwordx2 v[224:225], v6, s[8:11], s48 offen offset:1024 sc1
    buffer_load_dwordx2 v[226:227], v6, s[8:11], s48 offen offset:1280 sc1
    buffer_load_dwordx2 v[228:229], v6, s[8:11], s48 offen offset:1536 sc1
    s_add_u32 s50, s51, 4096
    buffer_load_dwordx4 v[48:51], v1, s[8:11], s50 offen offset:0 sc1
    buffer_load_dwordx4 v[52:55], v1, s[8:11], s50 offen offset:1024 sc1
    buffer_load_dwordx4 v[56:59], v1, s[8:11], s50 offen offset:2048 sc1
    buffer_load_dwordx4 v[60:63], v1, s[8:11], s50 offen offset:3072 sc1
    s_add_u32 s50, s51, 8192
    buffer_load_dwordx4 v[64:67], v1, s[8:11], s50 offen offset:0 sc1
    buffer_load_dwordx4 v[68:71], v1, s[8:11], s50 offen offset:1024 sc1
    ds_read_b128 v[208:211], v7 offset:1024
    buffer_load_dwordx4 v[72:75], v1, s[8:11], s50 offen offset:2048 sc1
    s_waitcnt lgkmcnt(3)
    s_waitcnt vmcnt(17)
    v_mfma_f32_32x32x16_bf16 v[160:175], v[192:195], v[32:35], 0
    ds_read_b128 v[212:215], v1 offset:1024
    v_mfma_f32_32x32x16_bf16 v[176:191], v[32:35], v[196:199], 0
    ds_read_b128 v[192:195], v1 offset:30720
    s_waitcnt lgkmcnt(3)
    v_mfma_f32_32x32x16_bf16 v[144:159], v[200:203], v[32:35], 0
    ds_read_b128 v[196:199], v7 offset:2048
    buffer_load_dwordx4 v[76:79], v1, s[8:11], s50 offen offset:3072 sc1
    s_waitcnt vmcnt(17)
    v_mfma_f32_32x32x16_bf16 v[160:175], v[204:207], v[36:39], v[160:175]
    ds_read_b128 v[200:203], v1 offset:2048
    s_waitcnt lgkmcnt(3)
    v_mfma_f32_32x32x16_bf16 v[176:191], v[36:39], v[208:211], v[176:191]
    ds_read_b128 v[204:207], v1 offset:31744
    v_mfma_f32_32x32x16_bf16 v[144:159], v[212:215], v[36:39], v[144:159]
    ds_read_b128 v[208:211], v7 offset:3072
    s_add_u32 s50, s51, 12288
    buffer_load_dwordx4 v[80:83], v1, s[8:11], s50 offen offset:0 sc1
    s_waitcnt lgkmcnt(3)
    s_waitcnt vmcnt(17)
    v_mfma_f32_32x32x16_bf16 v[160:175], v[192:195], v[40:43], v[160:175]
    ds_read_b128 v[212:215], v1 offset:3072
    v_mfma_f32_32x32x16_bf16 v[176:191], v[40:43], v[196:199], v[176:191]
    ds_read_b128 v[192:195], v1 offset:32768
    s_waitcnt lgkmcnt(3)
    v_mfma_f32_32x32x16_bf16 v[144:159], v[200:203], v[40:43], v[144:159]
    s_waitcnt vmcnt(14)
    v_add_f32 v216, v216, v218
    v_add_f32 v217, v217, v219
    ds_read_b128 v[196:199], v7 offset:4096
    buffer_load_dwordx4 v[84:87], v1, s[8:11], s50 offen offset:1024 sc1
    v_mfma_f32_32x32x16_bf16 v[160:175], v[204:207], v[44:47], v[160:175]
    s_waitcnt vmcnt(14)
    v_add_f32 v216, v216, v220
    v_add_f32 v217, v217, v221
    s_waitcnt vmcnt(13)
    v_add_f32 v216, v216, v222
    ds_read_b128 v[200:203], v1 offset:4096
    s_waitcnt lgkmcnt(3)
    v_mfma_f32_32x32x16_bf16 v[176:191], v[44:47], v[208:211], v[176:191]
    v_add_f32 v217, v217, v223
    s_waitcnt vmcnt(12)
    v_add_f32 v216, v216, v224
    v_add_f32 v217, v217, v225
    s_waitcnt vmcnt(11)
    v_add_f32 v216, v216, v226
    ds_read_b128 v[204:207], v1 offset:33792
    v_mfma_f32_32x32x16_bf16 v[144:159], v[212:215], v[44:47], v[144:159]
    v_add_f32 v217, v217, v227
    s_waitcnt vmcnt(10)
    v_add_f32 v216, v216, v228
    ds_read_b128 v[208:211], v7 offset:5120
    buffer_load_dwordx4 v[88:91], v1, s[8:11], s50 offen offset:2048 sc1
    s_waitcnt lgkmcnt(3)
    s_waitcnt vmcnt(10)
    v_mfma_f32_32x32x16_bf16 v[160:175], v[192:195], v[48:51], v[160:175]
    v_add_f32 v217, v217, v229
    v_mov_b32 v22, v216
    v_mov_b32 v23, v217
    s_nop 0
    v_permlane32_swap_b32 v216, v22
    ds_read_b128 v[212:215], v1 offset:5120
    v_mfma_f32_32x32x16_bf16 v[176:191], v[48:51], v[196:199], v[176:191]
    v_permlane32_swap_b32 v217, v23
    v_add_f32 v216, v216, v22
    v_add_f32 v217, v217, v23
    v_mul_f32 v216, 3138537765, v216
    ds_read_b128 v[192:195], v1 offset:34816
    s_waitcnt lgkmcnt(3)
    v_mfma_f32_32x32x16_bf16 v[144:159], v[200:203], v[48:51], v[144:159]
    v_mul_f32 v217, 991054117, v217
    v_fma_f32 v217, -v216, v216, v217
    v_max_f32 v217, 0, v217
    ds_read_b128 v[196:199], v7 offset:6144
    buffer_load_dwordx4 v[92:95], v1, s[8:11], s50 offen offset:3072 sc1
    s_waitcnt vmcnt(10)
    v_mfma_f32_32x32x16_bf16 v[160:175], v[204:207], v[52:55], v[160:175]
    v_cvt_pk_bf16_f32 v20, v216, v216
    v_cvt_pk_bf16_f32 v23, v217, v217
    v_and_b32 v23, 0xffff0000, v23
    v_add_f32 v23, 925353388, v23
    ds_read_b128 v[200:203], v1 offset:35840
    s_waitcnt lgkmcnt(3)
    v_mfma_f32_32x32x16_bf16 v[176:191], v[52:55], v[208:211], v[176:191]
    v_cvt_pk_bf16_f32 v23, v23, v23
    v_and_b32 v23, 0xffff0000, v23
    v_sqrt_f32 v23, v23
    s_nop 0
    v_cvt_pk_bf16_f32 v23, v23, v23
    ds_read_b128 v[204:207], v7 offset:7168
    v_mfma_f32_32x32x16_bf16 v[144:159], v[212:215], v[52:55], v[144:159]
    v_and_b32 v23, 0xffff0000, v23
    ds_read_b128 v[208:211], v1 offset:36864
    s_add_u32 s50, s51, 16384
    buffer_load_dwordx4 v[96:99], v1, s[8:11], s50 offen offset:0 sc1
    s_waitcnt lgkmcnt(3)
    s_waitcnt vmcnt(10)
    v_mfma_f32_32x32x16_bf16 v[160:175], v[192:195], v[56:59], v[160:175]
    v_rcp_f32 v21, v23
    v_mov_b32 v28, v20
    v_mov_b32 v29, v20
    v_mov_b32 v30, v20
    ds_read_b128 v[212:215], v7 offset:8192
    v_mfma_f32_32x32x16_bf16 v[176:191], v[56:59], v[196:199], v[176:191]
    v_mov_b32 v31, v20
    s_lshl_b32 s48, s3, 8
    ds_read_b128 v[192:195], v1 offset:37888
    buffer_load_dwordx4 v[100:103], v1, s[8:11], s50 offen offset:1024 sc1
    s_waitcnt lgkmcnt(3)
    s_waitcnt vmcnt(10)
    v_mfma_f32_32x32x16_bf16 v[160:175], v[200:203], v[60:63], v[160:175]
    s_add_u32 s48, s48, 143360
    v_lshlrev_b32 v22, 2, v3
    v_add_u32 v22, s48, v22
    ds_write_b32 v22, v21
    v_lshlrev_b32 v23, 4, v4
    ds_read_b128 v[196:199], v7 offset:9216
    v_mfma_f32_32x32x16_bf16 v[176:191], v[60:63], v[204:207], v[176:191]
    v_add_u32 v23, s48, v23
    ds_read_b128 v[240:243], v23 offset:0
    ds_read_b128 v[200:203], v1 offset:38912
    buffer_load_dwordx4 v[104:107], v1, s[8:11], s50 offen offset:2048 sc1
    s_waitcnt lgkmcnt(5)
    s_waitcnt vmcnt(10)
    v_mfma_f32_32x32x16_bf16 v[160:175], v[208:211], v[64:67], v[160:175]
    ds_read_b128 v[244:247], v23 offset:32
    ds_read_b128 v[248:251], v23 offset:64
    ds_read_b128 v[252:255], v23 offset:96
    s_lshl_b32 s48, s5, 6
    s_add_u32 s48, s48, s6
    ds_read_b128 v[204:207], v7 offset:10240
    v_mfma_f32_32x32x16_bf16 v[176:191], v[64:67], v[212:215], v[176:191]
    s_lshl_b32 s52, s48, 2
    s_add_u32 s52, s52, 32768
    ds_read_b128 v[208:211], v1 offset:39936
    buffer_load_dwordx4 v[108:111], v1, s[8:11], s50 offen offset:3072 sc1
    s_waitcnt lgkmcnt(7)
    s_waitcnt vmcnt(10)
    v_mfma_f32_32x32x16_bf16 v[160:175], v[192:195], v[68:71], v[160:175]
    s_lshl_b32 s53, s48, 12
    s_add_u32 s53, s53, s37
    ds_read_b128 v[212:215], v7 offset:11264
    v_mfma_f32_32x32x16_bf16 v[176:191], v[68:71], v[196:199], v[176:191]
    ds_read_b128 v[192:195], v1 offset:40960
    s_add_u32 s50, s51, 20480
    buffer_load_dwordx4 v[112:115], v1, s[8:11], s50 offen offset:0 sc1
    s_waitcnt lgkmcnt(3)
    s_waitcnt vmcnt(10)
    v_mfma_f32_32x32x16_bf16 v[160:175], v[200:203], v[72:75], v[160:175]
    ds_read_b128 v[196:199], v7 offset:12288
    v_mfma_f32_32x32x16_bf16 v[176:191], v[72:75], v[204:207], v[176:191]
    ds_read_b128 v[200:203], v1 offset:41984
    buffer_load_dwordx4 v[116:119], v1, s[8:11], s50 offen offset:1024 sc1
    s_waitcnt lgkmcnt(3)
    s_waitcnt vmcnt(10)
    v_mfma_f32_32x32x16_bf16 v[160:175], v[208:211], v[76:79], v[160:175]
    ds_read_b128 v[204:207], v7 offset:13312
    v_mfma_f32_32x32x16_bf16 v[176:191], v[76:79], v[212:215], v[176:191]
    ds_read_b128 v[208:211], v1 offset:43008
    buffer_load_dwordx4 v[120:123], v1, s[8:11], s50 offen offset:2048 sc1
    s_waitcnt lgkmcnt(3)
    s_waitcnt vmcnt(10)
    v_mfma_f32_32x32x16_bf16 v[160:175], v[192:195], v[80:83], v[160:175]
    ds_read_b128 v[212:215], v7 offset:14336
    v_mfma_f32_32x32x16_bf16 v[176:191], v[80:83], v[196:199], v[176:191]
    ds_read_b128 v[192:195], v1 offset:44032
    buffer_load_dwordx4 v[124:127], v1, s[8:11], s50 offen offset:3072 sc1
    s_waitcnt lgkmcnt(3)
    s_waitcnt vmcnt(10)
    v_mfma_f32_32x32x16_bf16 v[160:175], v[200:203], v[84:87], v[160:175]
    ds_read_b128 v[196:199], v7 offset:15360
    v_mfma_f32_32x32x16_bf16 v[176:191], v[84:87], v[204:207], v[176:191]
    ds_read_b128 v[200:203], v1 offset:45056
    s_add_u32 s50, s51, 24576
    buffer_load_dwordx4 v[128:131], v1, s[8:11], s50 offen offset:0 sc1
    s_waitcnt lgkmcnt(3)
    s_waitcnt vmcnt(10)
    v_mfma_f32_32x32x16_bf16 v[160:175], v[208:211], v[88:91], v[160:175]
    ds_read_b128 v[204:207], v7 offset:16384
    v_mfma_f32_32x32x16_bf16 v[176:191], v[88:91], v[212:215], v[176:191]
    ds_read_b128 v[208:211], v1 offset:46080
    buffer_load_dwordx4 v[132:135], v1, s[8:11], s50 offen offset:1024 sc1
    s_waitcnt lgkmcnt(3)
    s_waitcnt vmcnt(10)
    v_mfma_f32_32x32x16_bf16 v[160:175], v[192:195], v[92:95], v[160:175]
    ds_read_b128 v[212:215], v7 offset:17408
    v_mfma_f32_32x32x16_bf16 v[176:191], v[92:95], v[196:199], v[176:191]
    ds_read_b128 v[192:195], v1 offset:47104
    buffer_load_dwordx4 v[136:139], v1, s[8:11], s50 offen offset:2048 sc1
    s_waitcnt lgkmcnt(3)
    s_waitcnt vmcnt(10)
    v_mfma_f32_32x32x16_bf16 v[160:175], v[200:203], v[96:99], v[160:175]
    ds_read_b128 v[196:199], v7 offset:18432
    v_mfma_f32_32x32x16_bf16 v[176:191], v[96:99], v[204:207], v[176:191]
    ds_read_b128 v[200:203], v1 offset:48128
    buffer_load_dwordx4 v[140:143], v1, s[8:11], s50 offen offset:3072 sc1
    s_waitcnt lgkmcnt(3)
    s_waitcnt vmcnt(10)
    v_mfma_f32_32x32x16_bf16 v[160:175], v[208:211], v[100:103], v[160:175]
    ds_read_b128 v[204:207], v7 offset:19456
    v_mfma_f32_32x32x16_bf16 v[176:191], v[100:103], v[212:215], v[176:191]
    ds_read_b128 v[208:211], v1 offset:49152
    s_waitcnt lgkmcnt(3)
    s_waitcnt vmcnt(9)
    v_mfma_f32_32x32x16_bf16 v[160:175], v[192:195], v[104:107], v[160:175]
    ds_read_b128 v[212:215], v7 offset:20480
    v_mfma_f32_32x32x16_bf16 v[176:191], v[104:107], v[196:199], v[176:191]
    ds_read_b128 v[192:195], v1 offset:50176
    s_waitcnt lgkmcnt(3)
    s_waitcnt vmcnt(8)
    v_mfma_f32_32x32x16_bf16 v[160:175], v[200:203], v[108:111], v[160:175]
    ds_read_b128 v[196:199], v7 offset:21504
    v_mfma_f32_32x32x16_bf16 v[176:191], v[108:111], v[204:207], v[176:191]
    ds_read_b128 v[200:203], v1 offset:51200
    s_waitcnt lgkmcnt(3)
    s_waitcnt vmcnt(7)
    v_mfma_f32_32x32x16_bf16 v[160:175], v[208:211], v[112:115], v[160:175]
    ds_read_b128 v[204:207], v7 offset:22528
    v_mfma_f32_32x32x16_bf16 v[176:191], v[112:115], v[212:215], v[176:191]
    ds_read_b128 v[208:211], v1 offset:52224
    s_waitcnt lgkmcnt(3)
    s_waitcnt vmcnt(6)
    v_mfma_f32_32x32x16_bf16 v[160:175], v[192:195], v[116:119], v[160:175]
    ds_read_b128 v[212:215], v7 offset:23552
    v_mfma_f32_32x32x16_bf16 v[176:191], v[116:119], v[196:199], v[176:191]
    ds_read_b128 v[192:195], v1 offset:53248
    s_waitcnt lgkmcnt(3)
    s_waitcnt vmcnt(5)
    v_mfma_f32_32x32x16_bf16 v[160:175], v[200:203], v[120:123], v[160:175]
    ds_read_b128 v[196:199], v7 offset:24576
    v_mfma_f32_32x32x16_bf16 v[176:191], v[120:123], v[204:207], v[176:191]
    ds_read_b128 v[200:203], v1 offset:54272
    s_waitcnt lgkmcnt(3)
    s_waitcnt vmcnt(4)
    v_mfma_f32_32x32x16_bf16 v[160:175], v[208:211], v[124:127], v[160:175]
    ds_read_b128 v[204:207], v7 offset:25600
    v_mfma_f32_32x32x16_bf16 v[176:191], v[124:127], v[212:215], v[176:191]
    ds_read_b128 v[208:211], v1 offset:55296
    s_waitcnt lgkmcnt(3)
    s_waitcnt vmcnt(3)
    v_mfma_f32_32x32x16_bf16 v[160:175], v[192:195], v[128:131], v[160:175]
    ds_read_b128 v[212:215], v7 offset:26624
    v_mfma_f32_32x32x16_bf16 v[176:191], v[128:131], v[196:199], v[176:191]
    ds_read_b128 v[192:195], v1 offset:56320
    s_waitcnt lgkmcnt(3)
    s_waitcnt vmcnt(2)
    v_mfma_f32_32x32x16_bf16 v[160:175], v[200:203], v[132:135], v[160:175]
    ds_read_b128 v[196:199], v7 offset:27648
    v_mfma_f32_32x32x16_bf16 v[176:191], v[132:135], v[204:207], v[176:191]
    ds_read_b128 v[200:203], v16 offset:10240
    s_waitcnt lgkmcnt(3)
    s_waitcnt vmcnt(1)
    v_mfma_f32_32x32x16_bf16 v[160:175], v[208:211], v[136:139], v[160:175]
    ds_read_b128 v[204:207], v16 offset:11264
    v_mfma_f32_32x32x16_bf16 v[176:191], v[136:139], v[212:215], v[176:191]
    ds_read_b128 v[208:211], v1 offset:6144
    s_waitcnt lgkmcnt(3)
    s_waitcnt vmcnt(0)
    v_mfma_f32_32x32x16_bf16 v[160:175], v[192:195], v[140:143], v[160:175]
    ds_read_b128 v[212:215], v1 offset:7168
    v_mfma_f32_32x32x16_bf16 v[176:191], v[140:143], v[196:199], v[176:191]
    ds_read_b128 v[192:195], v1 offset:8192
    s_waitcnt lgkmcnt(3)
    v_mfma_f32_32x32x16_bf16 v[160:175], v[200:203], v[28:31], v[160:175]
    ds_read_b128 v[196:199], v1 offset:9216
    v_mfma_f32_32x32x16_bf16 v[176:191], v[28:31], v[204:207], v[176:191]
    ds_read_b128 v[200:203], v1 offset:10240
    s_waitcnt lgkmcnt(3)
    v_mfma_f32_32x32x16_bf16 v[144:159], v[208:211], v[56:59], v[144:159]
    ds_read_b128 v[204:207], v1 offset:11264
    v_mfma_f32_32x32x16_bf16 v[144:159], v[212:215], v[60:63], v[144:159]
    s_nop 4
    v_mul_f32 v160, v21, v160
    ds_read_b128 v[208:211], v1 offset:12288
    s_waitcnt lgkmcnt(3)
    v_mfma_f32_32x32x16_bf16 v[144:159], v[192:195], v[64:67], v[144:159]
    v_mul_f32 v161, v21, v161
    v_mul_f32 v162, v21, v162
    v_mul_f32 v163, v21, v163
    v_mul_f32 v164, v21, v164
    v_mul_f32 v165, v21, v165
    ds_read_b128 v[212:215], v1 offset:13312
    v_mfma_f32_32x32x16_bf16 v[144:159], v[196:199], v[68:71], v[144:159]
    v_mul_f32 v166, v21, v166
    v_mul_f32 v167, v21, v167
    v_mul_f32 v168, v21, v168
    v_mul_f32 v169, v21, v169
    ds_read_b128 v[192:195], v1 offset:14336
    s_waitcnt lgkmcnt(3)
    v_mfma_f32_32x32x16_bf16 v[144:159], v[200:203], v[72:75], v[144:159]
    v_mul_f32 v170, v21, v170
    v_mul_f32 v171, v21, v171
    v_mul_f32 v172, v21, v172
    v_mul_f32 v173, v21, v173
    v_mul_f32 v174, v21, v174
    ds_read_b128 v[196:199], v1 offset:15360
    v_mfma_f32_32x32x16_bf16 v[144:159], v[204:207], v[76:79], v[144:159]
    v_mul_f32 v175, v21, v175
    v_cvt_pk_bf16_f32 v216, v160, v161
    v_cvt_pk_bf16_f32 v217, v162, v163
    v_cvt_pk_bf16_f32 v218, v164, v165
    ds_read_b128 v[200:203], v1 offset:16384
    s_waitcnt lgkmcnt(3)
    v_mfma_f32_32x32x16_bf16 v[144:159], v[208:211], v[80:83], v[144:159]
    v_cvt_pk_bf16_f32 v219, v166, v167
    v_cvt_pk_bf16_f32 v220, v168, v169
    v_cvt_pk_bf16_f32 v221, v170, v171
    v_cvt_pk_bf16_f32 v222, v172, v173
    v_cvt_pk_bf16_f32 v223, v174, v175
    ds_read_b128 v[204:207], v1 offset:17408
    v_mfma_f32_32x32x16_bf16 v[144:159], v[212:215], v[84:87], v[144:159]
    buffer_store_dwordx4 v[216:219], v1, s[8:11], s53 offen offset:0 sc1
    buffer_store_dwordx4 v[220:223], v1, s[8:11], s53 offen offset:1024 sc1
    ds_read_b128 v[208:211], v1 offset:18432
    s_waitcnt lgkmcnt(3)
    v_mfma_f32_32x32x16_bf16 v[144:159], v[192:195], v[88:91], v[144:159]
    v_mul_f32 v176, v240, v176
    v_mul_f32 v177, v241, v177
    v_mul_f32 v178, v242, v178
    v_mul_f32 v179, v243, v179
    v_mul_f32 v180, v244, v180
    ds_read_b128 v[212:215], v1 offset:19456
    v_mfma_f32_32x32x16_bf16 v[144:159], v[196:199], v[92:95], v[144:159]
    v_mul_f32 v181, v245, v181
    v_mul_f32 v182, v246, v182
    v_mul_f32 v183, v247, v183
    v_mul_f32 v184, v248, v184
    ds_read_b128 v[192:195], v1 offset:20480
    s_waitcnt lgkmcnt(3)
    v_mfma_f32_32x32x16_bf16 v[144:159], v[200:203], v[96:99], v[144:159]
    v_mul_f32 v185, v249, v185
    v_mul_f32 v186, v250, v186
    v_mul_f32 v187, v251, v187
    v_mul_f32 v188, v252, v188
    v_mul_f32 v189, v253, v189
    ds_read_b128 v[196:199], v1 offset:21504
    v_mfma_f32_32x32x16_bf16 v[144:159], v[204:207], v[100:103], v[144:159]
    v_mul_f32 v190, v254, v190
    v_mul_f32 v191, v255, v191
    v_cvt_pk_bf16_f32 v224, v176, v177
    v_cndmask_b32 v224, v224, v8, s[98:99]
    ds_read_b128 v[200:203], v1 offset:22528
    s_waitcnt lgkmcnt(3)
    v_mfma_f32_32x32x16_bf16 v[144:159], v[208:211], v[104:107], v[144:159]
    v_cvt_pk_bf16_f32 v225, v178, v179
    v_cndmask_b32 v225, v225, v8, s[98:99]
    v_cvt_pk_bf16_f32 v226, v180, v181
    v_cndmask_b32 v226, v226, v8, s[98:99]
    v_cvt_pk_bf16_f32 v227, v182, v183
    ds_read_b128 v[204:207], v1 offset:23552
    v_mfma_f32_32x32x16_bf16 v[144:159], v[212:215], v[108:111], v[144:159]
    v_cndmask_b32 v227, v227, v8, s[98:99]
    v_cvt_pk_bf16_f32 v228, v184, v185
    v_cndmask_b32 v228, v228, v8, s[98:99]
    v_cvt_pk_bf16_f32 v229, v186, v187
    ds_read_b128 v[208:211], v1 offset:24576
    s_waitcnt lgkmcnt(3)
    v_mfma_f32_32x32x16_bf16 v[144:159], v[192:195], v[112:115], v[144:159]
    v_cndmask_b32 v229, v229, v8, s[98:99]
    v_cvt_pk_bf16_f32 v230, v188, v189
    v_cndmask_b32 v230, v230, v8, s[98:99]
    v_cvt_pk_bf16_f32 v231, v190, v191
    v_cndmask_b32 v231, v231, v8, s[98:99]
    ds_read_b128 v[212:215], v1 offset:25600
    v_mfma_f32_32x32x16_bf16 v[144:159], v[196:199], v[116:119], v[144:159]
    buffer_store_dwordx4 v[224:227], v1, s[8:11], s53 offen offset:2048 sc1
    buffer_store_dwordx4 v[228:231], v1, s[8:11], s53 offen offset:3072 sc1
    ds_read_b128 v[192:195], v1 offset:26624
    s_waitcnt lgkmcnt(3)
    v_mfma_f32_32x32x16_bf16 v[144:159], v[200:203], v[120:123], v[144:159]
    ds_read_b128 v[196:199], v1 offset:27648
    v_mfma_f32_32x32x16_bf16 v[144:159], v[204:207], v[124:127], v[144:159]
    ds_write_b128 v12, v[216:219] offset:32768
    ds_write_b128 v12, v[220:223] offset:33792
    ds_read_b128 v[200:203], v16 offset:9216
    s_waitcnt lgkmcnt(5)
    v_mfma_f32_32x32x16_bf16 v[144:159], v[208:211], v[128:131], v[144:159]
    ds_write_b128 v12, v[224:227] offset:34816
    ds_write_b128 v12, v[228:231] offset:35840
    v_mfma_f32_32x32x16_bf16 v[144:159], v[212:215], v[132:135], v[144:159]
    s_waitcnt lgkmcnt(5)
    v_mfma_f32_32x32x16_bf16 v[144:159], v[192:195], v[136:139], v[144:159]
    v_mfma_f32_32x32x16_bf16 v[144:159], v[196:199], v[140:143], v[144:159]
    v_mov_b32 v18, 2
    s_waitcnt vmcnt(0)
    s_mov_b64 exec, 1
    buffer_store_dword v18, v11, s[8:11], s52 offen sc1
    s_mov_b64 exec, -1
    s_waitcnt lgkmcnt(2)
    v_mfma_f32_32x32x16_bf16 v[144:159], v[200:203], v[28:31], v[144:159]
    v_mul_f32 v22, 1049335798, v21
    s_nop 10
    v_pk_mul_f32 v[144:145], v[144:145], v[22:23] op_sel_hi:[1,0]
    v_pk_mul_f32 v[146:147], v[146:147], v[22:23] op_sel_hi:[1,0]
    v_pk_mul_f32 v[148:149], v[148:149], v[22:23] op_sel_hi:[1,0]
    v_pk_mul_f32 v[150:151], v[150:151], v[22:23] op_sel_hi:[1,0]
    v_pk_mul_f32 v[152:153], v[152:153], v[22:23] op_sel_hi:[1,0]
    v_pk_mul_f32 v[154:155], v[154:155], v[22:23] op_sel_hi:[1,0]
    v_pk_mul_f32 v[156:157], v[156:157], v[22:23] op_sel_hi:[1,0]
    v_pk_mul_f32 v[158:159], v[158:159], v[22:23] op_sel_hi:[1,0]
    v_cvt_pk_bf16_f32 v232, v144, v145
    v_cvt_pk_bf16_f32 v233, v146, v147
    v_cvt_pk_bf16_f32 v234, v148, v149
    v_cvt_pk_bf16_f32 v235, v150, v151
    v_cvt_pk_bf16_f32 v236, v152, v153
    v_cvt_pk_bf16_f32 v237, v154, v155
    v_cvt_pk_bf16_f32 v238, v156, v157
    v_cvt_pk_bf16_f32 v239, v158, v159
    v_mov_b32 v23, 0x3f80
    v_cndmask_b32 v238, v238, v23, s[96:97]
    s_waitcnt lgkmcnt(0)
    s_barrier
    v_mfma_f32_32x32x16_bf16 v[32:47], v[216:219], v[232:235], 0
    v_mfma_f32_32x32x16_bf16 v[32:47], v[220:223], v[236:239], v[32:47]
    v_add_u32 v28, 28672, v12
    ds_read_b128 v[96:99], v28
    ds_read_b128 v[100:103], v28 offset:1024
    s_mul_i32 s48, s3, s3
    s_mul_i32 s63, s3, 30
    s_lshl_b32 s48, s48, 1
    s_sub_u32 s63, s63, s48
    s_lshl_b32 s63, s63, 10
    s_sub_u32 s0, s25, s26
    v_mov_b32 v104, v224
    v_mov_b32 v105, v225
    v_mov_b32 v106, v226
    v_mov_b32 v107, v227
    v_mov_b32 v108, v228
    v_mov_b32 v109, v229
    v_mov_b32 v110, v230
    v_mov_b32 v111, v231
    v_mov_b32 v64, 0
    v_mov_b32 v65, 0
    v_mov_b32 v66, 0
    v_mov_b32 v67, 0
    v_mov_b32 v68, 0
    v_mov_b32 v69, 0
    v_mov_b32 v70, 0
    v_mov_b32 v71, 0
    v_mov_b32 v72, 0
    v_mov_b32 v73, 0
    v_mov_b32 v74, 0
    v_mov_b32 v75, 0
    v_mov_b32 v76, 0
    v_mov_b32 v77, 0
    v_mov_b32 v78, 0
    v_mov_b32 v79, 0
    v_cndmask_b32 v32, v26, v32, s[64:65]
    v_cndmask_b32 v33, v26, v33, s[66:67]
    v_cndmask_b32 v34, v26, v34, s[68:69]
    v_cndmask_b32 v35, v26, v35, s[70:71]
    v_cndmask_b32 v36, v26, v36, s[72:73]
    v_cndmask_b32 v37, v26, v37, s[74:75]
    v_cndmask_b32 v38, v26, v38, s[76:77]
    v_cndmask_b32 v39, v26, v39, s[78:79]
    v_cndmask_b32 v40, v26, v40, s[80:81]
    v_cndmask_b32 v41, v26, v41, s[82:83]
    v_cndmask_b32 v42, v26, v42, s[84:85]
    v_cndmask_b32 v43, v26, v43, s[86:87]
    v_cndmask_b32 v44, v26, v44, s[88:89]
    v_cndmask_b32 v45, v26, v45, s[90:91]
    v_cndmask_b32 v46, v26, v46, s[92:93]
    v_cndmask_b32 v47, v26, v47, s[94:95]
    v_max_f32 v27, v32, v33
    v_max3_f32 v27, v34, v35, v27
    v_max3_f32 v27, v36, v37, v27
    v_max3_f32 v27, v38, v39, v27
    v_max3_f32 v27, v40, v41, v27
    v_max3_f32 v27, v42, v43, v27
    v_max3_f32 v27, v44, v45, v27
    v_max3_f32 v27, v46, v47, v27
    v_mov_b32 v23, v27
    s_nop 1
    v_permlane32_swap_b32 v27, v23
    v_max_f32 v27, v27, v23
    v_sub_f32 v80, 0, v27
    v_sub_f32 v81, 0, v27
    v_pk_add_f32 v[32:33], v[32:33], v[80:81]
    v_pk_add_f32 v[34:35], v[34:35], v[80:81]
    v_pk_add_f32 v[36:37], v[36:37], v[80:81]
    v_pk_add_f32 v[38:39], v[38:39], v[80:81]
    v_pk_add_f32 v[40:41], v[40:41], v[80:81]
    v_pk_add_f32 v[42:43], v[42:43], v[80:81]
    v_pk_add_f32 v[44:45], v[44:45], v[80:81]
    v_pk_add_f32 v[46:47], v[46:47], v[80:81]
    v_pk_mov_b32 v[82:83], v[80:81], v[80:81] op_sel:[0,1]
    v_pk_mov_b32 v[84:85], v[80:81], v[80:81] op_sel:[0,1]
    v_pk_mov_b32 v[86:87], v[80:81], v[80:81] op_sel:[0,1]
    v_pk_mov_b32 v[88:89], v[80:81], v[80:81] op_sel:[0,1]
    v_pk_mov_b32 v[90:91], v[80:81], v[80:81] op_sel:[0,1]
    v_pk_mov_b32 v[92:93], v[80:81], v[80:81] op_sel:[0,1]
    v_pk_mov_b32 v[94:95], v[80:81], v[80:81] op_sel:[0,1]
    v_exp_f32 v32, v32
    v_exp_f32 v33, v33
    v_exp_f32 v34, v34
    v_exp_f32 v35, v35
    s_add_u32 s50, s31, 0
    buffer_load_dwordx4 v[128:131], v1, s[8:11], s50 offen offset:0
    buffer_load_dwordx4 v[132:135], v1, s[8:11], s50 offen offset:1024
    buffer_load_dwordx4 v[136:139], v1, s[8:11], s50 offen offset:2048
    buffer_load_dwordx4 v[140:143], v1, s[8:11], s50 offen offset:3072
    v_exp_f32 v36, v36
    v_exp_f32 v37, v37
    v_exp_f32 v38, v38
    v_exp_f32 v39, v39
    s_add_u32 s50, s31, 4096
    buffer_load_dwordx4 v[144:147], v1, s[8:11], s50 offen offset:0
    buffer_load_dwordx4 v[148:151], v1, s[8:11], s50 offen offset:1024
    buffer_load_dwordx4 v[152:155], v1, s[8:11], s50 offen offset:2048
    buffer_load_dwordx4 v[156:159], v1, s[8:11], s50 offen offset:3072
    v_exp_f32 v40, v40
    v_exp_f32 v41, v41
    v_exp_f32 v42, v42
    v_exp_f32 v43, v43
    s_add_u32 s50, s32, 0
    buffer_load_dwordx4 v[160:163], v1, s[8:11], s50 offen offset:0
    buffer_load_dwordx4 v[164:167], v1, s[8:11], s50 offen offset:1024
    buffer_load_dwordx4 v[168:171], v1, s[8:11], s50 offen offset:2048
    buffer_load_dwordx4 v[172:175], v1, s[8:11], s50 offen offset:3072
    v_exp_f32 v44, v44
    v_exp_f32 v45, v45
    v_exp_f32 v46, v46
    v_exp_f32 v47, v47
    s_add_u32 s50, s32, 4096
    buffer_load_dwordx4 v[176:179], v1, s[8:11], s50 offen offset:0
    buffer_load_dwordx4 v[180:183], v1, s[8:11], s50 offen offset:1024
    buffer_load_dwordx4 v[184:187], v1, s[8:11], s50 offen offset:2048
    buffer_load_dwordx4 v[188:191], v1, s[8:11], s50 offen offset:3072
    v_cvt_pk_bf16_f32 v48, v32, v33
    v_cvt_pk_bf16_f32 v49, v34, v35
    v_cvt_pk_bf16_f32 v50, v36, v37
    v_cvt_pk_bf16_f32 v51, v38, v39
    v_cvt_pk_bf16_f32 v52, v40, v41
    v_cvt_pk_bf16_f32 v53, v42, v43
    v_cvt_pk_bf16_f32 v54, v44, v45
    v_cvt_pk_bf16_f32 v55, v46, v47
    s_lshl_b32 s50, s4, 2
    s_lshl_b32 s51, s3, 1
    s_add_u32 s50, s50, s51
    s_sub_i32 s50, s50, 8
    s_lshl_b32 s53, s3, 13
    s_add_u32 s53, s53, 86016
    s_cmp_lt_i32 s50, 0
    s_cbranch_scc1 A_fill_47
    s_lshl_b32 s48, s5, 6
    s_add_u32 s48, s48, s50
    s_lshl_b32 s52, s48, 2
    s_add_u32 s52, s52, 32768
    s_lshl_b32 s60, s48, 12
    s_add_u32 s60, s60, s37
    v_and_b32 v22, 1, v2
    v_lshlrev_b32 v22, 2, v22
    s_mov_b32 s47, 0
poll_49:
    buffer_load_dword v18, v22, s[8:11], s52 offen sc1
    s_add_u32 s47, s47, 1
    s_cmp_gt_u32 s47, 400000
    s_cbranch_scc1 polled_50
    s_waitcnt vmcnt(0)
    v_cmp_gt_u32 vcc, s44, v18
    s_nop 1
    s_cbranch_vccnz poll_49
polled_50:
    s_waitcnt vmcnt(0)
    s_add_u32 m0, s53, 0
    s_add_u32 s24, s60, 0
    buffer_load_dwordx4 v1, s[8:11], s24 offen offset:0 lds
    buffer_load_dwordx4 v1, s[8:11], s24 offen offset:1024 lds
    buffer_load_dwordx4 v1, s[8:11], s24 offen offset:2048 lds
    buffer_load_dwordx4 v1, s[8:11], s24 offen offset:3072 lds
    s_add_u32 m0, s53, 4096
    s_add_u32 s24, s60, 4096
    buffer_load_dwordx4 v1, s[8:11], s24 offen offset:0 lds
    buffer_load_dwordx4 v1, s[8:11], s24 offen offset:1024 lds
    buffer_load_dwordx4 v1, s[8:11], s24 offen offset:2048 lds
    buffer_load_dwordx4 v1, s[8:11], s24 offen offset:3072 lds
A_join_48:
    s_mov_b32 s62, s3
    s_waitcnt lgkmcnt(0)
    s_cmp_eq_u32 s62, 0
    s_cbranch_scc1 att1e_52
att1_51:
    s_nop 1
    v_mfma_f32_32x32x16_bf16 v[32:47], v[96:99], v[232:235], v[80:95]
    v_mfma_f32_32x32x16_bf16 v[32:47], v[100:103], v[236:239], v[32:47]
    v_mfma_f32_32x32x16_bf16 v[64:79], v[104:107], v[48:51], v[64:79]
    v_mfma_f32_32x32x16_bf16 v[64:79], v[108:111], v[52:55], v[64:79]
    ds_read_b128 v[104:107], v28 offset:2048
    ds_read_b128 v[108:111], v28 offset:3072
    v_subrev_u32 v28, 4096, v28
    ds_read_b128 v[96:99], v28
    ds_read_b128 v[100:103], v28 offset:1024
    s_nop 4
    v_exp_f32 v32, v32
    v_exp_f32 v33, v33
    v_exp_f32 v34, v34
    v_exp_f32 v35, v35
    v_cvt_pk_bf16_f32 v48, v32, v33
    v_exp_f32 v36, v36
    v_exp_f32 v37, v37
    v_cvt_pk_bf16_f32 v49, v34, v35
    v_exp_f32 v38, v38
    v_exp_f32 v39, v39
    v_cvt_pk_bf16_f32 v50, v36, v37
    v_exp_f32 v40, v40
    v_exp_f32 v41, v41
    v_cvt_pk_bf16_f32 v51, v38, v39
    v_exp_f32 v42, v42
    v_exp_f32 v43, v43
    v_cvt_pk_bf16_f32 v52, v40, v41
    v_exp_f32 v44, v44
    v_exp_f32 v45, v45
    v_cvt_pk_bf16_f32 v53, v42, v43
    v_exp_f32 v46, v46
    v_exp_f32 v47, v47
    v_cvt_pk_bf16_f32 v54, v44, v45
    v_cvt_pk_bf16_f32 v55, v46, v47
    s_sub_u32 s62, s62, 1
    s_cmp_lg_u32 s62, 0
    s_waitcnt lgkmcnt(0)
    s_cbranch_scc1 att1_51
att1e_52:
    s_waitcnt vmcnt(0)
    s_barrier
    ds_read_b128 v[96:99], v28
    ds_read_b128 v[100:103], v28 offset:1024
    s_sub_u32 s62, 7, s3
    s_waitcnt lgkmcnt(0)
att2_53:
    s_nop 1
    v_mfma_f32_32x32x16_bf16 v[32:47], v[96:99], v[232:235], v[80:95]
    v_mfma_f32_32x32x16_bf16 v[32:47], v[100:103], v[236:239], v[32:47]
    v_mfma_f32_32x32x16_bf16 v[64:79], v[104:107], v[48:51], v[64:79]
    v_mfma_f32_32x32x16_bf16 v[64:79], v[108:111], v[52:55], v[64:79]
    ds_read_b128 v[104:107], v28 offset:2048
    ds_read_b128 v[108:111], v28 offset:3072
    v_subrev_u32 v28, 4096, v28
    ds_read_b128 v[96:99], v28
    ds_read_b128 v[100:103], v28 offset:1024
    s_min_u32 m0, s63, 81920
    s_add_u32 s24, s0, m0
    buffer_load_dwordx4 v1, s[8:11], s24 offen offset:0 lds
    buffer_load_dwordx4 v1, s[8:11], s24 offen offset:1024 lds
    buffer_load_dwordx4 v1, s[8:11], s24 offen offset:2048 lds
    buffer_load_dwordx4 v1, s[8:11], s24 offen offset:3072 lds
    s_add_u32 s63, s63, 4096
    v_exp_f32 v32, v32
    v_exp_f32 v33, v33
    v_exp_f32 v34, v34
    v_exp_f32 v35, v35
    v_cvt_pk_bf16_f32 v48, v32, v33
    v_exp_f32 v36, v36
    v_exp_f32 v37, v37
    v_cvt_pk_bf16_f32 v49, v34, v35
    v_exp_f32 v38, v38
    v_exp_f32 v39, v39
    v_cvt_pk_bf16_f32 v50, v36, v37
    v_exp_f32 v40, v40
    v_exp_f32 v41, v41
    v_cvt_pk_bf16_f32 v51, v38, v39
    v_exp_f32 v42, v42
    v_exp_f32 v43, v43
    v_cvt_pk_bf16_f32 v52, v40, v41
    v_exp_f32 v44, v44
    v_exp_f32 v45, v45
    v_cvt_pk_bf16_f32 v53, v42, v43
    v_exp_f32 v46, v46
    v_exp_f32 v47, v47
    v_cvt_pk_bf16_f32 v54, v44, v45
    v_cvt_pk_bf16_f32 v55, v46, v47
    s_sub_u32 s62, s62, 1
    s_cmp_lg_u32 s62, 0
    s_waitcnt lgkmcnt(0)
    s_cbranch_scc1 att2_53
    s_nop 1
    v_mfma_f32_32x32x16_bf16 v[32:47], v[96:99], v[232:235], v[80:95]
    v_mfma_f32_32x32x16_bf16 v[32:47], v[100:103], v[236:239], v[32:47]
    v_mfma_f32_32x32x16_bf16 v[64:79], v[104:107], v[48:51], v[64:79]
    v_mfma_f32_32x32x16_bf16 v[64:79], v[108:111], v[52:55], v[64:79]
    ds_read_b128 v[104:107], v28 offset:2048
    ds_read_b128 v[108:111], v28 offset:3072
    v_subrev_u32 v28, 4096, v28
    s_nop 6
    v_cndmask_b32 v32, v32, v26, s[64:65]
    v_cndmask_b32 v33, v33, v26, s[66:67]
    v_cndmask_b32 v34, v34, v26, s[68:69]
    v_cndmask_b32 v35, v35, v26, s[70:71]
    v_cndmask_b32 v36, v36, v26, s[72:73]
    v_cndmask_b32 v37, v37, v26, s[74:75]
    v_cndmask_b32 v38, v38, v26, s[76:77]
    v_cndmask_b32 v39, v39, v26, s[78:79]
    v_cndmask_b32 v40, v40, v26, s[80:81]
    v_cndmask_b32 v41, v41, v26, s[82:83]
    v_cndmask_b32 v42, v42, v26, s[84:85]
    v_cndmask_b32 v43, v43, v26, s[86:87]
    v_cndmask_b32 v44, v44, v26, s[88:89]
    v_cndmask_b32 v45, v45, v26, s[90:91]
    v_cndmask_b32 v46, v46, v26, s[92:93]
    v_cndmask_b32 v47, v47, v26, s[94:95]
    v_exp_f32 v32, v32
    v_exp_f32 v33, v33
    v_exp_f32 v34, v34
    v_exp_f32 v35, v35
    v_cvt_pk_bf16_f32 v48, v32, v33
    v_exp_f32 v36, v36
    v_exp_f32 v37, v37
    v_cvt_pk_bf16_f32 v49, v34, v35
    v_exp_f32 v38, v38
    v_exp_f32 v39, v39
    v_cvt_pk_bf16_f32 v50, v36, v37
    v_exp_f32 v40, v40
    v_exp_f32 v41, v41
    v_cvt_pk_bf16_f32 v51, v38, v39
    v_exp_f32 v42, v42
    v_exp_f32 v43, v43
    v_cvt_pk_bf16_f32 v52, v40, v41
    v_exp_f32 v44, v44
    v_exp_f32 v45, v45
    v_cvt_pk_bf16_f32 v53, v42, v43
    v_exp_f32 v46, v46
    v_exp_f32 v47, v47
    v_cvt_pk_bf16_f32 v54, v44, v45
    v_cvt_pk_bf16_f32 v55, v46, v47
    s_waitcnt lgkmcnt(1)
    v_mfma_f32_32x32x16_bf16 v[64:79], v[104:107], v[48:51], v[64:79]
    s_waitcnt lgkmcnt(0)
    v_mfma_f32_32x32x16_bf16 v[64:79], v[108:111], v[52:55], v[64:79]
    s_lshl_b32 s52, s6, 7
    s_lshl_b32 s49, s5, 2
    s_add_u32 s52, s52, s49
    s_add_u32 s52, s52, 8192
    s_mov_b32 s48, 1602224128
    s_nop 6
    v_mov_b32 v22, v76
    v_mov_b32 v23, v76
    s_nop 1
    v_permlane32_swap_b32 v22, v23
    v_cmp_nge_f32 vcc, s48, v23
    s_nop 1
    s_cbranch_vccnz att_fb_55
att_ok_54:
    s_nop 1
    v_rcp_f32 v22, v23
    s_nop 0
    v_pk_mul_f32 v[64:65], v[64:65], v[22:23] op_sel_hi:[1,0]
    v_pk_mul_f32 v[66:67], v[66:67], v[22:23] op_sel_hi:[1,0]
    v_pk_mul_f32 v[68:69], v[68:69], v[22:23] op_sel_hi:[1,0]
    v_pk_mul_f32 v[70:71], v[70:71], v[22:23] op_sel_hi:[1,0]
    v_pk_mul_f32 v[72:73], v[72:73], v[22:23] op_sel_hi:[1,0]
    v_pk_mul_f32 v[74:75], v[74:75], v[22:23] op_sel_hi:[1,0]
    v_pk_mul_f32 v[76:77], v[76:77], v[22:23] op_sel_hi:[1,0]
    v_pk_mul_f32 v[78:79], v[78:79], v[22:23] op_sel_hi:[1,0]
    v_cvt_pk_bf16_f32 v64, v64, v65
    v_cvt_pk_bf16_f32 v65, v66, v67
    v_cvt_pk_bf16_f32 v66, v68, v69
    v_cvt_pk_bf16_f32 v67, v70, v71
    v_cvt_pk_bf16_f32 v68, v72, v73
    v_cvt_pk_bf16_f32 v69, v74, v75
    v_cvt_pk_bf16_f32 v70, v76, v77
    v_cvt_pk_bf16_f32 v71, v78, v79
    buffer_store_dwordx4 v[64:67], v1, s[8:11], s100 offen
    buffer_store_dwordx4 v[68:71], v1, s[8:11], s100 offen offset:1024
    v_mov_b32 v18, s44
    s_waitcnt vmcnt(0)
    s_mov_b64 exec, 1
    buffer_store_dword v18, v11, s[8:11], s52 offen
    s_mov_b64 exec, -1
    s_cmp_eq_u32 s46, 0
    s_cbranch_scc1 p3_skip_62
    s_mul_i32 s48, s55, 28
    s_lshl_b32 s49, s54, 1
    s_add_u32 s48, s48, s49
    s_lshl_b32 s48, s48, 10
    s_add_u32 s48, s48, s42
    buffer_load_dwordx4 v[96:99], v1, s[8:11], s48 offen sc1
    buffer_load_dwordx4 v[100:103], v1, s[8:11], s48 offen offset:1024 sc1
p3_res_65:
    s_and_b32 s52, s55, -2
    s_lshl_b32 s52, s52, 7
    s_add_u32 s52, s52, 8192
    s_lshl_b32 s49, s3, 19
    s_add_u32 s49, s49, s38
    s_lshl_b32 s50, s55, 11
    s_add_u32 s50, s50, s49
    s_lshl_b32 s51, s57, 11
    s_add_u32 s51, s51, s49
    s_mul_i32 s48, s3, 12288
    s_add_u32 s48, s48, 86016
    v_add_u32 v25, s48, v1
    s_lshl_b32 s60, s55, 7
    s_lshl_b32 s49, s54, 2
    s_add_u32 s60, s60, s49
    s_add_u32 s60, s60, 16384
    s_barrier
    s_waitcnt vmcnt(1)
    v_lshlrev_b32 v32, 16, v96
    v_and_b32 v33, 0xffff0000, v96
    v_lshlrev_b32 v34, 16, v97
    v_and_b32 v35, 0xffff0000, v97
    v_lshlrev_b32 v36, 16, v98
    v_and_b32 v37, 0xffff0000, v98
    v_lshlrev_b32 v38, 16, v99
    v_and_b32 v39, 0xffff0000, v99
    s_waitcnt vmcnt(0)
    v_lshlrev_b32 v40, 16, v100
    v_and_b32 v41, 0xffff0000, v100
    v_lshlrev_b32 v42, 16, v101
    v_and_b32 v43, 0xffff0000, v101
    v_lshlrev_b32 v44, 16, v102
    v_and_b32 v45, 0xffff0000, v102
    v_lshlrev_b32 v46, 16, v103
    v_and_b32 v47, 0xffff0000, v103
    s_mov_b32 s47, 0
poll_66:
    buffer_load_dword v18, v10, s[8:11], s52 offen sc1
    s_add_u32 s47, s47, 1
    s_cmp_gt_u32 s47, 400000
    s_cbranch_scc1 polled_67
    s_waitcnt vmcnt(0)
    v_cmp_gt_u32 vcc, s44, v18
    s_nop 1
    s_cbranch_vccnz poll_66
polled_67:
    s_waitcnt vmcnt(0)
    buffer_load_dwordx4 v[224:227], v1, s[8:11], s51 offen offset:0 sc1
    buffer_load_dwordx4 v[228:231], v1, s[8:11], s51 offen offset:1024 sc1
    s_add_u32 s51, s51, 131072
    buffer_load_dwordx4 v[232:235], v1, s[8:11], s51 offen offset:0 sc1
    buffer_load_dwordx4 v[236:239], v1, s[8:11], s51 offen offset:1024 sc1
    s_add_u32 s51, s51, 131072
    buffer_load_dwordx4 v[240:243], v1, s[8:11], s51 offen offset:0 sc1
    buffer_load_dwordx4 v[244:247], v1, s[8:11], s51 offen offset:1024 sc1
    s_add_u32 s51, s51, 131072
    buffer_load_dwordx4 v[248:251], v1, s[8:11], s51 offen offset:0 sc1
    buffer_load_dwordx4 v[252:255], v1, s[8:11], s51 offen offset:1024 sc1
    buffer_load_dwordx4 v[192:195], v1, s[8:11], s50 offen offset:0 sc1
    buffer_load_dwordx4 v[196:199], v1, s[8:11], s50 offen offset:1024 sc1
    s_add_u32 s50, s50, 131072
    buffer_load_dwordx4 v[200:203], v1, s[8:11], s50 offen offset:0 sc1
    buffer_load_dwordx4 v[204:207], v1, s[8:11], s50 offen offset:1024 sc1
    s_add_u32 s50, s50, 131072
    buffer_load_dwordx4 v[208:211], v1, s[8:11], s50 offen offset:0 sc1
    buffer_load_dwordx4 v[212:215], v1, s[8:11], s50 offen offset:1024 sc1
    s_add_u32 s50, s50, 131072
    buffer_load_dwordx4 v[216:219], v1, s[8:11], s50 offen offset:0 sc1
    buffer_load_dwordx4 v[220:223], v1, s[8:11], s50 offen offset:1024 sc1
    s_waitcnt vmcnt(15)
    v_mfma_f32_32x32x16_bf16 v[64:79], v[128:131], v[224:227], 0
    v_mfma_f32_32x32x16_bf16 v[80:95], v[160:163], v[224:227], 0
    s_waitcnt vmcnt(14)
    v_mfma_f32_32x32x16_bf16 v[64:79], v[132:135], v[228:231], v[64:79]
    v_min_u32 v19, 55, v2
    v_lshlrev_b32 v19, 7, v19
    s_add_u32 s0, s61, 0
    buffer_load_dword v0, v19, s[8:11], s0 offen sc1
    v_mfma_f32_32x32x16_bf16 v[80:95], v[164:167], v[228:231], v[80:95]
    s_waitcnt vmcnt(14)
    v_mfma_f32_32x32x16_bf16 v[64:79], v[136:139], v[232:235], v[64:79]
    v_mfma_f32_32x32x16_bf16 v[80:95], v[168:171], v[232:235], v[80:95]
    s_waitcnt vmcnt(13)
    v_mfma_f32_32x32x16_bf16 v[64:79], v[140:143], v[236:239], v[64:79]
    v_mfma_f32_32x32x16_bf16 v[80:95], v[172:175], v[236:239], v[80:95]
    s_waitcnt vmcnt(12)
    v_mfma_f32_32x32x16_bf16 v[64:79], v[144:147], v[240:243], v[64:79]
    v_mfma_f32_32x32x16_bf16 v[80:95], v[176:179], v[240:243], v[80:95]
    s_waitcnt vmcnt(11)
    v_mfma_f32_32x32x16_bf16 v[64:79], v[148:151], v[244:247], v[64:79]
    v_mfma_f32_32x32x16_bf16 v[80:95], v[180:183], v[244:247], v[80:95]
    s_waitcnt vmcnt(10)
    v_mfma_f32_32x32x16_bf16 v[64:79], v[152:155], v[248:251], v[64:79]
    v_mfma_f32_32x32x16_bf16 v[80:95], v[184:187], v[248:251], v[80:95]
    s_waitcnt vmcnt(9)
    v_mfma_f32_32x32x16_bf16 v[64:79], v[156:159], v[252:255], v[64:79]
    v_mfma_f32_32x32x16_bf16 v[80:95], v[188:191], v[252:255], v[80:95]
    s_waitcnt vmcnt(8)
    v_mfma_f32_32x32x16_bf16 v[48:63], v[160:163], v[192:195], 0
    s_waitcnt vmcnt(7)
    v_mfma_f32_32x32x16_bf16 v[48:63], v[164:167], v[196:199], v[48:63]
    s_waitcnt vmcnt(6)
    v_mfma_f32_32x32x16_bf16 v[48:63], v[168:171], v[200:203], v[48:63]
    s_xor_b32 s48, s3, 2
    s_mul_i32 s48, s48, 12288
    s_add_u32 s48, s48, 90112
    v_add_u32 v23, s48, v1
    s_nop 0
    ds_write_b128 v23, v[64:67] offset:0
    s_waitcnt vmcnt(5)
    v_mfma_f32_32x32x16_bf16 v[48:63], v[172:175], v[204:207], v[48:63]
    ds_write_b128 v23, v[68:71] offset:1024
    ds_write_b128 v23, v[72:75] offset:2048
    ds_write_b128 v23, v[76:79] offset:3072
    s_waitcnt vmcnt(4)
    v_mfma_f32_32x32x16_bf16 v[48:63], v[176:179], v[208:211], v[48:63]
    s_xor_b32 s48, s3, 3
    s_mul_i32 s48, s48, 12288
    s_add_u32 s48, s48, 94208
    v_add_u32 v24, s48, v1
    ds_write_b128 v24, v[80:83] offset:0
    s_waitcnt vmcnt(3)
    v_mfma_f32_32x32x16_bf16 v[48:63], v[180:183], v[212:215], v[48:63]
    ds_write_b128 v24, v[84:87] offset:1024
    ds_write_b128 v24, v[88:91] offset:2048
    ds_write_b128 v24, v[92:95] offset:3072
    s_waitcnt vmcnt(2)
    v_mfma_f32_32x32x16_bf16 v[48:63], v[184:187], v[216:219], v[48:63]
    s_waitcnt vmcnt(1)
    v_mfma_f32_32x32x16_bf16 v[48:63], v[188:191], v[220:223], v[48:63]
    v_mfma_f32_32x32x16_bf16 v[32:47], v[128:131], v[192:195], v[32:47]
    v_mfma_f32_32x32x16_bf16 v[32:47], v[132:135], v[196:199], v[32:47]
    v_mfma_f32_32x32x16_bf16 v[32:47], v[136:139], v[200:203], v[32:47]
    s_xor_b32 s48, s3, 1
    s_mul_i32 s48, s48, 12288
    s_add_u32 s48, s48, 86016
    v_add_u32 v22, s48, v1
    s_nop 4
    ds_write_b128 v22, v[48:51] offset:0
    v_mfma_f32_32x32x16_bf16 v[32:47], v[140:143], v[204:207], v[32:47]
    ds_write_b128 v22, v[52:55] offset:1024
    ds_write_b128 v22, v[56:59] offset:2048
    ds_write_b128 v22, v[60:63] offset:3072
    v_mfma_f32_32x32x16_bf16 v[32:47], v[144:147], v[208:211], v[32:47]
    v_mfma_f32_32x32x16_bf16 v[32:47], v[148:151], v[212:215], v[32:47]
    v_mfma_f32_32x32x16_bf16 v[32:47], v[152:155], v[216:219], v[32:47]
    v_mfma_f32_32x32x16_bf16 v[32:47], v[156:159], v[220:223], v[32:47]
    s_waitcnt lgkmcnt(0)
    s_barrier
    ds_read_b128 v[48:51], v25 offset:0
    ds_read_b128 v[64:67], v25 offset:4096
    ds_read_b128 v[80:83], v25 offset:8192
    ds_read_b128 v[52:55], v25 offset:1024
    ds_read_b128 v[68:71], v25 offset:5120
    ds_read_b128 v[84:87], v25 offset:9216
    ds_read_b128 v[56:59], v25 offset:2048
    ds_read_b128 v[72:75], v25 offset:6144
    ds_read_b128 v[88:91], v25 offset:10240
    ds_read_b128 v[60:63], v25 offset:3072
    ds_read_b128 v[76:79], v25 offset:7168
    ds_read_b128 v[92:95], v25 offset:11264
    s_waitcnt lgkmcnt(9)
    v_pk_add_f32 v[48:49], v[48:49], v[64:65]
    v_pk_add_f32 v[32:33], v[32:33], v[80:81]
    v_pk_add_f32 v[50:51], v[50:51], v[66:67]
    v_pk_add_f32 v[34:35], v[34:35], v[82:83]
    v_pk_add_f32 v[32:33], v[32:33], v[48:49]
    v_pk_add_f32 v[34:35], v[34:35], v[50:51]
    v_cvt_pk_bf16_f32 v96, v32, v33
    v_cvt_pk_bf16_f32 v97, v34, v35
    s_waitcnt lgkmcnt(6)
    v_pk_add_f32 v[52:53], v[52:53], v[68:69]
    v_pk_add_f32 v[36:37], v[36:37], v[84:85]
    v_pk_add_f32 v[54:55], v[54:55], v[70:71]
    v_pk_add_f32 v[38:39], v[38:39], v[86:87]
    v_pk_add_f32 v[36:37], v[36:37], v[52:53]
    v_pk_add_f32 v[38:39], v[38:39], v[54:55]
    v_cvt_pk_bf16_f32 v98, v36, v37
    v_cvt_pk_bf16_f32 v99, v38, v39
    buffer_store_dwordx4 v[96:99], v1, s[8:11], s101 offen
    s_waitcnt lgkmcnt(3)
    v_pk_add_f32 v[56:57], v[56:57], v[72:73]
    v_pk_add_f32 v[40:41], v[40:41], v[88:89]
    v_pk_add_f32 v[58:59], v[58:59], v[74:75]
    v_pk_add_f32 v[42:43], v[42:43], v[90:91]
    v_pk_add_f32 v[40:41], v[40:41], v[56:57]
    v_pk_add_f32 v[42:43], v[42:43], v[58:59]
    v_cvt_pk_bf16_f32 v100, v40, v41
    v_cvt_pk_bf16_f32 v101, v42, v43
    s_waitcnt lgkmcnt(0)
    v_pk_add_f32 v[60:61], v[60:61], v[76:77]
    v_pk_add_f32 v[44:45], v[44:45], v[92:93]
    v_pk_add_f32 v[62:63], v[62:63], v[78:79]
    v_pk_add_f32 v[46:47], v[46:47], v[94:95]
    v_pk_add_f32 v[44:45], v[44:45], v[60:61]
    v_pk_add_f32 v[46:47], v[46:47], v[62:63]
    v_cvt_pk_bf16_f32 v102, v44, v45
    v_cvt_pk_bf16_f32 v103, v46, v47
    buffer_store_dwordx4 v[100:103], v1, s[8:11], s101 offen offset:1024
    v_mov_b32 v22, 0
    v_mov_b32 v23, 0
    v_dot2_f32_bf16 v22, v96, v8, v22
    v_dot2_f32_bf16 v23, v96, v96, v23
    v_dot2_f32_bf16 v22, v97, v8, v22
    v_dot2_f32_bf16 v23, v97, v97, v23
    v_dot2_f32_bf16 v22, v98, v8, v22
    v_dot2_f32_bf16 v23, v98, v98, v23
    v_dot2_f32_bf16 v22, v99, v8, v22
    v_dot2_f32_bf16 v23, v99, v99, v23
    v_dot2_f32_bf16 v22, v100, v8, v22
    v_dot2_f32_bf16 v23, v100, v100, v23
    v_dot2_f32_bf16 v22, v101, v8, v22
    v_dot2_f32_bf16 v23, v101, v101, v23
    v_dot2_f32_bf16 v22, v102, v8, v22
    v_dot2_f32_bf16 v23, v102, v102, v23
    v_dot2_f32_bf16 v22, v103, v8, v22
    v_dot2_f32_bf16 v23, v103, v103, v23
    s_nop 2
    v_permlane32_swap_b32 v22, v23
    v_add_f32 v22, v22, v23
    buffer_store_dword v22, v5, s[8:11], s1 offen
    v_mov_b32 v18, s44
    s_waitcnt vmcnt(0)
    s_mov_b64 exec, 1
    buffer_store_dword v18, v11, s[8:11], s60 offen
    s_mov_b64 exec, -1
p3_join_63:
    s_lshl_b32 s52, s6, 7
    s_add_u32 s52, s52, 16384
    s_mul_i32 s51, s6, 28672
    s_add_u32 s51, s51, s39
    s_waitcnt vmcnt(0)
    s_barrier
    ds_read_b128 v[192:195], v1 offset:0
    ds_read_b128 v[196:199], v1 offset:28672
    ds_read_b128 v[200:203], v1 offset:1024
    ds_read_b128 v[204:207], v1 offset:29696
    ds_read_b128 v[208:211], v1 offset:2048
    ds_read_b128 v[212:215], v1 offset:30720
    s_mov_b32 s47, 0
poll_68:
    buffer_load_dword v18, v9, s[8:11], s52 offen sc1
    s_add_u32 s47, s47, 1
    s_cmp_gt_u32 s47, 400000
    s_cbranch_scc1 polled_69
    s_waitcnt vmcnt(0)
    v_cmp_gt_u32 vcc, s44, v18
    s_nop 1
    s_cbranch_vccnz poll_68
polled_69:
    s_waitcnt vmcnt(0)
    s_add_u32 s50, s51, 0
    buffer_load_dwordx4 v[32:35], v1, s[8:11], s50 offen offset:0 sc1
    buffer_load_dwordx4 v[36:39], v1, s[8:11], s50 offen offset:1024 sc1
    buffer_load_dwordx4 v[40:43], v1, s[8:11], s50 offen offset:2048 sc1
    buffer_load_dwordx4 v[44:47], v1, s[8:11], s50 offen offset:3072 sc1
    s_mul_i32 s48, s6, 3584
    s_add_u32 s48, s48, s40
    buffer_load_dwordx2 v[224:225], v6, s[8:11], s48 offen offset:0 sc1
    buffer_load_dwordx2 v[226:227], v6, s[8:11], s48 offen offset:256 sc1
    buffer_load_dwordx2 v[228:229], v6, s[8:11], s48 offen offset:512 sc1
    buffer_load_dwordx2 v[230:231], v6, s[8:11], s48 offen offset:768 sc1
    buffer_load_dwordx2 v[232:233], v6, s[8:11], s48 offen offset:1024 sc1
    buffer_load_dwordx2 v[234:235], v6, s[8:11], s48 offen offset:1280 sc1
    buffer_load_dwordx2 v[236:237], v6, s[8:11], s48 offen offset:1536 sc1
    s_add_u32 s50, s51, 4096
    buffer_load_dwordx4 v[48:51], v1, s[8:11], s50 offen offset:0 sc1
    buffer_load_dwordx4 v[52:55], v1, s[8:11], s50 offen offset:1024 sc1
    buffer_load_dwordx4 v[56:59], v1, s[8:11], s50 offen offset:2048 sc1
    buffer_load_dwordx4 v[60:63], v1, s[8:11], s50 offen offset:3072 sc1
    s_add_u32 s50, s51, 8192
    buffer_load_dwordx4 v[64:67], v1, s[8:11], s50 offen offset:0 sc1
    buffer_load_dwordx4 v[68:71], v1, s[8:11], s50 offen offset:1024 sc1
    ds_read_b128 v[216:219], v1 offset:3072
    buffer_load_dwordx4 v[72:75], v1, s[8:11], s50 offen offset:2048 sc1
    s_waitcnt lgkmcnt(5)
    s_waitcnt vmcnt(17)
    v_mfma_f32_32x32x16_bf16 v[144:159], v[192:195], v[32:35], 0
    ds_read_b128 v[220:223], v1 offset:31744
    v_mfma_f32_32x32x16_bf16 v[160:175], v[196:199], v[32:35], 0
    ds_read_b128 v[192:195], v1 offset:4096
    buffer_load_dwordx4 v[76:79], v1, s[8:11], s50 offen offset:3072 sc1
    s_waitcnt lgkmcnt(5)
    s_waitcnt vmcnt(17)
    v_mfma_f32_32x32x16_bf16 v[144:159], v[200:203], v[36:39], v[144:159]
    ds_read_b128 v[196:199], v1 offset:32768
    v_mfma_f32_32x32x16_bf16 v[160:175], v[204:207], v[36:39], v[160:175]
    ds_read_b128 v[200:203], v1 offset:5120
    s_add_u32 s50, s51, 12288
    buffer_load_dwordx4 v[80:83], v1, s[8:11], s50 offen offset:0 sc1
    s_waitcnt lgkmcnt(5)
    s_waitcnt vmcnt(17)
    v_mfma_f32_32x32x16_bf16 v[144:159], v[208:211], v[40:43], v[144:159]
    ds_read_b128 v[204:207], v1 offset:33792
    v_mfma_f32_32x32x16_bf16 v[160:175], v[212:215], v[40:43], v[160:175]
    ds_read_b128 v[208:211], v1 offset:6144
    buffer_load_dwordx4 v[84:87], v1, s[8:11], s50 offen offset:1024 sc1
    s_waitcnt lgkmcnt(5)
    s_waitcnt vmcnt(17)
    v_mfma_f32_32x32x16_bf16 v[144:159], v[216:219], v[44:47], v[144:159]
    s_waitcnt vmcnt(15)
    v_add_f32 v224, v224, v226
    v_add_f32 v225, v225, v227
    s_waitcnt vmcnt(14)
    v_add_f32 v224, v224, v228
    ds_read_b128 v[212:215], v1 offset:34816
    v_mfma_f32_32x32x16_bf16 v[160:175], v[220:223], v[44:47], v[160:175]
    v_add_f32 v225, v225, v229
    s_waitcnt vmcnt(13)
    v_add_f32 v224, v224, v230
    ds_read_b128 v[216:219], v1 offset:7168
    buffer_load_dwordx4 v[88:91], v1, s[8:11], s50 offen offset:2048 sc1
    s_waitcnt lgkmcnt(5)
    s_waitcnt vmcnt(10)
    v_mfma_f32_32x32x16_bf16 v[144:159], v[192:195], v[48:51], v[144:159]
    v_add_f32 v225, v225, v231
    v_add_f32 v224, v224, v232
    v_add_f32 v225, v225, v233
    v_add_f32 v224, v224, v234
    v_add_f32 v225, v225, v235
    ds_read_b128 v[220:223], v1 offset:35840
    v_mfma_f32_32x32x16_bf16 v[160:175], v[196:199], v[48:51], v[160:175]
    v_add_f32 v224, v224, v236
    v_add_f32 v225, v225, v237
    ds_read_b128 v[192:195], v1 offset:8192
    buffer_load_dwordx4 v[92:95], v1, s[8:11], s50 offen offset:3072 sc1
    s_waitcnt lgkmcnt(5)
    s_waitcnt vmcnt(10)
    v_mfma_f32_32x32x16_bf16 v[144:159], v[200:203], v[52:55], v[144:159]
    v_mov_b32 v22, v224
    v_mov_b32 v23, v225
    s_nop 0
    v_permlane32_swap_b32 v224, v22
    v_permlane32_swap_b32 v225, v23
    ds_read_b128 v[196:199], v1 offset:36864
    v_mfma_f32_32x32x16_bf16 v[160:175], v[204:207], v[52:55], v[160:175]
    v_add_f32 v224, v224, v22
    ds_read_b128 v[200:203], v1 offset:9216
    s_add_u32 s50, s51, 16384
    buffer_load_dwordx4 v[96:99], v1, s[8:11], s50 offen offset:0 sc1
    s_waitcnt lgkmcnt(5)
    s_waitcnt vmcnt(10)
    v_mfma_f32_32x32x16_bf16 v[144:159], v[208:211], v[56:59], v[144:159]
    v_add_f32 v225, v225, v23
    v_mul_f32 v224, 3138537765, v224
    v_mul_f32 v225, 991054117, v225
    v_fma_f32 v225, -v224, v224, v225
    v_max_f32 v225, 0, v225
    ds_read_b128 v[204:207], v1 offset:37888
    v_mfma_f32_32x32x16_bf16 v[160:175], v[212:215], v[56:59], v[160:175]
    v_cvt_pk_bf16_f32 v20, v224, v224
    v_cvt_pk_bf16_f32 v23, v225, v225
    ds_read_b128 v[208:211], v1 offset:10240
    buffer_load_dwordx4 v[100:103], v1, s[8:11], s50 offen offset:1024 sc1
    s_waitcnt lgkmcnt(5)
    s_waitcnt vmcnt(10)
    v_mfma_f32_32x32x16_bf16 v[144:159], v[216:219], v[60:63], v[144:159]
    v_and_b32 v23, 0xffff0000, v23
    v_add_f32 v23, 925353388, v23
    v_cvt_pk_bf16_f32 v23, v23, v23
    v_and_b32 v23, 0xffff0000, v23
    ds_read_b128 v[212:215], v1 offset:38912
    v_mfma_f32_32x32x16_bf16 v[160:175], v[220:223], v[60:63], v[160:175]
    v_sqrt_f32 v23, v23
    ds_read_b128 v[216:219], v1 offset:11264
    buffer_load_dwordx4 v[104:107], v1, s[8:11], s50 offen offset:2048 sc1
    s_waitcnt lgkmcnt(5)
    s_waitcnt vmcnt(10)
    v_mfma_f32_32x32x16_bf16 v[144:159], v[192:195], v[64:67], v[144:159]
    v_cvt_pk_bf16_f32 v23, v23, v23
    v_and_b32 v23, 0xffff0000, v23
    v_rcp_f32 v21, v23
    v_mov_b32 v28, v20
    ds_read_b128 v[220:223], v1 offset:39936
    v_mfma_f32_32x32x16_bf16 v[160:175], v[196:199], v[64:67], v[160:175]
    v_mov_b32 v29, v20
    v_mov_b32 v30, v20
    ds_read_b128 v[192:195], v1 offset:12288
    buffer_load_dwordx4 v[108:111], v1, s[8:11], s50 offen offset:3072 sc1
    s_waitcnt lgkmcnt(5)
    s_waitcnt vmcnt(10)
    v_mfma_f32_32x32x16_bf16 v[144:159], v[200:203], v[68:71], v[144:159]
    v_mov_b32 v31, v20
    v_mul_f32 v17, 3216550459, v21
    s_lshl_b32 s33, s6, 7
    s_lshl_b32 s49, s5, 2
    s_add_u32 s33, s33, s49
    ds_read_b128 v[196:199], v1 offset:40960
    v_mfma_f32_32x32x16_bf16 v[160:175], v[204:207], v[68:71], v[160:175]
    s_add_u32 s33, s33, 24576
    ds_read_b128 v[200:203], v1 offset:13312
    s_add_u32 s50, s51, 20480
    buffer_load_dwordx4 v[112:115], v1, s[8:11], s50 offen offset:0 sc1
    s_waitcnt lgkmcnt(5)
    s_waitcnt vmcnt(10)
    v_mfma_f32_32x32x16_bf16 v[144:159], v[208:211], v[72:75], v[144:159]
    s_and_b32 s34, s55, -2
    s_lshl_b32 s34, s34, 7
    s_add_u32 s34, s34, 24576
    s_mul_i32 s49, s3, 28672
    s_add_u32 s49, s49, s41
    ds_read_b128 v[204:207], v1 offset:41984
    v_mfma_f32_32x32x16_bf16 v[160:175], v[212:215], v[72:75], v[160:175]
    s_mul_i32 s35, s55, 114688
    s_add_u32 s35, s35, s49
    ds_read_b128 v[208:211], v1 offset:14336
    buffer_load_dwordx4 v[116:119], v1, s[8:11], s50 offen offset:1024 sc1
    s_waitcnt lgkmcnt(5)
    s_waitcnt vmcnt(10)
    v_mfma_f32_32x32x16_bf16 v[144:159], v[216:219], v[76:79], v[144:159]
    s_mul_i32 s36, s57, 114688
    s_add_u32 s36, s36, s49
    ds_read_b128 v[212:215], v1 offset:43008
    v_mfma_f32_32x32x16_bf16 v[160:175], v[220:223], v[76:79], v[160:175]
    ds_read_b128 v[216:219], v1 offset:15360
    buffer_load_dwordx4 v[120:123], v1, s[8:11], s50 offen offset:2048 sc1
    s_waitcnt lgkmcnt(5)
    s_waitcnt vmcnt(10)
    v_mfma_f32_32x32x16_bf16 v[144:159], v[192:195], v[80:83], v[144:159]
    s_mul_i32 s101, s55, 28
    s_lshl_b32 s49, s54, 1
    s_add_u32 s101, s101, s49
    s_lshl_b32 s101, s101, 10
    s_add_u32 s101, s101, s42
    s_mul_i32 s1, s55, 14
    s_add_u32 s1, s1, s54
    s_lshl_b32 s1, s1, 8
    s_add_u32 s1, s1, s43
    ds_read_b128 v[220:223], v1 offset:44032
    v_mfma_f32_32x32x16_bf16 v[160:175], v[196:199], v[80:83], v[160:175]
    ds_read_b128 v[192:195], v1 offset:16384
    buffer_load_dwordx4 v[124:127], v1, s[8:11], s50 offen offset:3072 sc1
    s_waitcnt lgkmcnt(5)
    s_waitcnt vmcnt(10)
    v_mfma_f32_32x32x16_bf16 v[144:159], v[200:203], v[84:87], v[144:159]
    ds_read_b128 v[196:199], v1 offset:45056
    v_mfma_f32_32x32x16_bf16 v[160:175], v[204:207], v[84:87], v[160:175]
    ds_read_b128 v[200:203], v1 offset:17408
    s_add_u32 s50, s51, 24576
    buffer_load_dwordx4 v[128:131], v1, s[8:11], s50 offen offset:0 sc1
    s_waitcnt lgkmcnt(5)
    s_waitcnt vmcnt(10)
    v_mfma_f32_32x32x16_bf16 v[144:159], v[208:211], v[88:91], v[144:159]
    ds_read_b128 v[204:207], v1 offset:46080
    v_mfma_f32_32x32x16_bf16 v[160:175], v[212:215], v[88:91], v[160:175]
    ds_read_b128 v[208:211], v1 offset:18432
    buffer_load_dwordx4 v[132:135], v1, s[8:11], s50 offen offset:1024 sc1
    s_waitcnt lgkmcnt(5)
    s_waitcnt vmcnt(10)
    v_mfma_f32_32x32x16_bf16 v[144:159], v[216:219], v[92:95], v[144:159]
    ds_read_b128 v[212:215], v1 offset:47104
    v_mfma_f32_32x32x16_bf16 v[160:175], v[220:223], v[92:95], v[160:175]
    ds_read_b128 v[216:219], v1 offset:19456
    buffer_load_dwordx4 v[136:139], v1, s[8:11], s50 offen offset:2048 sc1
    s_waitcnt lgkmcnt(5)
    s_waitcnt vmcnt(10)
    v_mfma_f32_32x32x16_bf16 v[144:159], v[192:195], v[96:99], v[144:159]
    ds_read_b128 v[220:223], v1 offset:48128
    v_mfma_f32_32x32x16_bf16 v[160:175], v[196:199], v[96:99], v[160:175]
    ds_read_b128 v[192:195], v1 offset:20480
    buffer_load_dwordx4 v[140:143], v1, s[8:11], s50 offen offset:3072 sc1
    s_waitcnt lgkmcnt(5)
    s_waitcnt vmcnt(10)
    v_mfma_f32_32x32x16_bf16 v[144:159], v[200:203], v[100:103], v[144:159]
    ds_read_b128 v[196:199], v1 offset:49152
    v_mfma_f32_32x32x16_bf16 v[160:175], v[204:207], v[100:103], v[160:175]
    ds_read_b128 v[200:203], v1 offset:21504
    s_waitcnt lgkmcnt(5)
    s_waitcnt vmcnt(9)
    v_mfma_f32_32x32x16_bf16 v[144:159], v[208:211], v[104:107], v[144:159]
    s_add_u32 m0, s26, 86016
    s_add_u32 s24, s25, 86016
    buffer_load_dwordx4 v1, s[8:11], s24 offen offset:0 lds
    ds_read_b128 v[204:207], v1 offset:50176
    v_mfma_f32_32x32x16_bf16 v[160:175], v[212:215], v[104:107], v[160:175]
    buffer_load_dwordx4 v1, s[8:11], s24 offen offset:1024 lds
    ds_read_b128 v[208:211], v1 offset:22528
    s_waitcnt lgkmcnt(5)
    s_waitcnt vmcnt(10)
    v_mfma_f32_32x32x16_bf16 v[144:159], v[216:219], v[108:111], v[144:159]
    ds_read_b128 v[212:215], v1 offset:51200
    v_mfma_f32_32x32x16_bf16 v[160:175], v[220:223], v[108:111], v[160:175]
    buffer_load_dwordx4 v1, s[8:11], s24 offen offset:2048 lds
    ds_read_b128 v[216:219], v1 offset:23552
    s_waitcnt lgkmcnt(5)
    s_waitcnt vmcnt(10)
    v_mfma_f32_32x32x16_bf16 v[144:159], v[192:195], v[112:115], v[144:159]
    buffer_load_dwordx4 v1, s[8:11], s24 offen offset:3072 lds
    ds_read_b128 v[220:223], v1 offset:52224
    v_mfma_f32_32x32x16_bf16 v[160:175], v[196:199], v[112:115], v[160:175]
    ds_read_b128 v[192:195], v1 offset:24576
    s_waitcnt lgkmcnt(5)
    s_waitcnt vmcnt(10)
    v_mfma_f32_32x32x16_bf16 v[144:159], v[200:203], v[116:119], v[144:159]
    s_add_u32 m0, s26, 90112
    s_add_u32 s24, s25, 90112
    buffer_load_dwordx4 v1, s[8:11], s24 offen offset:0 lds
    ds_read_b128 v[196:199], v1 offset:53248
    v_mfma_f32_32x32x16_bf16 v[160:175], v[204:207], v[116:119], v[160:175]
    buffer_load_dwordx4 v1, s[8:11], s24 offen offset:1024 lds
    ds_read_b128 v[200:203], v1 offset:25600
    s_waitcnt lgkmcnt(5)
    s_waitcnt vmcnt(11)
    v_mfma_f32_32x32x16_bf16 v[144:159], v[208:211], v[120:123], v[144:159]
    ds_read_b128 v[204:207], v1 offset:54272
    v_mfma_f32_32x32x16_bf16 v[160:175], v[212:215], v[120:123], v[160:175]
    buffer_load_dwordx4 v1, s[8:11], s24 offen offset:2048 lds
    ds_read_b128 v[208:211], v1 offset:26624
    s_waitcnt lgkmcnt(5)
    s_waitcnt vmcnt(11)
    v_mfma_f32_32x32x16_bf16 v[144:159], v[216:219], v[124:127], v[144:159]
    s_add_u32 m0, s26, 114688
    s_add_u32 s24, s25, 114688
    buffer_load_dwordx4 v1, s[8:11], s24 offen offset:0 lds
    ds_read_b128 v[212:215], v1 offset:55296
    v_mfma_f32_32x32x16_bf16 v[160:175], v[220:223], v[124:127], v[160:175]
    ds_read_b128 v[216:219], v1 offset:27648
    s_waitcnt lgkmcnt(5)
    s_waitcnt vmcnt(11)
    v_mfma_f32_32x32x16_bf16 v[144:159], v[192:195], v[128:131], v[144:159]
    buffer_load_dwordx4 v1, s[8:11], s24 offen offset:1024 lds
    ds_read_b128 v[220:223], v1 offset:56320
    v_mfma_f32_32x32x16_bf16 v[160:175], v[196:199], v[128:131], v[160:175]
    buffer_load_dwordx4 v1, s[8:11], s24 offen offset:2048 lds
    ds_read_b128 v[192:195], v16 offset:1024
    s_waitcnt lgkmcnt(5)
    s_waitcnt vmcnt(12)
    v_mfma_f32_32x32x16_bf16 v[144:159], v[200:203], v[132:135], v[144:159]
    ds_read_b128 v[196:199], v16 offset:2048
    v_mfma_f32_32x32x16_bf16 v[160:175], v[204:207], v[132:135], v[160:175]
    buffer_load_dwordx4 v1, s[8:11], s24 offen offset:3072 lds
    ds_read_b128 v[200:203], v14 offset:0
    s_waitcnt lgkmcnt(5)
    s_waitcnt vmcnt(12)
    v_mfma_f32_32x32x16_bf16 v[144:159], v[208:211], v[136:139], v[144:159]
    s_add_u32 m0, s26, 118784
    s_add_u32 s24, s25, 118784
    buffer_load_dwordx4 v1, s[8:11], s24 offen offset:0 lds
    ds_read_b128 v[204:207], v14 offset:1024
    v_mfma_f32_32x32x16_bf16 v[160:175], v[212:215], v[136:139], v[160:175]
    ds_read_b128 v[208:211], v14 offset:2048
    s_waitcnt lgkmcnt(5)
    s_waitcnt vmcnt(12)
    v_mfma_f32_32x32x16_bf16 v[144:159], v[216:219], v[140:143], v[144:159]
    buffer_load_dwordx4 v1, s[8:11], s24 offen offset:1024 lds
    ds_read_b128 v[212:215], v14 offset:3072
    v_mfma_f32_32x32x16_bf16 v[160:175], v[220:223], v[140:143], v[160:175]
    buffer_load_dwordx4 v1, s[8:11], s24 offen offset:2048 lds
    ds_read_b128 v[216:219], v14 offset:4096
    s_waitcnt lgkmcnt(5)
    v_mfma_f32_32x32x16_bf16 v[144:159], v[192:195], v[28:31], v[144:159]
    ds_read_b128 v[220:223], v14 offset:5120
    v_mfma_f32_32x32x16_bf16 v[160:175], v[196:199], v[28:31], v[160:175]
    ds_read_b128 v[192:195], v14 offset:6144
    s_waitcnt lgkmcnt(5)
    v_mfma_f32_32x32x16_bf16 v[176:191], v[200:203], v[32:35], 0
    ds_read_b128 v[196:199], v14 offset:7168
    v_mfma_f32_32x32x16_bf16 v[176:191], v[204:207], v[36:39], v[176:191]
    s_nop 4
    v_mul_f32 v224, v17, v144
    ds_read_b128 v[200:203], v14 offset:8192
    s_waitcnt lgkmcnt(5)
    v_mfma_f32_32x32x16_bf16 v[176:191], v[208:211], v[40:43], v[176:191]
    v_mul_f32 v225, v17, v145
    v_mul_f32 v226, v17, v146
    v_mul_f32 v227, v17, v147
    v_mul_f32 v228, v17, v148
    v_mul_f32 v229, v17, v149
    ds_read_b128 v[204:207], v14 offset:9216
    v_mfma_f32_32x32x16_bf16 v[176:191], v[212:215], v[44:47], v[176:191]
    v_mul_f32 v230, v17, v150
    v_mul_f32 v231, v17, v151
    v_exp_f32 v224, v224
    ds_read_b128 v[208:211], v14 offset:10240
    s_waitcnt lgkmcnt(5)
    v_mfma_f32_32x32x16_bf16 v[176:191], v[216:219], v[48:51], v[176:191]
    v_mul_f32 v144, v144, v152
    v_exp_f32 v225, v225
    v_mul_f32 v145, v145, v153
    ds_read_b128 v[212:215], v14 offset:11264
    v_mfma_f32_32x32x16_bf16 v[176:191], v[220:223], v[52:55], v[176:191]
    v_exp_f32 v226, v226
    v_mul_f32 v146, v146, v154
    ds_read_b128 v[216:219], v14 offset:12288
    s_waitcnt lgkmcnt(5)
    v_mfma_f32_32x32x16_bf16 v[176:191], v[192:195], v[56:59], v[176:191]
    v_exp_f32 v227, v227
    v_mul_f32 v147, v147, v155
    v_exp_f32 v228, v228
    ds_read_b128 v[220:223], v14 offset:13312
    v_mfma_f32_32x32x16_bf16 v[176:191], v[196:199], v[60:63], v[176:191]
    v_mul_f32 v148, v148, v156
    v_exp_f32 v229, v229
    v_mul_f32 v149, v149, v157
    ds_read_b128 v[192:195], v14 offset:14336
    s_waitcnt lgkmcnt(5)
    v_mfma_f32_32x32x16_bf16 v[176:191], v[200:203], v[64:67], v[176:191]
    v_exp_f32 v230, v230
    v_mul_f32 v150, v150, v158
    v_exp_f32 v231, v231
    ds_read_b128 v[196:199], v14 offset:15360
    v_mfma_f32_32x32x16_bf16 v[176:191], v[204:207], v[68:71], v[176:191]
    v_mul_f32 v151, v151, v159
    v_add_f32 v224, 1.0, v224
    v_add_f32 v225, 1.0, v225
    v_add_f32 v226, 1.0, v226
    ds_read_b128 v[200:203], v14 offset:16384
    s_waitcnt lgkmcnt(5)
    v_mfma_f32_32x32x16_bf16 v[176:191], v[208:211], v[72:75], v[176:191]
    v_add_f32 v227, 1.0, v227
    v_add_f32 v228, 1.0, v228
    v_add_f32 v229, 1.0, v229
    v_add_f32 v230, 1.0, v230
    v_add_f32 v231, 1.0, v231
    ds_read_b128 v[204:207], v14 offset:17408
    v_mfma_f32_32x32x16_bf16 v[176:191], v[212:215], v[76:79], v[176:191]
    v_rcp_f32 v224, v224
    v_rcp_f32 v225, v225
    ds_read_b128 v[208:211], v14 offset:18432
    s_waitcnt lgkmcnt(5)
    v_mfma_f32_32x32x16_bf16 v[176:191], v[216:219], v[80:83], v[176:191]
    v_mul_f32 v144, v144, v224
    v_rcp_f32 v226, v226
    v_mul_f32 v145, v145, v225
    ds_read_b128 v[212:215], v14 offset:19456
    v_mfma_f32_32x32x16_bf16 v[176:191], v[220:223], v[84:87], v[176:191]
    v_rcp_f32 v227, v227
    v_mul_f32 v146, v146, v226
    ds_read_b128 v[216:219], v14 offset:20480
    s_waitcnt lgkmcnt(5)
    v_mfma_f32_32x32x16_bf16 v[176:191], v[192:195], v[88:91], v[176:191]
    v_rcp_f32 v228, v228
    v_mul_f32 v147, v147, v227
    v_rcp_f32 v229, v229
    ds_read_b128 v[220:223], v14 offset:21504
    v_mfma_f32_32x32x16_bf16 v[176:191], v[196:199], v[92:95], v[176:191]
    v_mul_f32 v148, v148, v228
    v_rcp_f32 v230, v230
    v_mul_f32 v149, v149, v229
    ds_read_b128 v[192:195], v14 offset:22528
    s_waitcnt lgkmcnt(5)
    v_mfma_f32_32x32x16_bf16 v[176:191], v[200:203], v[96:99], v[176:191]
    v_rcp_f32 v231, v231
    v_mul_f32 v150, v150, v230
    v_mul_f32 v151, v151, v231
    v_cvt_pk_bf16_f32 v240, v144, v145
    ds_read_b128 v[196:199], v14 offset:23552
    v_mfma_f32_32x32x16_bf16 v[176:191], v[204:207], v[100:103], v[176:191]
    v_cvt_pk_bf16_f32 v241, v146, v147
    v_cvt_pk_bf16_f32 v242, v148, v149
    v_cvt_pk_bf16_f32 v243, v150, v151
    ds_read_b128 v[200:203], v14 offset:24576
    s_waitcnt lgkmcnt(5)
    v_mfma_f32_32x32x16_bf16 v[176:191], v[208:211], v[104:107], v[176:191]
    buffer_store_dwordx4 v[240:243], v1, s[8:11], s61 offen offset:0
    v_mul_f32 v232, v17, v160
    ds_read_b128 v[204:207], v14 offset:25600
    v_mfma_f32_32x32x16_bf16 v[176:191], v[212:215], v[108:111], v[176:191]
    v_mul_f32 v233, v17, v161
    v_mul_f32 v234, v17, v162
    v_mul_f32 v235, v17, v163
    v_mul_f32 v236, v17, v164
    ds_read_b128 v[208:211], v14 offset:26624
    s_waitcnt lgkmcnt(5)
    v_mfma_f32_32x32x16_bf16 v[176:191], v[216:219], v[112:115], v[176:191]
    v_mul_f32 v237, v17, v165
    v_mul_f32 v238, v17, v166
    v_mul_f32 v239, v17, v167
    v_exp_f32 v232, v232
    ds_read_b128 v[212:215], v14 offset:27648
    v_mfma_f32_32x32x16_bf16 v[176:191], v[220:223], v[116:119], v[176:191]
    v_mul_f32 v160, v160, v168
    v_exp_f32 v233, v233
    v_mul_f32 v161, v161, v169
    ds_read_b128 v[216:219], v16 offset:3072
    s_waitcnt lgkmcnt(5)
    v_mfma_f32_32x32x16_bf16 v[176:191], v[192:195], v[120:123], v[176:191]
    s_waitcnt vmcnt(1)
    s_waitcnt lgkmcnt(0)
    s_barrier
    ds_read_b128 v[220:223], v14 offset:28672
    v_mfma_f32_32x32x16_bf16 v[176:191], v[196:199], v[124:127], v[176:191]
    v_exp_f32 v234, v234
    v_mul_f32 v162, v162, v170
    ds_read_b128 v[192:195], v14 offset:29696
    v_mfma_f32_32x32x16_bf16 v[176:191], v[200:203], v[128:131], v[176:191]
    v_exp_f32 v235, v235
    v_mul_f32 v163, v163, v171
    v_exp_f32 v236, v236
    ds_read_b128 v[196:199], v14 offset:30720
    v_mfma_f32_32x32x16_bf16 v[176:191], v[204:207], v[132:135], v[176:191]
    v_mul_f32 v164, v164, v172
    v_exp_f32 v237, v237
    v_mul_f32 v165, v165, v173
    ds_read_b128 v[200:203], v14 offset:31744
    v_mfma_f32_32x32x16_bf16 v[176:191], v[208:211], v[136:139], v[176:191]
    v_exp_f32 v238, v238
    v_mul_f32 v166, v166, v174
    v_exp_f32 v239, v239
    ds_read_b128 v[204:207], v14 offset:32768
    v_mfma_f32_32x32x16_bf16 v[176:191], v[212:215], v[140:143], v[176:191]
    v_mul_f32 v167, v167, v175
    v_add_f32 v232, 1.0, v232
    v_add_f32 v233, 1.0, v233
    v_add_f32 v234, 1.0, v234
    ds_read_b128 v[208:211], v14 offset:33792
    s_waitcnt lgkmcnt(5)
    v_mfma_f32_32x32x16_bf16 v[176:191], v[216:219], v[28:31], v[176:191]
    v_add_f32 v235, 1.0, v235
    v_add_f32 v236, 1.0, v236
    v_add_f32 v237, 1.0, v237
    v_add_f32 v238, 1.0, v238
    v_add_f32 v239, 1.0, v239
    ds_read_b128 v[212:215], v14 offset:34816
    v_mfma_f32_32x32x16_bf16 v[144:159], v[220:223], v[32:35], 0
    v_rcp_f32 v232, v232
    v_rcp_f32 v233, v233
    ds_read_b128 v[216:219], v14 offset:35840
    s_waitcnt lgkmcnt(5)
    v_mfma_f32_32x32x16_bf16 v[144:159], v[192:195], v[36:39], v[144:159]
    v_mul_f32 v160, v160, v232
    v_rcp_f32 v234, v234
    v_mul_f32 v161, v161, v233
    ds_read_b128 v[220:223], v14 offset:36864
    v_mfma_f32_32x32x16_bf16 v[144:159], v[196:199], v[40:43], v[144:159]
    v_rcp_f32 v235, v235
    v_mul_f32 v162, v162, v234
    ds_read_b128 v[192:195], v14 offset:37888
    s_waitcnt lgkmcnt(5)
    v_mfma_f32_32x32x16_bf16 v[144:159], v[200:203], v[44:47], v[144:159]
    v_rcp_f32 v236, v236
    v_mul_f32 v163, v163, v235
    v_rcp_f32 v237, v237
    ds_read_b128 v[196:199], v14 offset:38912
    v_mfma_f32_32x32x16_bf16 v[144:159], v[204:207], v[48:51], v[144:159]
    v_mul_f32 v164, v164, v236
    v_rcp_f32 v238, v238
    v_mul_f32 v165, v165, v237
    ds_read_b128 v[200:203], v14 offset:39936
    s_waitcnt lgkmcnt(5)
    v_mfma_f32_32x32x16_bf16 v[144:159], v[208:211], v[52:55], v[144:159]
    v_rcp_f32 v239, v239
    v_mul_f32 v166, v166, v238
    v_mul_f32 v167, v167, v239
    v_cvt_pk_bf16_f32 v244, v160, v161
    ds_read_b128 v[204:207], v14 offset:40960
    v_mfma_f32_32x32x16_bf16 v[144:159], v[212:215], v[56:59], v[144:159]
    v_cvt_pk_bf16_f32 v245, v162, v163
    v_cvt_pk_bf16_f32 v246, v164, v165
    v_cvt_pk_bf16_f32 v247, v166, v167
    ds_read_b128 v[208:211], v14 offset:41984
    s_waitcnt lgkmcnt(5)
    v_mfma_f32_32x32x16_bf16 v[144:159], v[216:219], v[60:63], v[144:159]
    buffer_store_dwordx4 v[244:247], v1, s[8:11], s61 offen offset:1024
    v_mul_f32 v224, v17, v176
    ds_read_b128 v[212:215], v14 offset:43008
    v_mfma_f32_32x32x16_bf16 v[144:159], v[220:223], v[64:67], v[144:159]
    v_mul_f32 v225, v17, v177
    v_mul_f32 v226, v17, v178
    s_add_u32 m0, s26, 0
    s_add_u32 s24, s25, 143360
    ds_read_b128 v[216:219], v14 offset:44032
    s_waitcnt lgkmcnt(5)
    v_mfma_f32_32x32x16_bf16 v[144:159], v[192:195], v[68:71], v[144:159]
    buffer_load_dwordx4 v1, s[8:11], s24 offen offset:0 lds
    v_mul_f32 v227, v17, v179
    v_mul_f32 v228, v17, v180
    v_mul_f32 v229, v17, v181
    buffer_load_dwordx4 v1, s[8:11], s24 offen offset:1024 lds
    ds_read_b128 v[220:223], v14 offset:45056
    v_mfma_f32_32x32x16_bf16 v[144:159], v[196:199], v[72:75], v[144:159]
    v_mul_f32 v230, v17, v182
    v_mul_f32 v231, v17, v183
    v_exp_f32 v224, v224
    ds_read_b128 v[192:195], v14 offset:46080
    s_waitcnt lgkmcnt(5)
    v_mfma_f32_32x32x16_bf16 v[144:159], v[200:203], v[76:79], v[144:159]
    buffer_load_dwordx4 v1, s[8:11], s24 offen offset:2048 lds
    v_mul_f32 v176, v176, v184
    v_exp_f32 v225, v225
    v_mul_f32 v177, v177, v185
    ds_read_b128 v[196:199], v14 offset:47104
    v_mfma_f32_32x32x16_bf16 v[144:159], v[204:207], v[80:83], v[144:159]
    buffer_load_dwordx4 v1, s[8:11], s24 offen offset:3072 lds
    v_exp_f32 v226, v226
    v_mul_f32 v178, v178, v186
    ds_read_b128 v[200:203], v14 offset:48128
    s_waitcnt lgkmcnt(5)
    v_mfma_f32_32x32x16_bf16 v[144:159], v[208:211], v[84:87], v[144:159]
    v_exp_f32 v227, v227
    s_add_u32 m0, s26, 4096
    s_add_u32 s24, s25, 147456
    buffer_load_dwordx4 v1, s[8:11], s24 offen offset:0 lds
    ds_read_b128 v[204:207], v14 offset:49152
    v_mfma_f32_32x32x16_bf16 v[144:159], v[212:215], v[88:91], v[144:159]
    v_mul_f32 v179, v179, v187
    v_exp_f32 v228, v228
    v_mul_f32 v180, v180, v188
    ds_read_b128 v[208:211], v14 offset:50176
    s_waitcnt lgkmcnt(5)
    v_mfma_f32_32x32x16_bf16 v[144:159], v[216:219], v[92:95], v[144:159]
    buffer_load_dwordx4 v1, s[8:11], s24 offen offset:1024 lds
    v_exp_f32 v229, v229
    v_mul_f32 v181, v181, v189
    ds_read_b128 v[212:215], v14 offset:51200
    v_mfma_f32_32x32x16_bf16 v[144:159], v[220:223], v[96:99], v[144:159]
    v_exp_f32 v230, v230
    buffer_load_dwordx4 v1, s[8:11], s24 offen offset:2048 lds
    v_mul_f32 v182, v182, v190
    ds_read_b128 v[216:219], v14 offset:52224
    s_waitcnt lgkmcnt(5)
    v_mfma_f32_32x32x16_bf16 v[144:159], v[192:195], v[100:103], v[144:159]
    v_exp_f32 v231, v231
    v_mul_f32 v183, v183, v191
    s_add_u32 m0, s26, 28672
    s_add_u32 s24, s25, 172032
    ds_read_b128 v[220:223], v14 offset:53248
    v_mfma_f32_32x32x16_bf16 v[144:159], v[196:199], v[104:107], v[144:159]
    buffer_load_dwordx4 v1, s[8:11], s24 offen offset:0 lds
    v_add_f32 v224, 1.0, v224
    v_add_f32 v225, 1.0, v225
    v_add_f32 v226, 1.0, v226
    ds_read_b128 v[192:195], v14 offset:54272
    s_waitcnt lgkmcnt(5)
    v_mfma_f32_32x32x16_bf16 v[144:159], v[200:203], v[108:111], v[144:159]
    buffer_load_dwordx4 v1, s[8:11], s24 offen offset:1024 lds
    v_add_f32 v227, 1.0, v227
    v_add_f32 v228, 1.0, v228
    v_add_f32 v229, 1.0, v229
    buffer_load_dwordx4 v1, s[8:11], s24 offen offset:2048 lds
    ds_read_b128 v[196:199], v14 offset:55296
    v_mfma_f32_32x32x16_bf16 v[144:159], v[204:207], v[112:115], v[144:159]
    v_add_f32 v230, 1.0, v230
    v_add_f32 v231, 1.0, v231
    v_rcp_f32 v224, v224
    ds_read_b128 v[200:203], v14 offset:56320
    s_waitcnt lgkmcnt(5)
    v_mfma_f32_32x32x16_bf16 v[144:159], v[208:211], v[116:119], v[144:159]
    buffer_load_dwordx4 v1, s[8:11], s24 offen offset:3072 lds
    v_rcp_f32 v225, v225
    v_mul_f32 v176, v176, v224
    ds_read_b128 v[204:207], v16 offset:4096
    v_mfma_f32_32x32x16_bf16 v[144:159], v[212:215], v[120:123], v[144:159]
    v_rcp_f32 v226, v226
    s_add_u32 m0, s26, 32768
    s_add_u32 s24, s25, 176128
    ds_read_b128 v[208:211], v15 offset:0
    s_waitcnt lgkmcnt(5)
    v_mfma_f32_32x32x16_bf16 v[144:159], v[216:219], v[124:127], v[144:159]
    buffer_load_dwordx4 v1, s[8:11], s24 offen offset:0 lds
    v_mul_f32 v177, v177, v225
    v_rcp_f32 v227, v227
    v_mul_f32 v178, v178, v226
    ds_read_b128 v[212:215], v15 offset:1024
    v_mfma_f32_32x32x16_bf16 v[144:159], v[220:223], v[128:131], v[144:159]
    buffer_load_dwordx4 v1, s[8:11], s24 offen offset:1024 lds
    v_rcp_f32 v228, v228
    v_mul_f32 v179, v179, v227
    ds_read_b128 v[216:219], v15 offset:2048
    s_waitcnt lgkmcnt(5)
    v_mfma_f32_32x32x16_bf16 v[144:159], v[192:195], v[132:135], v[144:159]
    v_rcp_f32 v229, v229
    buffer_load_dwordx4 v1, s[8:11], s24 offen offset:2048 lds
    v_mul_f32 v180, v180, v228
    ds_read_b128 v[220:223], v15 offset:3072
    v_mfma_f32_32x32x16_bf16 v[144:159], v[196:199], v[136:139], v[144:159]
    v_rcp_f32 v230, v230
    v_mul_f32 v181, v181, v229
    ds_read_b128 v[192:195], v15 offset:4096
    s_waitcnt lgkmcnt(5)
    v_mfma_f32_32x32x16_bf16 v[144:159], v[200:203], v[140:143], v[144:159]
    ds_read_b128 v[196:199], v15 offset:5120
    v_mfma_f32_32x32x16_bf16 v[144:159], v[204:207], v[28:31], v[144:159]
    v_rcp_f32 v231, v231
    v_mul_f32 v182, v182, v230
    v_mul_f32 v183, v183, v231
    ds_read_b128 v[200:203], v15 offset:6144
    s_waitcnt lgkmcnt(5)
    v_mfma_f32_32x32x16_bf16 v[160:175], v[208:211], v[32:35], 0
    v_cvt_pk_bf16_f32 v240, v176, v177
    v_cvt_pk_bf16_f32 v241, v178, v179
    v_cvt_pk_bf16_f32 v242, v180, v181
    v_cvt_pk_bf16_f32 v243, v182, v183
    ds_read_b128 v[204:207], v15 offset:7168
    v_mfma_f32_32x32x16_bf16 v[160:175], v[212:215], v[36:39], v[160:175]
    buffer_store_dwordx4 v[240:243], v1, s[8:11], s61 offen offset:2048
    ds_read_b128 v[208:211], v15 offset:8192
    s_waitcnt lgkmcnt(5)
    v_mfma_f32_32x32x16_bf16 v[160:175], v[216:219], v[40:43], v[160:175]
    v_mul_f32 v232, v17, v144
    v_mul_f32 v233, v17, v145
    v_mul_f32 v234, v17, v146
    v_mul_f32 v235, v17, v147
    v_mul_f32 v236, v17, v148
    ds_read_b128 v[212:215], v15 offset:9216
    v_mfma_f32_32x32x16_bf16 v[160:175], v[220:223], v[44:47], v[160:175]
    v_mul_f32 v237, v17, v149
    v_mul_f32 v238, v17, v150
    v_mul_f32 v239, v17, v151
    ds_read_b128 v[216:219], v15 offset:10240
    s_waitcnt lgkmcnt(5)
    v_mfma_f32_32x32x16_bf16 v[160:175], v[192:195], v[48:51], v[160:175]
    v_exp_f32 v232, v232
    v_mul_f32 v144, v144, v152
    v_exp_f32 v233, v233
    ds_read_b128 v[220:223], v15 offset:11264
    v_mfma_f32_32x32x16_bf16 v[160:175], v[196:199], v[52:55], v[160:175]
    v_mul_f32 v145, v145, v153
    v_exp_f32 v234, v234
    v_mul_f32 v146, v146, v154
    ds_read_b128 v[192:195], v15 offset:12288
    s_waitcnt lgkmcnt(5)
    v_mfma_f32_32x32x16_bf16 v[160:175], v[200:203], v[56:59], v[160:175]
    v_exp_f32 v235, v235
    v_mul_f32 v147, v147, v155
    v_exp_f32 v236, v236
    ds_read_b128 v[196:199], v15 offset:13312
    v_mfma_f32_32x32x16_bf16 v[160:175], v[204:207], v[60:63], v[160:175]
    v_mul_f32 v148, v148, v156
    v_exp_f32 v237, v237
    v_mul_f32 v149, v149, v157
    ds_read_b128 v[200:203], v15 offset:14336
    s_waitcnt lgkmcnt(5)
    v_mfma_f32_32x32x16_bf16 v[160:175], v[208:211], v[64:67], v[160:175]
    v_exp_f32 v238, v238
    v_mul_f32 v150, v150, v158
    v_exp_f32 v239, v239
    ds_read_b128 v[204:207], v15 offset:15360
    v_mfma_f32_32x32x16_bf16 v[160:175], v[212:215], v[68:71], v[160:175]
    v_mul_f32 v151, v151, v159
    v_add_f32 v232, 1.0, v232
    v_add_f32 v233, 1.0, v233
    v_add_f32 v234, 1.0, v234
    ds_read_b128 v[208:211], v15 offset:16384
    s_waitcnt lgkmcnt(5)
    v_mfma_f32_32x32x16_bf16 v[160:175], v[216:219], v[72:75], v[160:175]
    v_add_f32 v235, 1.0, v235
    v_add_f32 v236, 1.0, v236
    v_add_f32 v237, 1.0, v237
    v_add_f32 v238, 1.0, v238
    v_add_f32 v239, 1.0, v239
    ds_read_b128 v[212:215], v15 offset:17408
    v_mfma_f32_32x32x16_bf16 v[160:175], v[220:223], v[76:79], v[160:175]
    v_rcp_f32 v232, v232
    v_rcp_f32 v233, v233
    ds_read_b128 v[216:219], v15 offset:18432
    s_waitcnt lgkmcnt(5)
    v_mfma_f32_32x32x16_bf16 v[160:175], v[192:195], v[80:83], v[160:175]
    v_mul_f32 v144, v144, v232
    v_rcp_f32 v234, v234
    v_mul_f32 v145, v145, v233
    ds_read_b128 v[220:223], v15 offset:19456
    v_mfma_f32_32x32x16_bf16 v[160:175], v[196:199], v[84:87], v[160:175]
    v_rcp_f32 v235, v235
    v_mul_f32 v146, v146, v234
    ds_read_b128 v[192:195], v15 offset:20480
    s_waitcnt lgkmcnt(5)
    v_mfma_f32_32x32x16_bf16 v[160:175], v[200:203], v[88:91], v[160:175]
    v_rcp_f32 v236, v236
    v_mul_f32 v147, v147, v235
    v_rcp_f32 v237, v237
    ds_read_b128 v[196:199], v15 offset:21504
    v_mfma_f32_32x32x16_bf16 v[160:175], v[204:207], v[92:95], v[160:175]
    v_mul_f32 v148, v148, v236
    v_rcp_f32 v238, v238
    v_mul_f32 v149, v149, v237
    ds_read_b128 v[200:203], v15 offset:22528
    s_waitcnt lgkmcnt(5)
    v_mfma_f32_32x32x16_bf16 v[160:175], v[208:211], v[96:99], v[160:175]
    v_rcp_f32 v239, v239
    v_mul_f32 v150, v150, v238
    v_mul_f32 v151, v151, v239
    v_cvt_pk_bf16_f32 v244, v144, v145
    ds_read_b128 v[204:207], v15 offset:23552
    v_mfma_f32_32x32x16_bf16 v[160:175], v[212:215], v[100:103], v[160:175]
    v_cvt_pk_bf16_f32 v245, v146, v147
    v_cvt_pk_bf16_f32 v246, v148, v149
    v_cvt_pk_bf16_f32 v247, v150, v151
    ds_read_b128 v[208:211], v15 offset:24576
    s_waitcnt lgkmcnt(5)
    v_mfma_f32_32x32x16_bf16 v[160:175], v[216:219], v[104:107], v[160:175]
    buffer_store_dwordx4 v[244:247], v1, s[8:11], s61 offen offset:3072
    ds_read_b128 v[212:215], v15 offset:25600
    v_mfma_f32_32x32x16_bf16 v[160:175], v[220:223], v[108:111], v[160:175]
    ds_read_b128 v[216:219], v15 offset:26624
    s_waitcnt lgkmcnt(5)
    v_mfma_f32_32x32x16_bf16 v[160:175], v[192:195], v[112:115], v[160:175]
    ds_read_b128 v[220:223], v15 offset:27648
    v_mfma_f32_32x32x16_bf16 v[160:175], v[196:199], v[116:119], v[160:175]
    ds_read_b128 v[192:195], v16 offset:5120
    s_waitcnt lgkmcnt(5)
    v_mfma_f32_32x32x16_bf16 v[160:175], v[200:203], v[120:123], v[160:175]
    s_waitcnt vmcnt(2)
    s_waitcnt lgkmcnt(0)
    s_barrier
    ds_read_b128 v[196:199], v1 offset:0
    v_mfma_f32_32x32x16_bf16 v[160:175], v[204:207], v[124:127], v[160:175]
    ds_read_b128 v[200:203], v1 offset:1024
    v_mfma_f32_32x32x16_bf16 v[160:175], v[208:211], v[128:131], v[160:175]
    ds_read_b128 v[204:207], v1 offset:2048
    v_mfma_f32_32x32x16_bf16 v[160:175], v[212:215], v[132:135], v[160:175]
    ds_read_b128 v[208:211], v1 offset:3072
    v_mfma_f32_32x32x16_bf16 v[160:175], v[216:219], v[136:139], v[160:175]
    ds_read_b128 v[212:215], v1 offset:4096
    v_mfma_f32_32x32x16_bf16 v[160:175], v[220:223], v[140:143], v[160:175]
    ds_read_b128 v[216:219], v1 offset:5120
    s_waitcnt lgkmcnt(5)
    v_mfma_f32_32x32x16_bf16 v[160:175], v[192:195], v[28:31], v[160:175]
    ds_read_b128 v[220:223], v1 offset:6144
    v_mfma_f32_32x32x16_bf16 v[176:191], v[196:199], v[32:35], 0
    ds_read_b128 v[192:195], v1 offset:7168
    s_waitcnt lgkmcnt(5)
    v_mfma_f32_32x32x16_bf16 v[176:191], v[200:203], v[36:39], v[176:191]
    ds_read_b128 v[196:199], v1 offset:8192
    v_mfma_f32_32x32x16_bf16 v[176:191], v[204:207], v[40:43], v[176:191]
    s_nop 4
    v_mul_f32 v224, v17, v160
    ds_read_b128 v[200:203], v1 offset:9216
    s_waitcnt lgkmcnt(5)
    v_mfma_f32_32x32x16_bf16 v[176:191], v[208:211], v[44:47], v[176:191]
    v_mul_f32 v225, v17, v161
    v_mul_f32 v226, v17, v162
    v_mul_f32 v227, v17, v163
    v_mul_f32 v228, v17, v164
    v_mul_f32 v229, v17, v165
    ds_read_b128 v[204:207], v1 offset:10240
    v_mfma_f32_32x32x16_bf16 v[176:191], v[212:215], v[48:51], v[176:191]
    v_mul_f32 v230, v17, v166
    v_mul_f32 v231, v17, v167
    v_exp_f32 v224, v224
    ds_read_b128 v[208:211], v1 offset:11264
    s_waitcnt lgkmcnt(5)
    v_mfma_f32_32x32x16_bf16 v[176:191], v[216:219], v[52:55], v[176:191]
    v_mul_f32 v160, v160, v168
    v_exp_f32 v225, v225
    v_mul_f32 v161, v161, v169
    ds_read_b128 v[212:215], v1 offset:12288
    v_mfma_f32_32x32x16_bf16 v[176:191], v[220:223], v[56:59], v[176:191]
    v_exp_f32 v226, v226
    v_mul_f32 v162, v162, v170
    ds_read_b128 v[216:219], v1 offset:13312
    s_waitcnt lgkmcnt(5)
    v_mfma_f32_32x32x16_bf16 v[176:191], v[192:195], v[60:63], v[176:191]
    v_exp_f32 v227, v227
    v_mul_f32 v163, v163, v171
    v_exp_f32 v228, v228
    ds_read_b128 v[220:223], v1 offset:14336
    v_mfma_f32_32x32x16_bf16 v[176:191], v[196:199], v[64:67], v[176:191]
    v_mul_f32 v164, v164, v172
    v_exp_f32 v229, v229
    v_mul_f32 v165, v165, v173
    ds_read_b128 v[192:195], v1 offset:15360
    s_waitcnt lgkmcnt(5)
    v_mfma_f32_32x32x16_bf16 v[176:191], v[200:203], v[68:71], v[176:191]
    v_exp_f32 v230, v230
    v_mul_f32 v166, v166, v174
    v_exp_f32 v231, v231
    ds_read_b128 v[196:199], v1 offset:16384
    v_mfma_f32_32x32x16_bf16 v[176:191], v[204:207], v[72:75], v[176:191]
    v_mul_f32 v167, v167, v175
    v_add_f32 v224, 1.0, v224
    v_add_f32 v225, 1.0, v225
    v_add_f32 v226, 1.0, v226
    ds_read_b128 v[200:203], v1 offset:17408
    s_waitcnt lgkmcnt(5)
    v_mfma_f32_32x32x16_bf16 v[176:191], v[208:211], v[76:79], v[176:191]
    v_add_f32 v227, 1.0, v227
    v_add_f32 v228, 1.0, v228
    v_add_f32 v229, 1.0, v229
    ds_read_b128 v[204:207], v1 offset:18432
    v_mfma_f32_32x32x16_bf16 v[176:191], v[212:215], v[80:83], v[176:191]
    ds_read_b128 v[208:211], v1 offset:19456
    s_waitcnt lgkmcnt(5)
    v_mfma_f32_32x32x16_bf16 v[176:191], v[216:219], v[84:87], v[176:191]
    ds_read_b128 v[212:215], v1 offset:20480
    v_mfma_f32_32x32x16_bf16 v[176:191], v[220:223], v[88:91], v[176:191]
    ds_read_b128 v[216:219], v1 offset:21504
    s_waitcnt lgkmcnt(5)
    v_mfma_f32_32x32x16_bf16 v[176:191], v[192:195], v[92:95], v[176:191]
    ds_read_b128 v[220:223], v1 offset:22528
    v_mfma_f32_32x32x16_bf16 v[176:191], v[196:199], v[96:99], v[176:191]
    v_mov_b32 v18, 4
    s_waitcnt vmcnt(0)
    s_mov_b64 exec, 1
    buffer_store_dword v18, v11, s[8:11], s33 offen
    s_mov_b64 exec, -1
    ds_read_b128 v[192:195], v1 offset:23552
    s_waitcnt lgkmcnt(5)
    v_mfma_f32_32x32x16_bf16 v[176:191], v[200:203], v[100:103], v[176:191]
    v_add_f32 v230, 1.0, v230
    v_add_f32 v231, 1.0, v231
    v_rcp_f32 v224, v224
    ds_read_b128 v[196:199], v1 offset:24576
    v_mfma_f32_32x32x16_bf16 v[176:191], v[204:207], v[104:107], v[176:191]
    v_rcp_f32 v225, v225
    v_mul_f32 v160, v160, v224
    ds_read_b128 v[200:203], v1 offset:25600
    s_waitcnt lgkmcnt(5)
    v_mfma_f32_32x32x16_bf16 v[176:191], v[208:211], v[108:111], v[176:191]
    v_rcp_f32 v226, v226
    v_mul_f32 v161, v161, v225
    v_rcp_f32 v227, v227
    ds_read_b128 v[204:207], v1 offset:26624
    v_mfma_f32_32x32x16_bf16 v[176:191], v[212:215], v[112:115], v[176:191]
    v_mul_f32 v162, v162, v226
    v_rcp_f32 v228, v228
    v_mul_f32 v163, v163, v227
    ds_read_b128 v[208:211], v1 offset:27648
    s_waitcnt lgkmcnt(5)
    v_mfma_f32_32x32x16_bf16 v[176:191], v[216:219], v[116:119], v[176:191]
    v_rcp_f32 v229, v229
    v_mul_f32 v164, v164, v228
    v_rcp_f32 v230, v230
    ds_read_b128 v[212:215], v16 offset:6144
    v_mfma_f32_32x32x16_bf16 v[176:191], v[220:223], v[120:123], v[176:191]
    v_mul_f32 v165, v165, v229
    v_rcp_f32 v231, v231
    v_mul_f32 v166, v166, v230
    ds_read_b128 v[216:219], v1 offset:28672
    s_waitcnt lgkmcnt(5)
    v_mfma_f32_32x32x16_bf16 v[176:191], v[192:195], v[124:127], v[176:191]
    v_mul_f32 v167, v167, v231
    v_cvt_pk_bf16_f32 v240, v160, v161
    v_cvt_pk_bf16_f32 v241, v162, v163
    v_cvt_pk_bf16_f32 v242, v164, v165
    v_cvt_pk_bf16_f32 v243, v166, v167
    ds_read_b128 v[220:223], v1 offset:29696
    v_mfma_f32_32x32x16_bf16 v[176:191], v[196:199], v[128:131], v[176:191]
    s_add_u32 s61, s61, 4096
    buffer_store_dwordx4 v[240:243], v1, s[8:11], s61 offen offset:0
    ds_read_b128 v[192:195], v1 offset:30720
    s_waitcnt lgkmcnt(5)
    v_mfma_f32_32x32x16_bf16 v[176:191], v[200:203], v[132:135], v[176:191]
    ds_read_b128 v[196:199], v1 offset:31744
    v_mfma_f32_32x32x16_bf16 v[176:191], v[204:207], v[136:139], v[176:191]
    ds_read_b128 v[200:203], v1 offset:32768
    s_waitcnt lgkmcnt(5)
    v_mfma_f32_32x32x16_bf16 v[176:191], v[208:211], v[140:143], v[176:191]
    ds_read_b128 v[204:207], v1 offset:33792
    v_mfma_f32_32x32x16_bf16 v[176:191], v[212:215], v[28:31], v[176:191]
    ds_read_b128 v[208:211], v1 offset:34816
    s_waitcnt lgkmcnt(5)
    v_mfma_f32_32x32x16_bf16 v[144:159], v[216:219], v[32:35], 0
    ds_read_b128 v[212:215], v1 offset:35840
    v_mfma_f32_32x32x16_bf16 v[144:159], v[220:223], v[36:39], v[144:159]
    ds_read_b128 v[216:219], v1 offset:36864
    s_waitcnt lgkmcnt(5)
    v_mfma_f32_32x32x16_bf16 v[144:159], v[192:195], v[40:43], v[144:159]
    s_nop 3
    v_mul_f32 v232, v17, v176
    ds_read_b128 v[220:223], v1 offset:37888
    v_mfma_f32_32x32x16_bf16 v[144:159], v[196:199], v[44:47], v[144:159]
    v_mul_f32 v233, v17, v177
    v_mul_f32 v234, v17, v178
    v_mul_f32 v235, v17, v179
    v_mul_f32 v236, v17, v180
    ds_read_b128 v[192:195], v1 offset:38912
    s_waitcnt lgkmcnt(5)
    v_mfma_f32_32x32x16_bf16 v[144:159], v[200:203], v[48:51], v[144:159]
    v_mul_f32 v237, v17, v181
    v_mul_f32 v238, v17, v182
    v_mul_f32 v239, v17, v183
    v_exp_f32 v232, v232
    ds_read_b128 v[196:199], v1 offset:39936
    v_mfma_f32_32x32x16_bf16 v[144:159], v[204:207], v[52:55], v[144:159]
    v_mul_f32 v176, v176, v184
    v_exp_f32 v233, v233
    v_mul_f32 v177, v177, v185
    ds_read_b128 v[200:203], v1 offset:40960
    s_waitcnt lgkmcnt(5)
    v_mfma_f32_32x32x16_bf16 v[144:159], v[208:211], v[56:59], v[144:159]
    v_exp_f32 v234, v234
    v_mul_f32 v178, v178, v186
    v_exp_f32 v235, v235
    ds_read_b128 v[204:207], v1 offset:41984
    v_mfma_f32_32x32x16_bf16 v[144:159], v[212:215], v[60:63], v[144:159]
    v_mul_f32 v179, v179, v187
    v_exp_f32 v236, v236
    ds_read_b128 v[208:211], v1 offset:43008
    buffer_load_dword v19, v10, s[8:11], s34 offen sc1
    s_waitcnt lgkmcnt(5)
    v_mfma_f32_32x32x16_bf16 v[144:159], v[216:219], v[64:67], v[144:159]
    v_mul_f32 v180, v180, v188
    v_exp_f32 v237, v237
    v_mul_f32 v181, v181, v189
    ds_read_b128 v[212:215], v1 offset:44032
    v_mfma_f32_32x32x16_bf16 v[144:159], v[220:223], v[68:71], v[144:159]
    v_exp_f32 v238, v238
    v_mul_f32 v182, v182, v190
    ds_read_b128 v[216:219], v1 offset:45056
    s_waitcnt lgkmcnt(5)
    v_mfma_f32_32x32x16_bf16 v[144:159], v[192:195], v[72:75], v[144:159]
    v_exp_f32 v239, v239
    v_mul_f32 v183, v183, v191
    v_add_f32 v232, 1.0, v232
    v_add_f32 v233, 1.0, v233
    ds_read_b128 v[220:223], v1 offset:46080
    v_mfma_f32_32x32x16_bf16 v[144:159], v[196:199], v[76:79], v[144:159]
    v_add_f32 v234, 1.0, v234
    v_add_f32 v235, 1.0, v235
    v_add_f32 v236, 1.0, v236
    v_add_f32 v237, 1.0, v237
    ds_read_b128 v[192:195], v1 offset:47104
    s_waitcnt lgkmcnt(5)
    v_mfma_f32_32x32x16_bf16 v[144:159], v[200:203], v[80:83], v[144:159]
    v_add_f32 v238, 1.0, v238
    v_add_f32 v239, 1.0, v239
    v_rcp_f32 v232, v232
    ds_read_b128 v[196:199], v1 offset:48128
    v_mfma_f32_32x32x16_bf16 v[144:159], v[204:207], v[84:87], v[144:159]
    v_rcp_f32 v233, v233
    v_mul_f32 v176, v176, v232
    ds_read_b128 v[200:203], v1 offset:49152
    s_waitcnt lgkmcnt(5)
    v_mfma_f32_32x32x16_bf16 v[144:159], v[208:211], v[88:91], v[144:159]
    v_rcp_f32 v234, v234
    v_mul_f32 v177, v177, v233
    v_rcp_f32 v235, v235
    ds_read_b128 v[204:207], v1 offset:50176
    v_mfma_f32_32x32x16_bf16 v[144:159], v[212:215], v[92:95], v[144:159]
    v_mul_f32 v178, v178, v234
    v_rcp_f32 v236, v236
    v_mul_f32 v179, v179, v235
    ds_read_b128 v[208:211], v1 offset:51200
    s_waitcnt lgkmcnt(5)
    v_mfma_f32_32x32x16_bf16 v[144:159], v[216:219], v[96:99], v[144:159]
    v_rcp_f32 v237, v237
    v_mul_f32 v180, v180, v236
    v_rcp_f32 v238, v238
    ds_read_b128 v[212:215], v1 offset:52224
    v_mfma_f32_32x32x16_bf16 v[144:159], v[220:223], v[100:103], v[144:159]
    ds_read_b128 v[216:219], v1 offset:53248
    s_waitcnt vmcnt(0)
    v_cmp_gt_u32 vcc, 4, v19
    s_nop 1
    s_cbranch_vccnz hwait_71
hok_70:
    s_add_u32 s48, s36, 0
    buffer_load_dwordx4 v[100:103], v1, s[8:11], s48 offen sc1
    s_add_u32 s48, s35, 0
    buffer_load_dwordx4 v[96:99], v1, s[8:11], s48 offen sc1
    s_waitcnt lgkmcnt(5)
    v_mfma_f32_32x32x16_bf16 v[144:159], v[192:195], v[104:107], v[144:159]
    v_mul_f32 v181, v181, v237
    v_rcp_f32 v239, v239
    v_mul_f32 v182, v182, v238
    v_mul_f32 v183, v183, v239
    ds_read_b128 v[220:223], v1 offset:54272
    v_mfma_f32_32x32x16_bf16 v[144:159], v[196:199], v[108:111], v[144:159]
    ds_read_b128 v[192:195], v1 offset:55296
    s_add_u32 s48, s36, 1024
    buffer_load_dwordx4 v[108:111], v1, s[8:11], s48 offen sc1
    s_add_u32 s48, s35, 1024
    buffer_load_dwordx4 v[104:107], v1, s[8:11], s48 offen sc1
    s_waitcnt lgkmcnt(5)
    v_mfma_f32_32x32x16_bf16 v[144:159], v[200:203], v[112:115], v[144:159]
    v_cvt_pk_bf16_f32 v244, v176, v177
    v_cvt_pk_bf16_f32 v245, v178, v179
    v_cvt_pk_bf16_f32 v246, v180, v181
    v_cvt_pk_bf16_f32 v247, v182, v183
    buffer_store_dwordx4 v[244:247], v1, s[8:11], s61 offen offset:1024
    ds_read_b128 v[196:199], v1 offset:56320
    v_mfma_f32_32x32x16_bf16 v[144:159], v[204:207], v[116:119], v[144:159]
    ds_read_b128 v[200:203], v16 offset:7168
    s_add_u32 s48, s36, 2048
    buffer_load_dwordx4 v[116:119], v1, s[8:11], s48 offen sc1
    s_add_u32 s48, s35, 2048
    buffer_load_dwordx4 v[112:115], v1, s[8:11], s48 offen sc1
    s_waitcnt lgkmcnt(5)
    v_mfma_f32_32x32x16_bf16 v[144:159], v[208:211], v[120:123], v[144:159]
    v_mfma_f32_32x32x16_bf16 v[144:159], v[212:215], v[124:127], v[144:159]
    s_add_u32 s48, s36, 3072
    buffer_load_dwordx4 v[124:127], v1, s[8:11], s48 offen sc1
    s_add_u32 s48, s35, 3072
    buffer_load_dwordx4 v[120:123], v1, s[8:11], s48 offen sc1
    s_waitcnt lgkmcnt(3)
    v_mfma_f32_32x32x16_bf16 v[144:159], v[216:219], v[128:131], v[144:159]
    v_mfma_f32_32x32x16_bf16 v[144:159], v[220:223], v[132:135], v[144:159]
    s_add_u32 s48, s36, 7168
    buffer_load_dwordx4 v[132:135], v1, s[8:11], s48 offen sc1
    s_add_u32 s48, s35, 7168
    buffer_load_dwordx4 v[128:131], v1, s[8:11], s48 offen sc1
    s_waitcnt lgkmcnt(1)
    v_mfma_f32_32x32x16_bf16 v[144:159], v[192:195], v[136:139], v[144:159]
    v_mfma_f32_32x32x16_bf16 v[144:159], v[196:199], v[140:143], v[144:159]
    s_add_u32 s48, s36, 8192
    buffer_load_dwordx4 v[140:143], v1, s[8:11], s48 offen sc1
    s_add_u32 s48, s35, 8192
    buffer_load_dwordx4 v[136:139], v1, s[8:11], s48 offen sc1
    s_waitcnt lgkmcnt(0)
    v_mfma_f32_32x32x16_bf16 v[144:159], v[200:203], v[28:31], v[144:159]
    v_mov_b32 v18, 5
    s_waitcnt vmcnt(8)
    s_mov_b64 exec, 1
    buffer_store_dword v18, v11, s[8:11], s33 offen
    s_mov_b64 exec, -1
    s_cmp_eq_u32 s46, 0
    s_cbranch_scc1 p5_skip_74
    s_add_u32 s48, s36, 9216
    buffer_load_dwordx4 v[164:167], v1, s[8:11], s48 offen sc1
    s_add_u32 s48, s35, 9216
    buffer_load_dwordx4 v[160:163], v1, s[8:11], s48 offen sc1
    v_mfma_f32_32x32x16_bf16 v[64:79], a[0:3], v[100:103], 0
    v_mul_f32 v224, v17, v144
    v_mul_f32 v225, v17, v145
    v_mul_f32 v226, v17, v146
    v_mul_f32 v227, v17, v147
    v_mul_f32 v228, v17, v148
    v_mul_f32 v229, v17, v149
    v_mfma_f32_32x32x16_bf16 v[80:95], a[112:115], v[100:103], 0
    v_mul_f32 v230, v17, v150
    v_mul_f32 v231, v17, v151
    v_exp_f32 v224, v224
    v_mul_f32 v144, v144, v152
    v_mfma_f32_32x32x16_bf16 v[48:63], a[112:115], v[96:99], 0
    v_exp_f32 v225, v225
    v_mul_f32 v145, v145, v153
    v_exp_f32 v226, v226
    v_mul_f32 v146, v146, v154
    v_mfma_f32_32x32x16_bf16 v[32:47], a[0:3], v[96:99], 0
    s_add_u32 s48, s36, 10240
    buffer_load_dwordx4 v[172:175], v1, s[8:11], s48 offen sc1
    s_add_u32 s48, s35, 10240
    buffer_load_dwordx4 v[168:171], v1, s[8:11], s48 offen sc1
    v_mfma_f32_32x32x16_bf16 v[64:79], a[4:7], v[108:111], v[64:79]
    v_exp_f32 v227, v227
    v_mul_f32 v147, v147, v155
    v_exp_f32 v228, v228
    v_mul_f32 v148, v148, v156
    v_mfma_f32_32x32x16_bf16 v[80:95], a[116:119], v[108:111], v[80:95]
    v_exp_f32 v229, v229
    v_mul_f32 v149, v149, v157
    v_exp_f32 v230, v230
    v_mfma_f32_32x32x16_bf16 v[48:63], a[116:119], v[104:107], v[48:63]
    v_mul_f32 v150, v150, v158
    v_exp_f32 v231, v231
    v_mul_f32 v151, v151, v159
    v_add_f32 v224, 1.0, v224
    v_add_f32 v225, 1.0, v225
    v_mfma_f32_32x32x16_bf16 v[32:47], a[4:7], v[104:107], v[32:47]
    v_add_f32 v226, 1.0, v226
    s_add_u32 s48, s36, 14336
    buffer_load_dwordx4 v[180:183], v1, s[8:11], s48 offen sc1
    s_add_u32 s48, s35, 14336
    buffer_load_dwordx4 v[176:179], v1, s[8:11], s48 offen sc1
    s_waitcnt vmcnt(14)
    v_mfma_f32_32x32x16_bf16 v[64:79], a[8:11], v[116:119], v[64:79]
    v_add_f32 v227, 1.0, v227
    v_add_f32 v228, 1.0, v228
    v_add_f32 v229, 1.0, v229
    v_add_f32 v230, 1.0, v230
    v_add_f32 v231, 1.0, v231
    v_mfma_f32_32x32x16_bf16 v[80:95], a[120:123], v[116:119], v[80:95]
    v_rcp_f32 v224, v224
    v_rcp_f32 v225, v225
    v_mul_f32 v144, v144, v224
    s_waitcnt vmcnt(13)
    v_mfma_f32_32x32x16_bf16 v[48:63], a[120:123], v[112:115], v[48:63]
    v_rcp_f32 v226, v226
    v_mul_f32 v145, v145, v225
    v_rcp_f32 v227, v227
    v_mul_f32 v146, v146, v226
    v_mfma_f32_32x32x16_bf16 v[32:47], a[8:11], v[112:115], v[32:47]
    s_add_u32 s48, s36, 15360
    buffer_load_dwordx4 v[188:191], v1, s[8:11], s48 offen sc1
    s_add_u32 s48, s35, 15360
    buffer_load_dwordx4 v[184:187], v1, s[8:11], s48 offen sc1
    s_waitcnt vmcnt(14)
    v_mfma_f32_32x32x16_bf16 v[64:79], a[12:15], v[124:127], v[64:79]
    v_rcp_f32 v228, v228
    v_mul_f32 v147, v147, v227
    v_rcp_f32 v229, v229
    v_mul_f32 v148, v148, v228
    v_mfma_f32_32x32x16_bf16 v[80:95], a[124:127], v[124:127], v[80:95]
    v_rcp_f32 v230, v230
    v_mul_f32 v149, v149, v229
    v_rcp_f32 v231, v231
    s_waitcnt vmcnt(13)
    v_mfma_f32_32x32x16_bf16 v[48:63], a[124:127], v[120:123], v[48:63]
    v_mul_f32 v150, v150, v230
    v_mul_f32 v151, v151, v231
    v_cvt_pk_bf16_f32 v240, v144, v145
    v_cvt_pk_bf16_f32 v241, v146, v147
    v_cvt_pk_bf16_f32 v242, v148, v149
    v_cvt_pk_bf16_f32 v243, v150, v151
    v_mfma_f32_32x32x16_bf16 v[32:47], a[12:15], v[120:123], v[32:47]
    s_add_u32 s48, s36, 16384
    buffer_load_dwordx4 v[196:199], v1, s[8:11], s48 offen sc1
    s_add_u32 s48, s35, 16384
    buffer_load_dwordx4 v[192:195], v1, s[8:11], s48 offen sc1
    s_waitcnt vmcnt(14)
    v_mfma_f32_32x32x16_bf16 v[64:79], a[28:31], v[132:135], v[64:79]
    buffer_store_dwordx4 v[240:243], v1, s[8:11], s61 offen offset:2048
    v_mfma_f32_32x32x16_bf16 v[80:95], a[140:143], v[132:135], v[80:95]
    s_waitcnt vmcnt(14)
    v_mfma_f32_32x32x16_bf16 v[48:63], a[140:143], v[128:131], v[48:63]
    v_mfma_f32_32x32x16_bf16 v[32:47], a[28:31], v[128:131], v[32:47]
    s_add_u32 s48, s36, 17408
    buffer_load_dwordx4 v[204:207], v1, s[8:11], s48 offen sc1
    s_add_u32 s48, s35, 17408
    buffer_load_dwordx4 v[200:203], v1, s[8:11], s48 offen sc1
    s_waitcnt vmcnt(15)
    v_mfma_f32_32x32x16_bf16 v[64:79], a[32:35], v[140:143], v[64:79]
    v_mfma_f32_32x32x16_bf16 v[80:95], a[144:147], v[140:143], v[80:95]
    s_waitcnt vmcnt(14)
    v_mfma_f32_32x32x16_bf16 v[48:63], a[144:147], v[136:139], v[48:63]
    v_mfma_f32_32x32x16_bf16 v[32:47], a[32:35], v[136:139], v[32:47]
    s_add_u32 s48, s36, 21504
    buffer_load_dwordx4 v[212:215], v1, s[8:11], s48 offen sc1
    s_add_u32 s48, s35, 21504
    buffer_load_dwordx4 v[208:211], v1, s[8:11], s48 offen sc1
    buffer_load_dword v19, v10, s[8:11], s34 offen sc1
    s_waitcnt vmcnt(15)
    v_mfma_f32_32x32x16_bf16 v[64:79], a[36:39], v[164:167], v[64:79]
    v_mfma_f32_32x32x16_bf16 v[80:95], a[148:151], v[164:167], v[80:95]
    s_waitcnt vmcnt(14)
    v_mfma_f32_32x32x16_bf16 v[48:63], a[148:151], v[160:163], v[48:63]
    v_mov_b32 v18, 6
    s_waitcnt vmcnt(5)
    s_mov_b64 exec, 1
    buffer_store_dword v18, v11, s[8:11], s33 offen
    s_mov_b64 exec, -1
    v_mfma_f32_32x32x16_bf16 v[32:47], a[36:39], v[160:163], v[32:47]
    s_add_u32 s48, s36, 22528
    buffer_load_dwordx4 v[220:223], v1, s[8:11], s48 offen sc1
    s_add_u32 s48, s35, 22528
    buffer_load_dwordx4 v[216:219], v1, s[8:11], s48 offen sc1
    v_mfma_f32_32x32x16_bf16 v[64:79], a[40:43], v[172:175], v[64:79]
    s_mul_i32 s50, s55, 28
    s_lshl_b32 s49, s54, 1
    s_add_u32 s50, s50, s49
    s_lshl_b32 s50, s50, 10
    s_add_u32 s50, s50, s39
    buffer_load_dwordx4 v[232:235], v1, s[8:11], s50 offen sc1
    v_mfma_f32_32x32x16_bf16 v[80:95], a[152:155], v[172:175], v[80:95]
    buffer_load_dwordx4 v[236:239], v1, s[8:11], s50 offen offset:1024 sc1
    s_mul_i32 s51, s55, 3584
    s_add_u32 s51, s51, s40
    buffer_load_dwordx2 v[144:145], v6, s[8:11], s51 offen offset:0 sc1
    buffer_load_dwordx2 v[146:147], v6, s[8:11], s51 offen offset:256 sc1
    v_mfma_f32_32x32x16_bf16 v[48:63], a[152:155], v[168:171], v[48:63]
    buffer_load_dwordx2 v[148:149], v6, s[8:11], s51 offen offset:512 sc1
    buffer_load_dwordx2 v[150:151], v6, s[8:11], s51 offen offset:768 sc1
    buffer_load_dwordx2 v[152:153], v6, s[8:11], s51 offen offset:1024 sc1
    buffer_load_dwordx2 v[154:155], v6, s[8:11], s51 offen offset:1280 sc1
    buffer_load_dwordx2 v[156:157], v6, s[8:11], s51 offen offset:1536 sc1
    v_mfma_f32_32x32x16_bf16 v[32:47], a[40:43], v[168:171], v[32:47]
    s_add_u32 s48, s36, 23552
    buffer_load_dwordx4 v[100:103], v1, s[8:11], s48 offen sc1
    s_add_u32 s48, s35, 23552
    buffer_load_dwordx4 v[96:99], v1, s[8:11], s48 offen sc1
    v_mfma_f32_32x32x16_bf16 v[64:79], a[56:59], v[180:183], v[64:79]
    v_mfma_f32_32x32x16_bf16 v[80:95], a[168:171], v[180:183], v[80:95]
    v_mfma_f32_32x32x16_bf16 v[48:63], a[168:171], v[176:179], v[48:63]
    v_mfma_f32_32x32x16_bf16 v[32:47], a[56:59], v[176:179], v[32:47]
    s_add_u32 s48, s36, 24576
    buffer_load_dwordx4 v[108:111], v1, s[8:11], s48 offen sc1
    s_add_u32 s48, s35, 24576
    buffer_load_dwordx4 v[104:107], v1, s[8:11], s48 offen sc1
    v_mfma_f32_32x32x16_bf16 v[64:79], a[60:63], v[188:191], v[64:79]
    v_mfma_f32_32x32x16_bf16 v[80:95], a[172:175], v[188:191], v[80:95]
    v_mfma_f32_32x32x16_bf16 v[48:63], a[172:175], v[184:187], v[48:63]
    v_mfma_f32_32x32x16_bf16 v[32:47], a[60:63], v[184:187], v[32:47]
    s_waitcnt vmcnt(16)
    v_cmp_gt_u32 vcc, 5, v19
    s_nop 1
    s_cbranch_vccnz hwait_77
hok_76:
    s_add_u32 s48, s36, 4096
    buffer_load_dwordx4 v[116:119], v1, s[8:11], s48 offen sc1
    s_add_u32 s48, s35, 4096
    buffer_load_dwordx4 v[112:115], v1, s[8:11], s48 offen sc1
    v_mfma_f32_32x32x16_bf16 v[64:79], a[64:67], v[196:199], v[64:79]
    v_mfma_f32_32x32x16_bf16 v[80:95], a[176:179], v[196:199], v[80:95]
    v_mfma_f32_32x32x16_bf16 v[48:63], a[176:179], v[192:195], v[48:63]
    v_mfma_f32_32x32x16_bf16 v[32:47], a[64:67], v[192:195], v[32:47]
    s_add_u32 s48, s36, 5120
    buffer_load_dwordx4 v[124:127], v1, s[8:11], s48 offen sc1
    s_add_u32 s48, s35, 5120
    buffer_load_dwordx4 v[120:123], v1, s[8:11], s48 offen sc1
    v_mfma_f32_32x32x16_bf16 v[64:79], a[68:71], v[204:207], v[64:79]
    v_mfma_f32_32x32x16_bf16 v[80:95], a[180:183], v[204:207], v[80:95]
    v_mfma_f32_32x32x16_bf16 v[48:63], a[180:183], v[200:203], v[48:63]
    v_mfma_f32_32x32x16_bf16 v[32:47], a[68:71], v[200:203], v[32:47]
    s_add_u32 s48, s36, 11264
    buffer_load_dwordx4 v[132:135], v1, s[8:11], s48 offen sc1
    s_add_u32 s48, s35, 11264
    buffer_load_dwordx4 v[128:131], v1, s[8:11], s48 offen sc1
    v_mfma_f32_32x32x16_bf16 v[64:79], a[84:87], v[212:215], v[64:79]
    v_mfma_f32_32x32x16_bf16 v[80:95], a[196:199], v[212:215], v[80:95]
    v_mfma_f32_32x32x16_bf16 v[48:63], a[196:199], v[208:211], v[48:63]
    v_mfma_f32_32x32x16_bf16 v[32:47], a[84:87], v[208:211], v[32:47]
    s_add_u32 s48, s36, 12288
    buffer_load_dwordx4 v[140:143], v1, s[8:11], s48 offen sc1
    s_add_u32 s48, s35, 12288
    buffer_load_dwordx4 v[136:139], v1, s[8:11], s48 offen sc1
    s_waitcnt vmcnt(22)
    v_mfma_f32_32x32x16_bf16 v[64:79], a[88:91], v[220:223], v[64:79]
    s_waitcnt vmcnt(17)
    v_add_f32 v144, v144, v146
    v_add_f32 v145, v145, v147
    s_waitcnt vmcnt(16)
    v_add_f32 v144, v144, v148
    v_add_f32 v145, v145, v149
    v_mfma_f32_32x32x16_bf16 v[80:95], a[200:203], v[220:223], v[80:95]
    s_waitcnt vmcnt(15)
    v_add_f32 v144, v144, v150
    v_add_f32 v145, v145, v151
    s_waitcnt vmcnt(14)
    v_add_f32 v144, v144, v152
    v_mfma_f32_32x32x16_bf16 v[48:63], a[200:203], v[216:219], v[48:63]
    v_add_f32 v145, v145, v153
    s_waitcnt vmcnt(13)
    v_add_f32 v144, v144, v154
    v_add_f32 v145, v145, v155
    s_waitcnt vmcnt(12)
    v_add_f32 v144, v144, v156
    v_mfma_f32_32x32x16_bf16 v[32:47], a[88:91], v[216:219], v[32:47]
    s_add_u32 s48, s36, 18432
    buffer_load_dwordx4 v[164:167], v1, s[8:11], s48 offen sc1
    s_add_u32 s48, s35, 18432
    buffer_load_dwordx4 v[160:163], v1, s[8:11], s48 offen sc1
    buffer_load_dword v19, v10, s[8:11], s34 offen sc1
    s_waitcnt vmcnt(14)
    v_mfma_f32_32x32x16_bf16 v[64:79], a[92:95], v[100:103], v[64:79]
    v_add_f32 v145, v145, v157
    v_mov_b32 v22, v144
    v_mov_b32 v23, v145
    s_nop 0
    v_permlane32_swap_b32 v144, v22
    v_permlane32_swap_b32 v145, v23
    v_mfma_f32_32x32x16_bf16 v[80:95], a[204:207], v[100:103], v[80:95]
    v_add_f32 v144, v144, v22
    v_add_f32 v145, v145, v23
    v_mul_f32 v144, 3138537765, v144
    v_mul_f32 v145, 991054117, v145
    v_fma_f32 v145, -v144, v144, v145
    s_waitcnt vmcnt(13)
    v_mfma_f32_32x32x16_bf16 v[48:63], a[204:207], v[96:99], v[48:63]
    v_max_f32 v145, 0, v145
    v_cvt_pk_bf16_f32 v20, v144, v144
    v_cvt_pk_bf16_f32 v23, v145, v145
    v_and_b32 v23, 0xffff0000, v23
    v_add_f32 v23, 925353388, v23
    v_cvt_pk_bf16_f32 v23, v23, v23
    v_mfma_f32_32x32x16_bf16 v[32:47], a[92:95], v[96:99], v[32:47]
    v_and_b32 v23, 0xffff0000, v23
    s_add_u32 s48, s36, 19456
    buffer_load_dwordx4 v[172:175], v1, s[8:11], s48 offen sc1
    s_add_u32 s48, s35, 19456
    buffer_load_dwordx4 v[168:171], v1, s[8:11], s48 offen sc1
    s_waitcnt vmcnt(14)
    v_mfma_f32_32x32x16_bf16 v[64:79], a[96:99], v[108:111], v[64:79]
    v_sqrt_f32 v23, v23
    s_nop 0
    v_cvt_pk_bf16_f32 v23, v23, v23
    v_and_b32 v23, 0xffff0000, v23
    v_mfma_f32_32x32x16_bf16 v[80:95], a[208:211], v[108:111], v[80:95]
    v_rcp_f32 v21, v23
    s_nop 0
    v_mul_f32 v28, v21, v21
    v_mul_f32 v29, v21, v21
    s_waitcnt vmcnt(13)
    v_mfma_f32_32x32x16_bf16 v[48:63], a[208:211], v[104:107], v[48:63]
    v_lshlrev_b32 v240, 16, v232
    v_and_b32 v241, 0xffff0000, v232
    v_lshlrev_b32 v242, 16, v233
    v_and_b32 v243, 0xffff0000, v233
    v_lshlrev_b32 v244, 16, v234
    v_and_b32 v245, 0xffff0000, v234
    v_mfma_f32_32x32x16_bf16 v[32:47], a[96:99], v[104:107], v[32:47]
    v_lshlrev_b32 v246, 16, v235
    s_add_u32 s48, s36, 25600
    buffer_load_dwordx4 v[180:183], v1, s[8:11], s48 offen sc1
    s_add_u32 s48, s35, 25600
    buffer_load_dwordx4 v[176:179], v1, s[8:11], s48 offen sc1
    s_waitcnt vmcnt(14)
    v_mfma_f32_32x32x16_bf16 v[64:79], a[16:19], v[116:119], v[64:79]
    v_and_b32 v247, 0xffff0000, v235
    v_lshlrev_b32 v248, 16, v236
    v_and_b32 v249, 0xffff0000, v236
    v_lshlrev_b32 v250, 16, v237
    v_and_b32 v251, 0xffff0000, v237
    v_lshlrev_b32 v252, 16, v238
    v_mfma_f32_32x32x16_bf16 v[80:95], a[128:131], v[116:119], v[80:95]
    v_and_b32 v253, 0xffff0000, v238
    v_lshlrev_b32 v254, 16, v239
    v_and_b32 v255, 0xffff0000, v239
    s_waitcnt vmcnt(13)
    v_mfma_f32_32x32x16_bf16 v[48:63], a[128:131], v[112:115], v[48:63]
    s_mul_i32 s51, s3, 12288
    s_add_u32 s51, s51, 86016
    v_add_u32 v25, s51, v1
    s_lshl_b32 s53, s55, 7
    s_lshl_b32 s49, s54, 2
    s_add_u32 s53, s53, s49
    s_add_u32 s53, s53, 0
    v_mfma_f32_32x32x16_bf16 v[32:47], a[16:19], v[112:115], v[32:47]
    s_add_u32 s48, s36, 26624
    buffer_load_dwordx4 v[188:191], v1, s[8:11], s48 offen sc1
    s_add_u32 s48, s35, 26624
    buffer_load_dwordx4 v[184:187], v1, s[8:11], s48 offen sc1
    s_waitcnt vmcnt(14)
    v_mfma_f32_32x32x16_bf16 v[64:79], a[20:23], v[124:127], v[64:79]
    v_mfma_f32_32x32x16_bf16 v[80:95], a[132:135], v[124:127], v[80:95]
    s_waitcnt vmcnt(13)
    v_mfma_f32_32x32x16_bf16 v[48:63], a[132:135], v[120:123], v[48:63]
    v_mfma_f32_32x32x16_bf16 v[32:47], a[20:23], v[120:123], v[32:47]
    s_waitcnt vmcnt(6)
    v_cmp_gt_u32 vcc, 6, v19
    s_nop 1
    s_cbranch_vccnz hwait_81
hok_80:
    s_add_u32 s48, s36, 6144
    buffer_load_dwordx4 v[196:199], v1, s[8:11], s48 offen sc1
    s_add_u32 s48, s35, 6144
    buffer_load_dwordx4 v[192:195], v1, s[8:11], s48 offen sc1
    v_mfma_f32_32x32x16_bf16 v[64:79], a[44:47], v[132:135], v[64:79]
    v_mfma_f32_32x32x16_bf16 v[80:95], a[156:159], v[132:135], v[80:95]
    v_mfma_f32_32x32x16_bf16 v[48:63], a[156:159], v[128:131], v[48:63]
    v_mfma_f32_32x32x16_bf16 v[32:47], a[44:47], v[128:131], v[32:47]
    s_add_u32 s48, s36, 13312
    buffer_load_dwordx4 v[204:207], v1, s[8:11], s48 offen sc1
    s_add_u32 s48, s35, 13312
    buffer_load_dwordx4 v[200:203], v1, s[8:11], s48 offen sc1
    v_mfma_f32_32x32x16_bf16 v[64:79], a[48:51], v[140:143], v[64:79]
    v_mfma_f32_32x32x16_bf16 v[80:95], a[160:163], v[140:143], v[80:95]
    v_mfma_f32_32x32x16_bf16 v[48:63], a[160:163], v[136:139], v[48:63]
    v_mfma_f32_32x32x16_bf16 v[32:47], a[48:51], v[136:139], v[32:47]
    s_add_u32 s48, s36, 20480
    buffer_load_dwordx4 v[212:215], v1, s[8:11], s48 offen sc1
    s_add_u32 s48, s35, 20480
    buffer_load_dwordx4 v[208:211], v1, s[8:11], s48 offen sc1
    v_mfma_f32_32x32x16_bf16 v[64:79], a[72:75], v[164:167], v[64:79]
    v_mfma_f32_32x32x16_bf16 v[80:95], a[184:187], v[164:167], v[80:95]
    v_mfma_f32_32x32x16_bf16 v[48:63], a[184:187], v[160:163], v[48:63]
    v_mfma_f32_32x32x16_bf16 v[32:47], a[72:75], v[160:163], v[32:47]
    s_add_u32 s48, s36, 27648
    buffer_load_dwordx4 v[220:223], v1, s[8:11], s48 offen sc1
    s_add_u32 s48, s35, 27648
    buffer_load_dwordx4 v[216:219], v1, s[8:11], s48 offen sc1
    s_waitcnt vmcnt(13)
    v_mfma_f32_32x32x16_bf16 v[64:79], a[76:79], v[172:175], v[64:79]
    v_mfma_f32_32x32x16_bf16 v[80:95], a[188:191], v[172:175], v[80:95]
    s_waitcnt vmcnt(12)
    v_mfma_f32_32x32x16_bf16 v[48:63], a[188:191], v[168:171], v[48:63]
    s_barrier
    v_mfma_f32_32x32x16_bf16 v[32:47], a[76:79], v[168:171], v[32:47]
    s_waitcnt vmcnt(11)
    v_mfma_f32_32x32x16_bf16 v[64:79], a[100:103], v[180:183], v[64:79]
    v_mfma_f32_32x32x16_bf16 v[80:95], a[212:215], v[180:183], v[80:95]
    s_waitcnt vmcnt(10)
    v_mfma_f32_32x32x16_bf16 v[48:63], a[212:215], v[176:179], v[48:63]
    v_mfma_f32_32x32x16_bf16 v[32:47], a[100:103], v[176:179], v[32:47]
    s_waitcnt vmcnt(9)
    v_mfma_f32_32x32x16_bf16 v[64:79], a[104:107], v[188:191], v[64:79]
    v_mfma_f32_32x32x16_bf16 v[80:95], a[216:219], v[188:191], v[80:95]
    s_waitcnt vmcnt(8)
    v_mfma_f32_32x32x16_bf16 v[48:63], a[216:219], v[184:187], v[48:63]
    s_waitcnt vmcnt(7)
    v_mfma_f32_32x32x16_bf16 v[64:79], a[24:27], v[196:199], v[64:79]
    v_mfma_f32_32x32x16_bf16 v[80:95], a[136:139], v[196:199], v[80:95]
    s_waitcnt vmcnt(6)
    v_mfma_f32_32x32x16_bf16 v[48:63], a[136:139], v[192:195], v[48:63]
    s_waitcnt vmcnt(5)
    v_mfma_f32_32x32x16_bf16 v[64:79], a[52:55], v[204:207], v[64:79]
    v_mfma_f32_32x32x16_bf16 v[80:95], a[164:167], v[204:207], v[80:95]
    s_waitcnt vmcnt(4)
    v_mfma_f32_32x32x16_bf16 v[48:63], a[164:167], v[200:203], v[48:63]
    s_waitcnt vmcnt(3)
    v_mfma_f32_32x32x16_bf16 v[64:79], a[80:83], v[212:215], v[64:79]
    v_mfma_f32_32x32x16_bf16 v[80:95], a[192:195], v[212:215], v[80:95]
    s_waitcnt vmcnt(2)
    v_mfma_f32_32x32x16_bf16 v[48:63], a[192:195], v[208:211], v[48:63]
    s_waitcnt vmcnt(1)
    v_mfma_f32_32x32x16_bf16 v[64:79], a[108:111], v[220:223], v[64:79]
    v_mfma_f32_32x32x16_bf16 v[80:95], a[220:223], v[220:223], v[80:95]
    s_waitcnt vmcnt(0)
    v_mfma_f32_32x32x16_bf16 v[48:63], a[220:223], v[216:219], v[48:63]
    v_mfma_f32_32x32x16_bf16 v[32:47], a[104:107], v[184:187], v[32:47]
    s_xor_b32 s48, s3, 2
    s_mul_i32 s48, s48, 12288
    s_add_u32 s48, s48, 90112
    v_add_u32 v23, s48, v1
    s_nop 3
    ds_write_b128 v23, v[64:67] offset:0
    v_mfma_f32_32x32x16_bf16 v[32:47], a[24:27], v[192:195], v[32:47]
    ds_write_b128 v23, v[68:71] offset:1024
    ds_write_b128 v23, v[72:75] offset:2048
    ds_write_b128 v23, v[76:79] offset:3072
    v_mfma_f32_32x32x16_bf16 v[32:47], a[52:55], v[200:203], v[32:47]
    s_xor_b32 s48, s3, 3
    s_mul_i32 s48, s48, 12288
    s_add_u32 s48, s48, 94208
    v_add_u32 v24, s48, v1
    ds_write_b128 v24, v[80:83] offset:0
    v_mfma_f32_32x32x16_bf16 v[32:47], a[80:83], v[208:211], v[32:47]
    ds_write_b128 v24, v[84:87] offset:1024
    ds_write_b128 v24, v[88:91] offset:2048
    ds_write_b128 v24, v[92:95] offset:3072
    v_mfma_f32_32x32x16_bf16 v[32:47], a[108:111], v[216:219], v[32:47]
    s_xor_b32 s48, s3, 1
    s_mul_i32 s48, s48, 12288
    s_add_u32 s48, s48, 86016
    v_add_u32 v22, s48, v1
    ds_write_b128 v22, v[48:51] offset:0
    ds_write_b128 v22, v[52:55] offset:1024
    ds_write_b128 v22, v[56:59] offset:2048
    ds_write_b128 v22, v[60:63] offset:3072
    s_waitcnt lgkmcnt(0)
    s_barrier
    ds_read_b128 v[48:51], v25 offset:0
    ds_read_b128 v[64:67], v25 offset:4096
    ds_read_b128 v[80:83], v25 offset:8192
    ds_read_b128 v[52:55], v25 offset:1024
    ds_read_b128 v[68:71], v25 offset:5120
    ds_read_b128 v[84:87], v25 offset:9216
    ds_read_b128 v[56:59], v25 offset:2048
    ds_read_b128 v[72:75], v25 offset:6144
    ds_read_b128 v[88:91], v25 offset:10240
    ds_read_b128 v[60:63], v25 offset:3072
    ds_read_b128 v[76:79], v25 offset:7168
    ds_read_b128 v[92:95], v25 offset:11264
    s_waitcnt lgkmcnt(9)
    v_pk_add_f32 v[48:49], v[48:49], v[64:65]
    v_pk_add_f32 v[32:33], v[32:33], v[80:81]
    v_pk_add_f32 v[50:51], v[50:51], v[66:67]
    v_pk_add_f32 v[34:35], v[34:35], v[82:83]
    v_pk_add_f32 v[32:33], v[32:33], v[48:49]
    v_pk_add_f32 v[34:35], v[34:35], v[50:51]
    v_pk_fma_f32 v[32:33], v[32:33], v[28:29], v[240:241]
    v_pk_fma_f32 v[34:35], v[34:35], v[28:29], v[242:243]
    v_cvt_pk_bf16_f32 v232, v32, v33
    v_cvt_pk_bf16_f32 v233, v34, v35
    s_waitcnt lgkmcnt(6)
    v_pk_add_f32 v[52:53], v[52:53], v[68:69]
    v_pk_add_f32 v[36:37], v[36:37], v[84:85]
    v_pk_add_f32 v[54:55], v[54:55], v[70:71]
    v_pk_add_f32 v[38:39], v[38:39], v[86:87]
    v_pk_add_f32 v[36:37], v[36:37], v[52:53]
    v_pk_add_f32 v[38:39], v[38:39], v[54:55]
    v_pk_fma_f32 v[36:37], v[36:37], v[28:29], v[244:245]
    v_pk_fma_f32 v[38:39], v[38:39], v[28:29], v[246:247]
    v_cvt_pk_bf16_f32 v234, v36, v37
    v_cvt_pk_bf16_f32 v235, v38, v39
    s_waitcnt lgkmcnt(3)
    v_pk_add_f32 v[56:57], v[56:57], v[72:73]
    v_pk_add_f32 v[40:41], v[40:41], v[88:89]
    v_pk_add_f32 v[58:59], v[58:59], v[74:75]
    v_pk_add_f32 v[42:43], v[42:43], v[90:91]
    v_pk_add_f32 v[40:41], v[40:41], v[56:57]
    v_pk_add_f32 v[42:43], v[42:43], v[58:59]
    v_pk_fma_f32 v[40:41], v[40:41], v[28:29], v[248:249]
    v_pk_fma_f32 v[42:43], v[42:43], v[28:29], v[250:251]
    v_cvt_pk_bf16_f32 v236, v40, v41
    v_cvt_pk_bf16_f32 v237, v42, v43
    s_waitcnt lgkmcnt(0)
    v_pk_add_f32 v[60:61], v[60:61], v[76:77]
    v_pk_add_f32 v[44:45], v[44:45], v[92:93]
    v_pk_add_f32 v[62:63], v[62:63], v[78:79]
    v_pk_add_f32 v[46:47], v[46:47], v[94:95]
    v_pk_add_f32 v[44:45], v[44:45], v[60:61]
    v_pk_add_f32 v[46:47], v[46:47], v[62:63]
    v_pk_fma_f32 v[44:45], v[44:45], v[28:29], v[252:253]
    v_pk_fma_f32 v[46:47], v[46:47], v[28:29], v[254:255]
    v_cvt_pk_bf16_f32 v238, v44, v45
    v_cvt_pk_bf16_f32 v239, v46, v47
MAIN_fin:
    v_mul_u32_u24 v22, 896, v3
    v_lshl_add_u32 v22, v4, 4, v22
    s_mul_i32 s48, s55, 28672
    s_lshl_b32 s49, s54, 6
    s_add_u32 s48, s48, s49
    buffer_store_dwordx4 v[232:235], v22, s[12:15], s48 offen
    buffer_store_dwordx4 v[236:239], v22, s[12:15], s48 offen offset:32
MAIN_tail:
MAIN_end:
    s_endpgm
A_fill_5:
    v_mov_b32 v248, 0
    v_mov_b32 v249, 0
    v_mov_b32 v250, 0
    v_mov_b32 v251, 0
    v_mov_b32 v252, 0
    v_mov_b32 v253, 0
    v_mov_b32 v255, 0
    v_mov_b32 v23, 0xf14a
    v_cndmask_b32 v254, 0, v23, s[96:97]
    v_add_u32 v22, s53, v1
    ds_write_b128 v22, v[248:251] offset:0
    ds_write_b128 v22, v[252:255] offset:1024
    ds_write_b128 v22, v[248:251] offset:2048
    ds_write_b128 v22, v[248:251] offset:3072
    ds_write_b128 v22, v[248:251] offset:4096
    ds_write_b128 v22, v[252:255] offset:5120
    ds_write_b128 v22, v[248:251] offset:6144
    ds_write_b128 v22, v[248:251] offset:7168
    s_waitcnt lgkmcnt(0)
    s_branch A_join_6
att_fb_16:
    s_nop 7
    s_nop 7
    v_mov_b32 v28, v12
    v_mov_b32 v27, v26
    s_mov_b32 s62, 0
fb1_17:
    s_nop 7
    s_nop 4
    ds_read_b128 v[96:99], v28
    ds_read_b128 v[100:103], v28 offset:1024
    ds_read_b128 v[104:107], v28 offset:2048
    ds_read_b128 v[108:111], v28 offset:3072
    s_waitcnt lgkmcnt(3)
    v_mfma_f32_32x32x16_bf16 v[32:47], v[96:99], v[232:235], 0
    s_waitcnt lgkmcnt(2)
    v_mfma_f32_32x32x16_bf16 v[32:47], v[100:103], v[236:239], v[32:47]
    s_cmp_lg_u32 s62, 0
    s_cbranch_scc1 sk_19
    s_nop 9
    v_cndmask_b32 v32, v32, v26, s[64:65]
    v_cndmask_b32 v33, v33, v26, s[66:67]
    v_cndmask_b32 v34, v34, v26, s[68:69]
    v_cndmask_b32 v35, v35, v26, s[70:71]
    v_cndmask_b32 v36, v36, v26, s[72:73]
    v_cndmask_b32 v37, v37, v26, s[74:75]
    v_cndmask_b32 v38, v38, v26, s[76:77]
    v_cndmask_b32 v39, v39, v26, s[78:79]
    v_cndmask_b32 v40, v40, v26, s[80:81]
    v_cndmask_b32 v41, v41, v26, s[82:83]
    v_cndmask_b32 v42, v42, v26, s[84:85]
    v_cndmask_b32 v43, v43, v26, s[86:87]
    v_cndmask_b32 v44, v44, v26, s[88:89]
    v_cndmask_b32 v45, v45, v26, s[90:91]
    v_cndmask_b32 v46, v46, v26, s[92:93]
    v_cndmask_b32 v47, v47, v26, s[94:95]
sk_19:
    s_cmp_lg_u32 s62, 8
    s_cbranch_scc1 sk_20
    s_nop 7
    v_cndmask_b32 v32, v26, v32, s[64:65]
    v_cndmask_b32 v33, v26, v33, s[66:67]
    v_cndmask_b32 v34, v26, v34, s[68:69]
    v_cndmask_b32 v35, v26, v35, s[70:71]
    v_cndmask_b32 v36, v26, v36, s[72:73]
    v_cndmask_b32 v37, v26, v37, s[74:75]
    v_cndmask_b32 v38, v26, v38, s[76:77]
    v_cndmask_b32 v39, v26, v39, s[78:79]
    v_cndmask_b32 v40, v26, v40, s[80:81]
    v_cndmask_b32 v41, v26, v41, s[82:83]
    v_cndmask_b32 v42, v26, v42, s[84:85]
    v_cndmask_b32 v43, v26, v43, s[86:87]
    v_cndmask_b32 v44, v26, v44, s[88:89]
    v_cndmask_b32 v45, v26, v45, s[90:91]
    v_cndmask_b32 v46, v26, v46, s[92:93]
    v_cndmask_b32 v47, v26, v47, s[94:95]
sk_20:
    s_nop 7
    v_max3_f32 v27, v32, v33, v27
    v_max3_f32 v27, v34, v35, v27
    v_max3_f32 v27, v36, v37, v27
    v_max3_f32 v27, v38, v39, v27
    v_max3_f32 v27, v40, v41, v27
    v_max3_f32 v27, v42, v43, v27
    v_max3_f32 v27, v44, v45, v27
    v_max3_f32 v27, v46, v47, v27
    v_add_u32 v28, 4096, v28
    s_add_u32 s62, s62, 1
    s_cmp_lt_u32 s62, 9
    s_waitcnt lgkmcnt(0)
    s_cbranch_scc1 fb1_17
    v_mov_b32 v23, v27
    s_nop 1
    v_permlane32_swap_b32 v27, v23
    v_max_f32 v27, v27, v23
    v_mov_b32 v28, v12
    s_mov_b32 s62, 0
    v_mov_b32 v64, 0
    v_mov_b32 v65, 0
    v_mov_b32 v66, 0
    v_mov_b32 v67, 0
    v_mov_b32 v68, 0
    v_mov_b32 v69, 0
    v_mov_b32 v70, 0
    v_mov_b32 v71, 0
    v_mov_b32 v72, 0
    v_mov_b32 v73, 0
    v_mov_b32 v74, 0
    v_mov_b32 v75, 0
    v_mov_b32 v76, 0
    v_mov_b32 v77, 0
    v_mov_b32 v78, 0
    v_mov_b32 v79, 0
fb2_18:
    s_nop 7
    s_nop 4
    ds_read_b128 v[96:99], v28
    ds_read_b128 v[100:103], v28 offset:1024
    ds_read_b128 v[104:107], v28 offset:2048
    ds_read_b128 v[108:111], v28 offset:3072
    s_waitcnt lgkmcnt(3)
    v_mfma_f32_32x32x16_bf16 v[32:47], v[96:99], v[232:235], 0
    s_waitcnt lgkmcnt(2)
    v_mfma_f32_32x32x16_bf16 v[32:47], v[100:103], v[236:239], v[32:47]
    s_cmp_lg_u32 s62, 0
    s_cbranch_scc1 sk_21
    s_nop 9
    v_cndmask_b32 v32, v32, v26, s[64:65]
    v_cndmask_b32 v33, v33, v26, s[66:67]
    v_cndmask_b32 v34, v34, v26, s[68:69]
    v_cndmask_b32 v35, v35, v26, s[70:71]
    v_cndmask_b32 v36, v36, v26, s[72:73]
    v_cndmask_b32 v37, v37, v26, s[74:75]
    v_cndmask_b32 v38, v38, v26, s[76:77]
    v_cndmask_b32 v39, v39, v26, s[78:79]
    v_cndmask_b32 v40, v40, v26, s[80:81]
    v_cndmask_b32 v41, v41, v26, s[82:83]
    v_cndmask_b32 v42, v42, v26, s[84:85]
    v_cndmask_b32 v43, v43, v26, s[86:87]
    v_cndmask_b32 v44, v44, v26, s[88:89]
    v_cndmask_b32 v45, v45, v26, s[90:91]
    v_cndmask_b32 v46, v46, v26, s[92:93]
    v_cndmask_b32 v47, v47, v26, s[94:95]
sk_21:
    s_cmp_lg_u32 s62, 8
    s_cbranch_scc1 sk_22
    s_nop 7
    v_cndmask_b32 v32, v26, v32, s[64:65]
    v_cndmask_b32 v33, v26, v33, s[66:67]
    v_cndmask_b32 v34, v26, v34, s[68:69]
    v_cndmask_b32 v35, v26, v35, s[70:71]
    v_cndmask_b32 v36, v26, v36, s[72:73]
    v_cndmask_b32 v37, v26, v37, s[74:75]
    v_cndmask_b32 v38, v26, v38, s[76:77]
    v_cndmask_b32 v39, v26, v39, s[78:79]
    v_cndmask_b32 v40, v26, v40, s[80:81]
    v_cndmask_b32 v41, v26, v41, s[82:83]
    v_cndmask_b32 v42, v26, v42, s[84:85]
    v_cndmask_b32 v43, v26, v43, s[86:87]
    v_cndmask_b32 v44, v26, v44, s[88:89]
    v_cndmask_b32 v45, v26, v45, s[90:91]
    v_cndmask_b32 v46, v26, v46, s[92:93]
    v_cndmask_b32 v47, v26, v47, s[94:95]
sk_22:
    s_nop 7
    v_sub_f32 v32, v32, v27
    v_sub_f32 v33, v33, v27
    v_sub_f32 v34, v34, v27
    v_sub_f32 v35, v35, v27
    v_sub_f32 v36, v36, v27
    v_sub_f32 v37, v37, v27
    v_sub_f32 v38, v38, v27
    v_sub_f32 v39, v39, v27
    v_sub_f32 v40, v40, v27
    v_sub_f32 v41, v41, v27
    v_sub_f32 v42, v42, v27
    v_sub_f32 v43, v43, v27
    v_sub_f32 v44, v44, v27
    v_sub_f32 v45, v45, v27
    v_sub_f32 v46, v46, v27
    v_sub_f32 v47, v47, v27
    v_exp_f32 v32, v32
    v_exp_f32 v33, v33
    v_exp_f32 v34, v34
    v_exp_f32 v35, v35
    v_exp_f32 v36, v36
    v_exp_f32 v37, v37
    v_exp_f32 v38, v38
    v_exp_f32 v39, v39
    v_exp_f32 v40, v40
    v_exp_f32 v41, v41
    v_exp_f32 v42, v42
    v_exp_f32 v43, v43
    v_exp_f32 v44, v44
    v_exp_f32 v45, v45
    v_exp_f32 v46, v46
    v_exp_f32 v47, v47
    v_cvt_pk_bf16_f32 v48, v32, v33
    v_cvt_pk_bf16_f32 v49, v34, v35
    v_cvt_pk_bf16_f32 v50, v36, v37
    v_cvt_pk_bf16_f32 v51, v38, v39
    v_cvt_pk_bf16_f32 v52, v40, v41
    v_cvt_pk_bf16_f32 v53, v42, v43
    v_cvt_pk_bf16_f32 v54, v44, v45
    v_cvt_pk_bf16_f32 v55, v46, v47
    s_waitcnt lgkmcnt(1)
    v_mfma_f32_32x32x16_bf16 v[64:79], v[104:107], v[48:51], v[64:79]
    s_waitcnt lgkmcnt(0)
    v_mfma_f32_32x32x16_bf16 v[64:79], v[108:111], v[52:55], v[64:79]
    v_add_u32 v28, 4096, v28
    s_add_u32 s62, s62, 1
    s_cmp_lt_u32 s62, 9
    s_waitcnt lgkmcnt(0)
    s_cbranch_scc1 fb2_18
    s_nop 6
    v_mov_b32 v22, v76
    v_mov_b32 v23, v76
    s_nop 1
    v_permlane32_swap_b32 v22, v23
    s_nop 7
    s_branch att_ok_15
p3_skip_23:
    s_barrier
    s_branch p3_join_24
hwait_32:
    s_mov_b32 s47, 0
poll_33:
    buffer_load_dword v19, v10, s[8:11], s34 offen sc1
    s_add_u32 s47, s47, 1
    s_cmp_gt_u32 s47, 400000
    s_cbranch_scc1 polled_34
    s_waitcnt vmcnt(0)
    v_cmp_gt_u32 vcc, 1, v19
    s_nop 1
    s_cbranch_vccnz poll_33
polled_34:
    s_waitcnt vmcnt(0)
    s_branch hok_31
hwait_38:
    s_mov_b32 s47, 0
poll_39:
    buffer_load_dword v19, v10, s[8:11], s34 offen sc1
    s_add_u32 s47, s47, 1
    s_cmp_gt_u32 s47, 400000
    s_cbranch_scc1 polled_40
    s_waitcnt vmcnt(0)
    v_cmp_gt_u32 vcc, 2, v19
    s_nop 1
    s_cbranch_vccnz poll_39
polled_40:
    s_waitcnt vmcnt(0)
    s_branch hok_37
hwait_42:
    s_mov_b32 s47, 0
poll_43:
    buffer_load_dword v19, v10, s[8:11], s34 offen sc1
    s_add_u32 s47, s47, 1
    s_cmp_gt_u32 s47, 400000
    s_cbranch_scc1 polled_44
    s_waitcnt vmcnt(0)
    v_cmp_gt_u32 vcc, 3, v19
    s_nop 1
    s_cbranch_vccnz poll_43
polled_44:
    s_waitcnt vmcnt(0)
    s_branch hok_41
p5_skip_35:
    s_nop 4
    v_mul_f32 v224, v17, v144
    v_mul_f32 v225, v17, v145
    v_mul_f32 v226, v17, v146
    v_mul_f32 v227, v17, v147
    v_mul_f32 v228, v17, v148
    v_mul_f32 v229, v17, v149
    v_mul_f32 v230, v17, v150
    v_mul_f32 v231, v17, v151
    v_exp_f32 v224, v224
    v_mul_f32 v144, v144, v152
    v_exp_f32 v225, v225
    v_mul_f32 v145, v145, v153
    v_exp_f32 v226, v226
    v_mul_f32 v146, v146, v154
    v_exp_f32 v227, v227
    v_mul_f32 v147, v147, v155
    v_exp_f32 v228, v228
    v_mul_f32 v148, v148, v156
    v_exp_f32 v229, v229
    v_mul_f32 v149, v149, v157
    v_exp_f32 v230, v230
    v_mul_f32 v150, v150, v158
    v_exp_f32 v231, v231
    v_mul_f32 v151, v151, v159
    v_add_f32 v224, 1.0, v224
    v_add_f32 v225, 1.0, v225
    v_add_f32 v226, 1.0, v226
    v_add_f32 v227, 1.0, v227
    v_add_f32 v228, 1.0, v228
    v_add_f32 v229, 1.0, v229
    v_add_f32 v230, 1.0, v230
    v_add_f32 v231, 1.0, v231
    v_rcp_f32 v224, v224
    v_rcp_f32 v225, v225
    v_mul_f32 v144, v144, v224
    v_rcp_f32 v226, v226
    v_mul_f32 v145, v145, v225
    v_rcp_f32 v227, v227
    v_mul_f32 v146, v146, v226
    v_rcp_f32 v228, v228
    v_mul_f32 v147, v147, v227
    v_rcp_f32 v229, v229
    v_mul_f32 v148, v148, v228
    v_rcp_f32 v230, v230
    v_mul_f32 v149, v149, v229
    v_rcp_f32 v231, v231
    v_mul_f32 v150, v150, v230
    v_mul_f32 v151, v151, v231
    v_cvt_pk_bf16_f32 v240, v144, v145
    v_cvt_pk_bf16_f32 v241, v146, v147
    v_cvt_pk_bf16_f32 v242, v148, v149
    v_cvt_pk_bf16_f32 v243, v150, v151
    buffer_store_dwordx4 v[240:243], v1, s[8:11], s61 offen offset:2048 sc1
    v_mov_b32 v18, 3
    s_waitcnt vmcnt(0)
    s_mov_b64 exec, 1
    buffer_store_dword v18, v11, s[8:11], s33 offen
    s_mov_b64 exec, -1
    s_barrier
    s_add_u32 m0, s28, 0
    s_add_u32 s24, s27, 0
    buffer_load_dwordx4 v1, s[8:11], s24 offen offset:0 lds
    buffer_load_dwordx4 v1, s[8:11], s24 offen offset:1024 lds
    buffer_load_dwordx4 v1, s[8:11], s24 offen offset:2048 lds
    buffer_load_dwordx4 v1, s[8:11], s24 offen offset:3072 lds
    s_add_u32 m0, s28, 4096
    s_add_u32 s24, s27, 4096
    buffer_load_dwordx4 v1, s[8:11], s24 offen offset:0 lds
    buffer_load_dwordx4 v1, s[8:11], s24 offen offset:1024 lds
    buffer_load_dwordx4 v1, s[8:11], s24 offen offset:2048 lds
    buffer_load_dwordx4 v1, s[8:11], s24 offen offset:3072 lds
    s_add_u32 m0, s28, 8192
    s_add_u32 s24, s27, 8192
    buffer_load_dwordx4 v1, s[8:11], s24 offen offset:0 lds
    buffer_load_dwordx4 v1, s[8:11], s24 offen offset:1024 lds
    buffer_load_dwordx4 v1, s[8:11], s24 offen offset:2048 lds
    buffer_load_dwordx4 v1, s[8:11], s24 offen offset:3072 lds
    s_add_u32 m0, s28, 12288
    s_add_u32 s24, s27, 12288
    buffer_load_dwordx4 v1, s[8:11], s24 offen offset:0 lds
    buffer_load_dwordx4 v1, s[8:11], s24 offen offset:1024 lds
    buffer_load_dwordx4 v1, s[8:11], s24 offen offset:2048 lds
    buffer_load_dwordx4 v1, s[8:11], s24 offen offset:3072 lds
    s_add_u32 m0, s28, 16384
    s_add_u32 s24, s27, 16384
    buffer_load_dwordx4 v1, s[8:11], s24 offen offset:0 lds
    buffer_load_dwordx4 v1, s[8:11], s24 offen offset:1024 lds
    buffer_load_dwordx4 v1, s[8:11], s24 offen offset:2048 lds
    buffer_load_dwordx4 v1, s[8:11], s24 offen offset:3072 lds
    s_add_u32 m0, s28, 20480
    s_add_u32 s24, s27, 20480
    buffer_load_dwordx4 v1, s[8:11], s24 offen offset:0 lds
    s_branch p5_join_36
A_fill_47:
    v_mov_b32 v248, 0
    v_mov_b32 v249, 0
    v_mov_b32 v250, 0
    v_mov_b32 v251, 0
    v_mov_b32 v252, 0
    v_mov_b32 v253, 0
    v_mov_b32 v255, 0
    v_mov_b32 v23, 0xf14a
    v_cndmask_b32 v254, 0, v23, s[96:97]
    v_add_u32 v22, s53, v1
    ds_write_b128 v22, v[248:251] offset:0
    ds_write_b128 v22, v[252:255] offset:1024
    ds_write_b128 v22, v[248:251] offset:2048
    ds_write_b128 v22, v[248:251] offset:3072
    ds_write_b128 v22, v[248:251] offset:4096
    ds_write_b128 v22, v[252:255] offset:5120
    ds_write_b128 v22, v[248:251] offset:6144
    ds_write_b128 v22, v[248:251] offset:7168
    s_waitcnt lgkmcnt(0)
    s_branch A_join_48
att_fb_55:
    s_nop 7
    s_nop 7
    v_mov_b32 v28, v12
    v_mov_b32 v27, v26
    s_mov_b32 s62, 0
fb1_56:
    s_nop 7
    s_nop 4
    ds_read_b128 v[96:99], v28
    ds_read_b128 v[100:103], v28 offset:1024
    ds_read_b128 v[104:107], v28 offset:2048
    ds_read_b128 v[108:111], v28 offset:3072
    s_waitcnt lgkmcnt(3)
    v_mfma_f32_32x32x16_bf16 v[32:47], v[96:99], v[232:235], 0
    s_waitcnt lgkmcnt(2)
    v_mfma_f32_32x32x16_bf16 v[32:47], v[100:103], v[236:239], v[32:47]
    s_cmp_lg_u32 s62, 0
    s_cbranch_scc1 sk_58
    s_nop 9
    v_cndmask_b32 v32, v32, v26, s[64:65]
    v_cndmask_b32 v33, v33, v26, s[66:67]
    v_cndmask_b32 v34, v34, v26, s[68:69]
    v_cndmask_b32 v35, v35, v26, s[70:71]
    v_cndmask_b32 v36, v36, v26, s[72:73]
    v_cndmask_b32 v37, v37, v26, s[74:75]
    v_cndmask_b32 v38, v38, v26, s[76:77]
    v_cndmask_b32 v39, v39, v26, s[78:79]
    v_cndmask_b32 v40, v40, v26, s[80:81]
    v_cndmask_b32 v41, v41, v26, s[82:83]
    v_cndmask_b32 v42, v42, v26, s[84:85]
    v_cndmask_b32 v43, v43, v26, s[86:87]
    v_cndmask_b32 v44, v44, v26, s[88:89]
    v_cndmask_b32 v45, v45, v26, s[90:91]
    v_cndmask_b32 v46, v46, v26, s[92:93]
    v_cndmask_b32 v47, v47, v26, s[94:95]
sk_58:
    s_cmp_lg_u32 s62, 8
    s_cbranch_scc1 sk_59
    s_nop 7
    v_cndmask_b32 v32, v26, v32, s[64:65]
    v_cndmask_b32 v33, v26, v33, s[66:67]
    v_cndmask_b32 v34, v26, v34, s[68:69]
    v_cndmask_b32 v35, v26, v35, s[70:71]
    v_cndmask_b32 v36, v26, v36, s[72:73]
    v_cndmask_b32 v37, v26, v37, s[74:75]
    v_cndmask_b32 v38, v26, v38, s[76:77]
    v_cndmask_b32 v39, v26, v39, s[78:79]
    v_cndmask_b32 v40, v26, v40, s[80:81]
    v_cndmask_b32 v41, v26, v41, s[82:83]
    v_cndmask_b32 v42, v26, v42, s[84:85]
    v_cndmask_b32 v43, v26, v43, s[86:87]
    v_cndmask_b32 v44, v26, v44, s[88:89]
    v_cndmask_b32 v45, v26, v45, s[90:91]
    v_cndmask_b32 v46, v26, v46, s[92:93]
    v_cndmask_b32 v47, v26, v47, s[94:95]
sk_59:
    s_nop 7
    v_max3_f32 v27, v32, v33, v27
    v_max3_f32 v27, v34, v35, v27
    v_max3_f32 v27, v36, v37, v27
    v_max3_f32 v27, v38, v39, v27
    v_max3_f32 v27, v40, v41, v27
    v_max3_f32 v27, v42, v43, v27
    v_max3_f32 v27, v44, v45, v27
    v_max3_f32 v27, v46, v47, v27
    v_add_u32 v28, 4096, v28
    s_add_u32 s62, s62, 1
    s_cmp_lt_u32 s62, 9
    s_waitcnt lgkmcnt(0)
    s_cbranch_scc1 fb1_56
    v_mov_b32 v23, v27
    s_nop 1
    v_permlane32_swap_b32 v27, v23
    v_max_f32 v27, v27, v23
    v_mov_b32 v28, v12
    s_mov_b32 s62, 0
    v_mov_b32 v64, 0
    v_mov_b32 v65, 0
    v_mov_b32 v66, 0
    v_mov_b32 v67, 0
    v_mov_b32 v68, 0
    v_mov_b32 v69, 0
    v_mov_b32 v70, 0
    v_mov_b32 v71, 0
    v_mov_b32 v72, 0
    v_mov_b32 v73, 0
    v_mov_b32 v74, 0
    v_mov_b32 v75, 0
    v_mov_b32 v76, 0
    v_mov_b32 v77, 0
    v_mov_b32 v78, 0
    v_mov_b32 v79, 0
fb2_57:
    s_nop 7
    s_nop 4
    ds_read_b128 v[96:99], v28
    ds_read_b128 v[100:103], v28 offset:1024
    ds_read_b128 v[104:107], v28 offset:2048
    ds_read_b128 v[108:111], v28 offset:3072
    s_waitcnt lgkmcnt(3)
    v_mfma_f32_32x32x16_bf16 v[32:47], v[96:99], v[232:235], 0
    s_waitcnt lgkmcnt(2)
    v_mfma_f32_32x32x16_bf16 v[32:47], v[100:103], v[236:239], v[32:47]
    s_cmp_lg_u32 s62, 0
    s_cbranch_scc1 sk_60
    s_nop 9
    v_cndmask_b32 v32, v32, v26, s[64:65]
    v_cndmask_b32 v33, v33, v26, s[66:67]
    v_cndmask_b32 v34, v34, v26, s[68:69]
    v_cndmask_b32 v35, v35, v26, s[70:71]
    v_cndmask_b32 v36, v36, v26, s[72:73]
    v_cndmask_b32 v37, v37, v26, s[74:75]
    v_cndmask_b32 v38, v38, v26, s[76:77]
    v_cndmask_b32 v39, v39, v26, s[78:79]
    v_cndmask_b32 v40, v40, v26, s[80:81]
    v_cndmask_b32 v41, v41, v26, s[82:83]
    v_cndmask_b32 v42, v42, v26, s[84:85]
    v_cndmask_b32 v43, v43, v26, s[86:87]
    v_cndmask_b32 v44, v44, v26, s[88:89]
    v_cndmask_b32 v45, v45, v26, s[90:91]
    v_cndmask_b32 v46, v46, v26, s[92:93]
    v_cndmask_b32 v47, v47, v26, s[94:95]
sk_60:
    s_cmp_lg_u32 s62, 8
    s_cbranch_scc1 sk_61
    s_nop 7
    v_cndmask_b32 v32, v26, v32, s[64:65]
    v_cndmask_b32 v33, v26, v33, s[66:67]
    v_cndmask_b32 v34, v26, v34, s[68:69]
    v_cndmask_b32 v35, v26, v35, s[70:71]
    v_cndmask_b32 v36, v26, v36, s[72:73]
    v_cndmask_b32 v37, v26, v37, s[74:75]
    v_cndmask_b32 v38, v26, v38, s[76:77]
    v_cndmask_b32 v39, v26, v39, s[78:79]
    v_cndmask_b32 v40, v26, v40, s[80:81]
    v_cndmask_b32 v41, v26, v41, s[82:83]
    v_cndmask_b32 v42, v26, v42, s[84:85]
    v_cndmask_b32 v43, v26, v43, s[86:87]
    v_cndmask_b32 v44, v26, v44, s[88:89]
    v_cndmask_b32 v45, v26, v45, s[90:91]
    v_cndmask_b32 v46, v26, v46, s[92:93]
    v_cndmask_b32 v47, v26, v47, s[94:95]
sk_61:
    s_nop 7
    v_sub_f32 v32, v32, v27
    v_sub_f32 v33, v33, v27
    v_sub_f32 v34, v34, v27
    v_sub_f32 v35, v35, v27
    v_sub_f32 v36, v36, v27
    v_sub_f32 v37, v37, v27
    v_sub_f32 v38, v38, v27
    v_sub_f32 v39, v39, v27
    v_sub_f32 v40, v40, v27
    v_sub_f32 v41, v41, v27
    v_sub_f32 v42, v42, v27
    v_sub_f32 v43, v43, v27
    v_sub_f32 v44, v44, v27
    v_sub_f32 v45, v45, v27
    v_sub_f32 v46, v46, v27
    v_sub_f32 v47, v47, v27
    v_exp_f32 v32, v32
    v_exp_f32 v33, v33
    v_exp_f32 v34, v34
    v_exp_f32 v35, v35
    v_exp_f32 v36, v36
    v_exp_f32 v37, v37
    v_exp_f32 v38, v38
    v_exp_f32 v39, v39
    v_exp_f32 v40, v40
    v_exp_f32 v41, v41
    v_exp_f32 v42, v42
    v_exp_f32 v43, v43
    v_exp_f32 v44, v44
    v_exp_f32 v45, v45
    v_exp_f32 v46, v46
    v_exp_f32 v47, v47
    v_cvt_pk_bf16_f32 v48, v32, v33
    v_cvt_pk_bf16_f32 v49, v34, v35
    v_cvt_pk_bf16_f32 v50, v36, v37
    v_cvt_pk_bf16_f32 v51, v38, v39
    v_cvt_pk_bf16_f32 v52, v40, v41
    v_cvt_pk_bf16_f32 v53, v42, v43
    v_cvt_pk_bf16_f32 v54, v44, v45
    v_cvt_pk_bf16_f32 v55, v46, v47
    s_waitcnt lgkmcnt(1)
    v_mfma_f32_32x32x16_bf16 v[64:79], v[104:107], v[48:51], v[64:79]
    s_waitcnt lgkmcnt(0)
    v_mfma_f32_32x32x16_bf16 v[64:79], v[108:111], v[52:55], v[64:79]
    v_add_u32 v28, 4096, v28
    s_add_u32 s62, s62, 1
    s_cmp_lt_u32 s62, 9
    s_waitcnt lgkmcnt(0)
    s_cbranch_scc1 fb2_57
    s_nop 6
    v_mov_b32 v22, v76
    v_mov_b32 v23, v76
    s_nop 1
    v_permlane32_swap_b32 v22, v23
    s_nop 7
    s_branch att_ok_54
p3_skip_62:
    s_barrier
    v_min_u32 v19, 55, v2
    v_lshlrev_b32 v19, 7, v19
    s_add_u32 s0, s61, 0
    buffer_load_dword v0, v19, s[8:11], s0 offen sc1
    s_branch p3_join_63
hwait_71:
    s_mov_b32 s47, 0
poll_72:
    buffer_load_dword v19, v10, s[8:11], s34 offen sc1
    s_add_u32 s47, s47, 1
    s_cmp_gt_u32 s47, 400000
    s_cbranch_scc1 polled_73
    s_waitcnt vmcnt(0)
    v_cmp_gt_u32 vcc, 4, v19
    s_nop 1
    s_cbranch_vccnz poll_72
polled_73:
    s_waitcnt vmcnt(0)
    s_branch hok_70
hwait_77:
    s_mov_b32 s47, 0
poll_78:
    buffer_load_dword v19, v10, s[8:11], s34 offen sc1
    s_add_u32 s47, s47, 1
    s_cmp_gt_u32 s47, 400000
    s_cbranch_scc1 polled_79
    s_waitcnt vmcnt(0)
    v_cmp_gt_u32 vcc, 5, v19
    s_nop 1
    s_cbranch_vccnz poll_78
polled_79:
    s_waitcnt vmcnt(0)
    s_branch hok_76
hwait_81:
    s_mov_b32 s47, 0
poll_82:
    buffer_load_dword v19, v10, s[8:11], s34 offen sc1
    s_add_u32 s47, s47, 1
    s_cmp_gt_u32 s47, 400000
    s_cbranch_scc1 polled_83
    s_waitcnt vmcnt(0)
    v_cmp_gt_u32 vcc, 6, v19
    s_nop 1
    s_cbranch_vccnz poll_82
polled_83:
    s_waitcnt vmcnt(0)
    s_branch hok_80
p5_skip_74:
    s_nop 4
    v_mul_f32 v224, v17, v144
    v_mul_f32 v225, v17, v145
    v_mul_f32 v226, v17, v146
    v_mul_f32 v227, v17, v147
    v_mul_f32 v228, v17, v148
    v_mul_f32 v229, v17, v149
    v_mul_f32 v230, v17, v150
    v_mul_f32 v231, v17, v151
    v_exp_f32 v224, v224
    v_mul_f32 v144, v144, v152
    v_exp_f32 v225, v225
    v_mul_f32 v145, v145, v153
    v_exp_f32 v226, v226
    v_mul_f32 v146, v146, v154
    v_exp_f32 v227, v227
    v_mul_f32 v147, v147, v155
    v_exp_f32 v228, v228
    v_mul_f32 v148, v148, v156
    v_exp_f32 v229, v229
    v_mul_f32 v149, v149, v157
    v_exp_f32 v230, v230
    v_mul_f32 v150, v150, v158
    v_exp_f32 v231, v231
    v_mul_f32 v151, v151, v159
    v_add_f32 v224, 1.0, v224
    v_add_f32 v225, 1.0, v225
    v_add_f32 v226, 1.0, v226
    v_add_f32 v227, 1.0, v227
    v_add_f32 v228, 1.0, v228
    v_add_f32 v229, 1.0, v229
    v_add_f32 v230, 1.0, v230
    v_add_f32 v231, 1.0, v231
    v_rcp_f32 v224, v224
    v_rcp_f32 v225, v225
    v_mul_f32 v144, v144, v224
    v_rcp_f32 v226, v226
    v_mul_f32 v145, v145, v225
    v_rcp_f32 v227, v227
    v_mul_f32 v146, v146, v226
    v_rcp_f32 v228, v228
    v_mul_f32 v147, v147, v227
    v_rcp_f32 v229, v229
    v_mul_f32 v148, v148, v228
    v_rcp_f32 v230, v230
    v_mul_f32 v149, v149, v229
    v_rcp_f32 v231, v231
    v_mul_f32 v150, v150, v230
    v_mul_f32 v151, v151, v231
    v_cvt_pk_bf16_f32 v240, v144, v145
    v_cvt_pk_bf16_f32 v241, v146, v147
    v_cvt_pk_bf16_f32 v242, v148, v149
    v_cvt_pk_bf16_f32 v243, v150, v151
    buffer_store_dwordx4 v[240:243], v1, s[8:11], s61 offen offset:2048
    v_mov_b32 v18, 6
    s_waitcnt vmcnt(0)
    s_mov_b64 exec, 1
    buffer_store_dword v18, v11, s[8:11], s33 offen
    s_mov_b64 exec, -1
    s_branch MAIN_tail
SLOW_entry:
    s_mov_b32 s44, 1
    s_mov_b32 s39, 7303168
    s_mov_b32 s42, 38236160
    s_mov_b32 s40, 192512
    s_mov_b32 s43, 421888
    s_mov_b32 s37, 11235328
    s_mov_b32 s38, 9138176
    s_mov_b32 s41, 19623936
    s_lshl_b32 s100, s5, 6
    s_add_u32 s100, s100, s6
    s_lshl_b32 s100, s100, 11
    s_add_u32 s100, s100, s38
    s_mul_i32 s61, s6, 112
    s_mul_i32 s53, s5, 7
    s_add_u32 s61, s61, s53
    s_lshl_b32 s61, s61, 10
    s_add_u32 s61, s61, s41
    s_mul_i32 s101, s55, 28
    s_lshl_b32 s49, s54, 1
    s_add_u32 s101, s101, s49
    s_lshl_b32 s101, s101, 10
    s_add_u32 s101, s101, s39
    s_mul_i32 s1, s55, 14
    s_add_u32 s1, s1, s54
    s_lshl_b32 s1, s1, 8
    s_add_u32 s1, s1, s40
ATT_s:
    s_nop 7
    s_nop 4
    v_mfma_f32_32x32x16_bf16 v[32:47], v[216:219], v[232:235], 0
    v_mfma_f32_32x32x16_bf16 v[32:47], v[220:223], v[236:239], v[32:47]
    v_add_u32 v28, 28672, v12
    ds_read_b128 v[96:99], v28
    ds_read_b128 v[100:103], v28 offset:1024
    s_mul_i32 s48, s3, s3
    s_mul_i32 s63, s3, 30
    s_lshl_b32 s48, s48, 1
    s_sub_u32 s63, s63, s48
    s_lshl_b32 s63, s63, 10
    s_sub_u32 s0, s25, s26
    v_mov_b32 v104, v224
    v_mov_b32 v105, v225
    v_mov_b32 v106, v226
    v_mov_b32 v107, v227
    v_mov_b32 v108, v228
    v_mov_b32 v109, v229
    v_mov_b32 v110, v230
    v_mov_b32 v111, v231
    v_mov_b32 v64, 0
    v_mov_b32 v65, 0
    v_mov_b32 v66, 0
    v_mov_b32 v67, 0
    v_mov_b32 v68, 0
    v_mov_b32 v69, 0
    v_mov_b32 v70, 0
    v_mov_b32 v71, 0
    v_mov_b32 v72, 0
    v_mov_b32 v73, 0
    v_mov_b32 v74, 0
    v_mov_b32 v75, 0
    v_mov_b32 v76, 0
    v_mov_b32 v77, 0
    v_mov_b32 v78, 0
    v_mov_b32 v79, 0
    v_cndmask_b32 v32, v26, v32, s[64:65]
    v_cndmask_b32 v33, v26, v33, s[66:67]
    v_cndmask_b32 v34, v26, v34, s[68:69]
    v_cndmask_b32 v35, v26, v35, s[70:71]
    v_cndmask_b32 v36, v26, v36, s[72:73]
    v_cndmask_b32 v37, v26, v37, s[74:75]
    v_cndmask_b32 v38, v26, v38, s[76:77]
    v_cndmask_b32 v39, v26, v39, s[78:79]
    v_cndmask_b32 v40, v26, v40, s[80:81]
    v_cndmask_b32 v41, v26, v41, s[82:83]
    v_cndmask_b32 v42, v26, v42, s[84:85]
    v_cndmask_b32 v43, v26, v43, s[86:87]
    v_cndmask_b32 v44, v26, v44, s[88:89]
    v_cndmask_b32 v45, v26, v45, s[90:91]
    v_cndmask_b32 v46, v26, v46, s[92:93]
    v_cndmask_b32 v47, v26, v47, s[94:95]
    v_max_f32 v27, v32, v33
    v_max3_f32 v27, v34, v35, v27
    v_max3_f32 v27, v36, v37, v27
    v_max3_f32 v27, v38, v39, v27
    v_max3_f32 v27, v40, v41, v27
    v_max3_f32 v27, v42, v43, v27
    v_max3_f32 v27, v44, v45, v27
    v_max3_f32 v27, v46, v47, v27
    v_mov_b32 v23, v27
    s_nop 1
    v_permlane32_swap_b32 v27, v23
    v_max_f32 v27, v27, v23
    v_sub_f32 v80, 0, v27
    v_sub_f32 v81, 0, v27
    v_pk_add_f32 v[32:33], v[32:33], v[80:81]
    v_pk_add_f32 v[34:35], v[34:35], v[80:81]
    v_pk_add_f32 v[36:37], v[36:37], v[80:81]
    v_pk_add_f32 v[38:39], v[38:39], v[80:81]
    v_pk_add_f32 v[40:41], v[40:41], v[80:81]
    v_pk_add_f32 v[42:43], v[42:43], v[80:81]
    v_pk_add_f32 v[44:45], v[44:45], v[80:81]
    v_pk_add_f32 v[46:47], v[46:47], v[80:81]
    v_pk_mov_b32 v[82:83], v[80:81], v[80:81] op_sel:[0,1]
    v_pk_mov_b32 v[84:85], v[80:81], v[80:81] op_sel:[0,1]
    v_pk_mov_b32 v[86:87], v[80:81], v[80:81] op_sel:[0,1]
    v_pk_mov_b32 v[88:89], v[80:81], v[80:81] op_sel:[0,1]
    v_pk_mov_b32 v[90:91], v[80:81], v[80:81] op_sel:[0,1]
    v_pk_mov_b32 v[92:93], v[80:81], v[80:81] op_sel:[0,1]
    v_pk_mov_b32 v[94:95], v[80:81], v[80:81] op_sel:[0,1]
    v_exp_f32 v32, v32
    v_exp_f32 v33, v33
    v_exp_f32 v34, v34
    v_exp_f32 v35, v35
    s_cmp_eq_u32 s7, 0
    s_cbranch_scc1 sk_84
    s_add_u32 s50, s31, 0
    buffer_load_dwordx4 v[128:131], v1, s[8:11], s50 offen offset:0
    buffer_load_dwordx4 v[132:135], v1, s[8:11], s50 offen offset:1024
    buffer_load_dwordx4 v[136:139], v1, s[8:11], s50 offen offset:2048
    buffer_load_dwordx4 v[140:143], v1, s[8:11], s50 offen offset:3072
sk_84:
    v_exp_f32 v36, v36
    v_exp_f32 v37, v37
    v_exp_f32 v38, v38
    v_exp_f32 v39, v39
    s_cmp_eq_u32 s7, 0
    s_cbranch_scc1 sk_85
    s_add_u32 s50, s31, 4096
    buffer_load_dwordx4 v[144:147], v1, s[8:11], s50 offen offset:0
    buffer_load_dwordx4 v[148:151], v1, s[8:11], s50 offen offset:1024
    buffer_load_dwordx4 v[152:155], v1, s[8:11], s50 offen offset:2048
    buffer_load_dwordx4 v[156:159], v1, s[8:11], s50 offen offset:3072
sk_85:
    v_exp_f32 v40, v40
    v_exp_f32 v41, v41
    v_exp_f32 v42, v42
    v_exp_f32 v43, v43
    s_cmp_eq_u32 s7, 0
    s_cbranch_scc1 sk_86
    s_add_u32 s50, s32, 0
    buffer_load_dwordx4 v[160:163], v1, s[8:11], s50 offen offset:0
    buffer_load_dwordx4 v[164:167], v1, s[8:11], s50 offen offset:1024
    buffer_load_dwordx4 v[168:171], v1, s[8:11], s50 offen offset:2048
    buffer_load_dwordx4 v[172:175], v1, s[8:11], s50 offen offset:3072
sk_86:
    v_exp_f32 v44, v44
    v_exp_f32 v45, v45
    v_exp_f32 v46, v46
    v_exp_f32 v47, v47
    s_cmp_eq_u32 s7, 0
    s_cbranch_scc1 sk_87
    s_add_u32 s50, s32, 4096
    buffer_load_dwordx4 v[176:179], v1, s[8:11], s50 offen offset:0
    buffer_load_dwordx4 v[180:183], v1, s[8:11], s50 offen offset:1024
    buffer_load_dwordx4 v[184:187], v1, s[8:11], s50 offen offset:2048
    buffer_load_dwordx4 v[188:191], v1, s[8:11], s50 offen offset:3072
sk_87:
    v_cvt_pk_bf16_f32 v48, v32, v33
    v_cvt_pk_bf16_f32 v49, v34, v35
    v_cvt_pk_bf16_f32 v50, v36, v37
    v_cvt_pk_bf16_f32 v51, v38, v39
    v_cvt_pk_bf16_f32 v52, v40, v41
    v_cvt_pk_bf16_f32 v53, v42, v43
    v_cvt_pk_bf16_f32 v54, v44, v45
    v_cvt_pk_bf16_f32 v55, v46, v47
    s_lshl_b32 s50, s4, 2
    s_lshl_b32 s51, s3, 1
    s_add_u32 s50, s50, s51
    s_sub_i32 s50, s50, 8
    s_lshl_b32 s53, s3, 13
    s_add_u32 s53, s53, 86016
    s_cmp_lt_i32 s50, 0
    s_cbranch_scc1 A_fill_88
    s_lshl_b32 s48, s5, 6
    s_add_u32 s48, s48, s50
    s_lshl_b32 s52, s48, 2
    s_add_u32 s52, s52, 32768
    s_lshl_b32 s60, s48, 12
    s_add_u32 s60, s60, s37
    v_and_b32 v22, 1, v2
    v_lshlrev_b32 v22, 2, v22
    s_mov_b32 s47, 0
poll_90:
    buffer_load_dword v18, v22, s[8:11], s52 offen sc1
    s_add_u32 s47, s47, 1
    s_cmp_gt_u32 s47, 400000
    s_cbranch_scc1 polled_91
    s_waitcnt vmcnt(0)
    v_cmp_gt_u32 vcc, s44, v18
    s_nop 1
    s_cbranch_vccnz poll_90
polled_91:
    s_waitcnt vmcnt(0)
    s_add_u32 m0, s53, 0
    s_add_u32 s24, s60, 0
    buffer_load_dwordx4 v1, s[8:11], s24 offen offset:0 lds
    buffer_load_dwordx4 v1, s[8:11], s24 offen offset:1024 lds
    buffer_load_dwordx4 v1, s[8:11], s24 offen offset:2048 lds
    buffer_load_dwordx4 v1, s[8:11], s24 offen offset:3072 lds
    s_add_u32 m0, s53, 4096
    s_add_u32 s24, s60, 4096
    buffer_load_dwordx4 v1, s[8:11], s24 offen offset:0 lds
    buffer_load_dwordx4 v1, s[8:11], s24 offen offset:1024 lds
    buffer_load_dwordx4 v1, s[8:11], s24 offen offset:2048 lds
    buffer_load_dwordx4 v1, s[8:11], s24 offen offset:3072 lds
A_join_89:
    s_mov_b32 s62, s3
    s_waitcnt lgkmcnt(0)
    s_cmp_eq_u32 s62, 0
    s_cbranch_scc1 att1e_93
att1_92:
    s_nop 1
    v_mfma_f32_32x32x16_bf16 v[32:47], v[96:99], v[232:235], v[80:95]
    v_mfma_f32_32x32x16_bf16 v[32:47], v[100:103], v[236:239], v[32:47]
    v_mfma_f32_32x32x16_bf16 v[64:79], v[104:107], v[48:51], v[64:79]
    v_mfma_f32_32x32x16_bf16 v[64:79], v[108:111], v[52:55], v[64:79]
    ds_read_b128 v[104:107], v28 offset:2048
    ds_read_b128 v[108:111], v28 offset:3072
    v_subrev_u32 v28, 4096, v28
    ds_read_b128 v[96:99], v28
    ds_read_b128 v[100:103], v28 offset:1024
    s_nop 4
    v_exp_f32 v32, v32
    v_exp_f32 v33, v33
    v_exp_f32 v34, v34
    v_exp_f32 v35, v35
    v_cvt_pk_bf16_f32 v48, v32, v33
    v_exp_f32 v36, v36
    v_exp_f32 v37, v37
    v_cvt_pk_bf16_f32 v49, v34, v35
    v_exp_f32 v38, v38
    v_exp_f32 v39, v39
    v_cvt_pk_bf16_f32 v50, v36, v37
    v_exp_f32 v40, v40
    v_exp_f32 v41, v41
    v_cvt_pk_bf16_f32 v51, v38, v39
    v_exp_f32 v42, v42
    v_exp_f32 v43, v43
    v_cvt_pk_bf16_f32 v52, v40, v41
    v_exp_f32 v44, v44
    v_exp_f32 v45, v45
    v_cvt_pk_bf16_f32 v53, v42, v43
    v_exp_f32 v46, v46
    v_exp_f32 v47, v47
    v_cvt_pk_bf16_f32 v54, v44, v45
    v_cvt_pk_bf16_f32 v55, v46, v47
    s_sub_u32 s62, s62, 1
    s_cmp_lg_u32 s62, 0
    s_waitcnt lgkmcnt(0)
    s_cbranch_scc1 att1_92
att1e_93:
    s_cmp_lg_u32 s7, 0
    s_cbranch_scc1 wready_95
    s_mul_i32 s48, s5, 7
    s_add_u32 s49, s48, 6
    s_and_b32 s48, s48, -4
    s_or_b32 s49, s49, 3
    v_add_u32 v22, s48, v2
    v_min_u32 v22, s49, v22
    s_lshr_b32 s50, s54, 1
    s_lshl_b32 s48, s50, 3
    s_add_u32 s48, s48, 112
    v_and_b32 v23, 7, v2
    v_add_u32 v23, s48, v23
    v_cmp_le_u32 vcc, 16, v2
    s_lshl_b32 s48, s50, 1
    s_add_u32 s48, s48, 168
    v_cndmask_b32 v22, v22, v23, vcc
    v_and_b32 v23, 1, v2
    v_add_u32 v23, s48, v23
    v_cmp_le_u32 vcc, 24, v2
    v_bfe_u32 v24, v2, 1, 3
    v_and_b32 v25, 1, v2
    v_cndmask_b32 v22, v22, v23, vcc
    v_lshl_add_u32 v24, v25, 7, v24
    s_lshl_b32 s48, s5, 3
    v_add_u32 v24, s48, v24
    v_cndmask_b32 v22, v22, v24, s[96:97]
    v_lshlrev_b32 v22, 7, v22
    s_mov_b32 s48, 65536
    s_mov_b32 s47, 0
poll_96:
    buffer_load_dword v18, v22, s[8:11], s48 offen sc1
    s_add_u32 s47, s47, 1
    s_cmp_gt_u32 s47, 400000
    s_cbranch_scc1 polled_97
    s_waitcnt vmcnt(0)
    v_cmp_gt_u32 vcc, 1, v18
    s_nop 1
    s_cbranch_vccnz poll_96
polled_97:
    s_waitcnt vmcnt(0)
wready_95:
    s_waitcnt vmcnt(0)
    s_barrier
    ds_read_b128 v[96:99], v28
    ds_read_b128 v[100:103], v28 offset:1024
    s_sub_u32 s62, 7, s3
    s_cmp_lg_u32 s7, 0
    s_cbranch_scc1 sk_98
    s_add_u32 s50, s31, 0
    buffer_load_dwordx4 v[128:131], v1, s[8:11], s50 offen offset:0
    buffer_load_dwordx4 v[132:135], v1, s[8:11], s50 offen offset:1024
    buffer_load_dwordx4 v[136:139], v1, s[8:11], s50 offen offset:2048
    buffer_load_dwordx4 v[140:143], v1, s[8:11], s50 offen offset:3072
    s_add_u32 s50, s31, 4096
    buffer_load_dwordx4 v[144:147], v1, s[8:11], s50 offen offset:0
    buffer_load_dwordx4 v[148:151], v1, s[8:11], s50 offen offset:1024
    buffer_load_dwordx4 v[152:155], v1, s[8:11], s50 offen offset:2048
    buffer_load_dwordx4 v[156:159], v1, s[8:11], s50 offen offset:3072
    s_add_u32 s50, s32, 0
    buffer_load_dwordx4 v[160:163], v1, s[8:11], s50 offen offset:0
    buffer_load_dwordx4 v[164:167], v1, s[8:11], s50 offen offset:1024
    buffer_load_dwordx4 v[168:171], v1, s[8:11], s50 offen offset:2048
    buffer_load_dwordx4 v[172:175], v1, s[8:11], s50 offen offset:3072
    s_add_u32 s50, s32, 4096
    buffer_load_dwordx4 v[176:179], v1, s[8:11], s50 offen offset:0
    buffer_load_dwordx4 v[180:183], v1, s[8:11], s50 offen offset:1024
    buffer_load_dwordx4 v[184:187], v1, s[8:11], s50 offen offset:2048
    buffer_load_dwordx4 v[188:191], v1, s[8:11], s50 offen offset:3072
    v_lshlrev_b32 v22, 2, v3
    v_lshl_add_u32 v22, v4, 9, v22
    s_mul_i32 s48, s5, 7
    s_add_u32 s48, s48, s3
    s_lshl_b32 s48, s48, 7
    s_add_u32 s48, s48, 131072
    s_add_u32 s49, s48, 0
    buffer_load_dword v112, v22, s[8:11], s49 offen
    s_add_u32 s49, s48, 14336
    buffer_load_dword v113, v22, s[8:11], s49 offen
    s_add_u32 s49, s48, 28672
    buffer_load_dword v114, v22, s[8:11], s49 offen
    s_add_u32 s49, s48, 43008
    buffer_load_dword v115, v22, s[8:11], s49 offen
sk_98:
    s_waitcnt lgkmcnt(0)
att2_94:
    s_nop 1
    v_mfma_f32_32x32x16_bf16 v[32:47], v[96:99], v[232:235], v[80:95]
    v_mfma_f32_32x32x16_bf16 v[32:47], v[100:103], v[236:239], v[32:47]
    v_mfma_f32_32x32x16_bf16 v[64:79], v[104:107], v[48:51], v[64:79]
    v_mfma_f32_32x32x16_bf16 v[64:79], v[108:111], v[52:55], v[64:79]
    ds_read_b128 v[104:107], v28 offset:2048
    ds_read_b128 v[108:111], v28 offset:3072
    v_subrev_u32 v28, 4096, v28
    ds_read_b128 v[96:99], v28
    ds_read_b128 v[100:103], v28 offset:1024
    s_min_u32 m0, s63, 81920
    s_add_u32 s24, s0, m0
    buffer_load_dwordx4 v1, s[8:11], s24 offen offset:0 lds
    buffer_load_dwordx4 v1, s[8:11], s24 offen offset:1024 lds
    buffer_load_dwordx4 v1, s[8:11], s24 offen offset:2048 lds
    buffer_load_dwordx4 v1, s[8:11], s24 offen offset:3072 lds
    s_add_u32 s63, s63, 4096
    v_exp_f32 v32, v32
    v_exp_f32 v33, v33
    v_exp_f32 v34, v34
    v_exp_f32 v35, v35
    v_cvt_pk_bf16_f32 v48, v32, v33
    v_exp_f32 v36, v36
    v_exp_f32 v37, v37
    v_cvt_pk_bf16_f32 v49, v34, v35
    v_exp_f32 v38, v38
    v_exp_f32 v39, v39
    v_cvt_pk_bf16_f32 v50, v36, v37
    v_exp_f32 v40, v40
    v_exp_f32 v41, v41
    v_cvt_pk_bf16_f32 v51, v38, v39
    v_exp_f32 v42, v42
    v_exp_f32 v43, v43
    v_cvt_pk_bf16_f32 v52, v40, v41
    v_exp_f32 v44, v44
    v_exp_f32 v45, v45
    v_cvt_pk_bf16_f32 v53, v42, v43
    v_exp_f32 v46, v46
    v_exp_f32 v47, v47
    v_cvt_pk_bf16_f32 v54, v44, v45
    v_cvt_pk_bf16_f32 v55, v46, v47
    s_sub_u32 s62, s62, 1
    s_cmp_lg_u32 s62, 0
    s_waitcnt lgkmcnt(0)
    s_cbranch_scc1 att2_94
    s_nop 1
    v_mfma_f32_32x32x16_bf16 v[32:47], v[96:99], v[232:235], v[80:95]
    v_mfma_f32_32x32x16_bf16 v[32:47], v[100:103], v[236:239], v[32:47]
    v_mfma_f32_32x32x16_bf16 v[64:79], v[104:107], v[48:51], v[64:79]
    v_mfma_f32_32x32x16_bf16 v[64:79], v[108:111], v[52:55], v[64:79]
    ds_read_b128 v[104:107], v28 offset:2048
    ds_read_b128 v[108:111], v28 offset:3072
    v_subrev_u32 v28, 4096, v28
    s_nop 6
    v_cndmask_b32 v32, v32, v26, s[64:65]
    v_cndmask_b32 v33, v33, v26, s[66:67]
    v_cndmask_b32 v34, v34, v26, s[68:69]
    v_cndmask_b32 v35, v35, v26, s[70:71]
    v_cndmask_b32 v36, v36, v26, s[72:73]
    v_cndmask_b32 v37, v37, v26, s[74:75]
    v_cndmask_b32 v38, v38, v26, s[76:77]
    v_cndmask_b32 v39, v39, v26, s[78:79]
    v_cndmask_b32 v40, v40, v26, s[80:81]
    v_cndmask_b32 v41, v41, v26, s[82:83]
    v_cndmask_b32 v42, v42, v26, s[84:85]
    v_cndmask_b32 v43, v43, v26, s[86:87]
    v_cndmask_b32 v44, v44, v26, s[88:89]
    v_cndmask_b32 v45, v45, v26, s[90:91]
    v_cndmask_b32 v46, v46, v26, s[92:93]
    v_cndmask_b32 v47, v47, v26, s[94:95]
    v_exp_f32 v32, v32
    v_exp_f32 v33, v33
    v_exp_f32 v34, v34
    v_exp_f32 v35, v35
    v_cvt_pk_bf16_f32 v48, v32, v33
    v_exp_f32 v36, v36
    v_exp_f32 v37, v37
    v_cvt_pk_bf16_f32 v49, v34, v35
    v_exp_f32 v38, v38
    v_exp_f32 v39, v39
    v_cvt_pk_bf16_f32 v50, v36, v37
    v_exp_f32 v40, v40
    v_exp_f32 v41, v41
    v_cvt_pk_bf16_f32 v51, v38, v39
    v_exp_f32 v42, v42
    v_exp_f32 v43, v43
    v_cvt_pk_bf16_f32 v52, v40, v41
    v_exp_f32 v44, v44
    v_exp_f32 v45, v45
    v_cvt_pk_bf16_f32 v53, v42, v43
    v_exp_f32 v46, v46
    v_exp_f32 v47, v47
    v_cvt_pk_bf16_f32 v54, v44, v45
    v_cvt_pk_bf16_f32 v55, v46, v47
    s_waitcnt lgkmcnt(1)
    v_mfma_f32_32x32x16_bf16 v[64:79], v[104:107], v[48:51], v[64:79]
    s_waitcnt lgkmcnt(0)
    v_mfma_f32_32x32x16_bf16 v[64:79], v[108:111], v[52:55], v[64:79]
    s_lshl_b32 s52, s6, 7
    s_lshl_b32 s49, s5, 2
    s_add_u32 s52, s52, s49
    s_add_u32 s52, s52, 8192
    s_mov_b32 s48, 1602224128
    s_nop 6
    v_mov_b32 v22, v76
    v_mov_b32 v23, v76
    s_nop 1
    v_permlane32_swap_b32 v22, v23
    v_cmp_nge_f32 vcc, s48, v23
    s_nop 1
    s_cbranch_vccnz att_fb_100
att_ok_99:
    s_nop 1
    v_rcp_f32 v22, v23
    s_nop 0
    v_pk_mul_f32 v[64:65], v[64:65], v[22:23] op_sel_hi:[1,0]
    v_pk_mul_f32 v[66:67], v[66:67], v[22:23] op_sel_hi:[1,0]
    v_pk_mul_f32 v[68:69], v[68:69], v[22:23] op_sel_hi:[1,0]
    v_pk_mul_f32 v[70:71], v[70:71], v[22:23] op_sel_hi:[1,0]
    v_pk_mul_f32 v[72:73], v[72:73], v[22:23] op_sel_hi:[1,0]
    v_pk_mul_f32 v[74:75], v[74:75], v[22:23] op_sel_hi:[1,0]
    v_pk_mul_f32 v[76:77], v[76:77], v[22:23] op_sel_hi:[1,0]
    v_pk_mul_f32 v[78:79], v[78:79], v[22:23] op_sel_hi:[1,0]
    v_cvt_pk_bf16_f32 v64, v64, v65
    v_cvt_pk_bf16_f32 v65, v66, v67
    v_cvt_pk_bf16_f32 v66, v68, v69
    v_cvt_pk_bf16_f32 v67, v70, v71
    v_cvt_pk_bf16_f32 v68, v72, v73
    v_cvt_pk_bf16_f32 v69, v74, v75
    v_cvt_pk_bf16_f32 v70, v76, v77
    v_cvt_pk_bf16_f32 v71, v78, v79
    buffer_store_dwordx4 v[64:67], v1, s[8:11], s100 offen sc1
    buffer_store_dwordx4 v[68:71], v1, s[8:11], s100 offen offset:1024 sc1
    v_mov_b32 v18, s44
    s_waitcnt vmcnt(0)
    s_mov_b64 exec, 1
    buffer_store_dword v18, v11, s[8:11], s52 offen sc1
    s_mov_b64 exec, -1
    s_cmp_eq_u32 s46, 0
    s_cbranch_scc1 p3_skip_107
    s_cmp_lg_u32 s7, 0
    s_cbranch_scc1 p3_l1_109
    v_mul_u32_u24 v22, 896, v3
    v_lshl_add_u32 v22, v4, 4, v22
    s_mul_i32 s48, s55, 28672
    s_lshl_b32 s49, s54, 6
    s_add_u32 s48, s48, s49
    buffer_load_dwordx4 v[96:99], v22, s[20:23], s48 offen
    buffer_load_dwordx4 v[100:103], v22, s[20:23], s48 offen offset:32
    s_branch p3_res_110
p3_l1_109:
    s_mul_i32 s48, s55, 28
    s_lshl_b32 s49, s54, 1
    s_add_u32 s48, s48, s49
    s_lshl_b32 s48, s48, 10
    s_add_u32 s48, s48, s42
    buffer_load_dwordx4 v[96:99], v1, s[8:11], s48 offen sc1
    buffer_load_dwordx4 v[100:103], v1, s[8:11], s48 offen offset:1024 sc1
p3_res_110:
    s_and_b32 s52, s55, -2
    s_lshl_b32 s52, s52, 7
    s_add_u32 s52, s52, 8192
    s_lshl_b32 s49, s3, 19
    s_add_u32 s49, s49, s38
    s_lshl_b32 s50, s55, 11
    s_add_u32 s50, s50, s49
    s_lshl_b32 s51, s57, 11
    s_add_u32 s51, s51, s49
    s_mul_i32 s48, s3, 12288
    s_add_u32 s48, s48, 86016
    v_add_u32 v25, s48, v1
    s_lshl_b32 s60, s55, 7
    s_lshl_b32 s49, s54, 2
    s_add_u32 s60, s60, s49
    s_add_u32 s60, s60, 16384
    s_barrier
    s_waitcnt vmcnt(1)
    v_lshlrev_b32 v32, 16, v96
    v_and_b32 v33, 0xffff0000, v96
    v_lshlrev_b32 v34, 16, v97
    v_and_b32 v35, 0xffff0000, v97
    v_lshlrev_b32 v36, 16, v98
    v_and_b32 v37, 0xffff0000, v98
    v_lshlrev_b32 v38, 16, v99
    v_and_b32 v39, 0xffff0000, v99
    s_waitcnt vmcnt(0)
    v_lshlrev_b32 v40, 16, v100
    v_and_b32 v41, 0xffff0000, v100
    v_lshlrev_b32 v42, 16, v101
    v_and_b32 v43, 0xffff0000, v101
    v_lshlrev_b32 v44, 16, v102
    v_and_b32 v45, 0xffff0000, v102
    v_lshlrev_b32 v46, 16, v103
    v_and_b32 v47, 0xffff0000, v103
    s_mov_b32 s47, 0
poll_111:
    buffer_load_dword v18, v10, s[8:11], s52 offen sc1
    s_add_u32 s47, s47, 1
    s_cmp_gt_u32 s47, 400000
    s_cbranch_scc1 polled_112
    s_waitcnt vmcnt(0)
    v_cmp_gt_u32 vcc, s44, v18
    s_nop 1
    s_cbranch_vccnz poll_111
polled_112:
    s_waitcnt vmcnt(0)
    buffer_load_dwordx4 v[224:227], v1, s[8:11], s51 offen offset:0 sc1
    buffer_load_dwordx4 v[228:231], v1, s[8:11], s51 offen offset:1024 sc1
    s_add_u32 s51, s51, 131072
    buffer_load_dwordx4 v[232:235], v1, s[8:11], s51 offen offset:0 sc1
    buffer_load_dwordx4 v[236:239], v1, s[8:11], s51 offen offset:1024 sc1
    s_add_u32 s51, s51, 131072
    buffer_load_dwordx4 v[240:243], v1, s[8:11], s51 offen offset:0 sc1
    buffer_load_dwordx4 v[244:247], v1, s[8:11], s51 offen offset:1024 sc1
    s_add_u32 s51, s51, 131072
    buffer_load_dwordx4 v[248:251], v1, s[8:11], s51 offen offset:0 sc1
    buffer_load_dwordx4 v[252:255], v1, s[8:11], s51 offen offset:1024 sc1
    buffer_load_dwordx4 v[192:195], v1, s[8:11], s50 offen offset:0 sc1
    buffer_load_dwordx4 v[196:199], v1, s[8:11], s50 offen offset:1024 sc1
    s_add_u32 s50, s50, 131072
    buffer_load_dwordx4 v[200:203], v1, s[8:11], s50 offen offset:0 sc1
    buffer_load_dwordx4 v[204:207], v1, s[8:11], s50 offen offset:1024 sc1
    s_add_u32 s50, s50, 131072
    buffer_load_dwordx4 v[208:211], v1, s[8:11], s50 offen offset:0 sc1
    buffer_load_dwordx4 v[212:215], v1, s[8:11], s50 offen offset:1024 sc1
    s_add_u32 s50, s50, 131072
    buffer_load_dwordx4 v[216:219], v1, s[8:11], s50 offen offset:0 sc1
    buffer_load_dwordx4 v[220:223], v1, s[8:11], s50 offen offset:1024 sc1
    s_waitcnt vmcnt(15)
    v_mfma_f32_32x32x16_bf16 v[64:79], v[128:131], v[224:227], 0
    v_mfma_f32_32x32x16_bf16 v[80:95], v[160:163], v[224:227], 0
    s_waitcnt vmcnt(14)
    v_mfma_f32_32x32x16_bf16 v[64:79], v[132:135], v[228:231], v[64:79]
    s_cmp_eq_u32 s7, 0
    s_cbranch_scc1 sk_113
    v_min_u32 v19, 55, v2
    v_lshlrev_b32 v19, 7, v19
    s_add_u32 s0, s61, 0
    buffer_load_dword v0, v19, s[8:11], s0 offen sc1
sk_113:
    v_mfma_f32_32x32x16_bf16 v[80:95], v[164:167], v[228:231], v[80:95]
    s_cmp_lg_u32 s7, 0
    s_cbranch_scc1 sk_114
    s_add_u32 s63, s29, 0
    buffer_load_dwordx4 a[0:3], v1, s[8:11], s63 offen offset:0
    buffer_load_dwordx4 a[4:7], v1, s[8:11], s63 offen offset:1024
sk_114:
    s_cmp_lg_u32 s7, 0
    s_cbranch_scc1 sk_115
    buffer_load_dwordx4 a[8:11], v1, s[8:11], s63 offen offset:2048
    buffer_load_dwordx4 a[12:15], v1, s[8:11], s63 offen offset:3072
sk_115:
    s_waitcnt vmcnt(13)
    v_mfma_f32_32x32x16_bf16 v[64:79], v[136:139], v[232:235], v[64:79]
    s_cmp_lg_u32 s7, 0
    s_cbranch_scc1 sk_116
    s_add_u32 s63, s29, 4096
    buffer_load_dwordx4 a[16:19], v1, s[8:11], s63 offen offset:0
    buffer_load_dwordx4 a[20:23], v1, s[8:11], s63 offen offset:1024
sk_116:
    s_cmp_lg_u32 s7, 0
    s_cbranch_scc1 sk_117
    buffer_load_dwordx4 a[24:27], v1, s[8:11], s63 offen offset:2048
    buffer_load_dwordx4 a[28:31], v1, s[8:11], s63 offen offset:3072
sk_117:
    v_mfma_f32_32x32x16_bf16 v[80:95], v[168:171], v[232:235], v[80:95]
    s_cmp_lg_u32 s7, 0
    s_cbranch_scc1 sk_118
    s_add_u32 s63, s29, 8192
    buffer_load_dwordx4 a[32:35], v1, s[8:11], s63 offen offset:0
    buffer_load_dwordx4 a[36:39], v1, s[8:11], s63 offen offset:1024
sk_118:
    s_cmp_lg_u32 s7, 0
    s_cbranch_scc1 sk_119
    buffer_load_dwordx4 a[40:43], v1, s[8:11], s63 offen offset:2048
    buffer_load_dwordx4 a[44:47], v1, s[8:11], s63 offen offset:3072
sk_119:
    s_waitcnt vmcnt(12)
    v_mfma_f32_32x32x16_bf16 v[64:79], v[140:143], v[236:239], v[64:79]
    s_cmp_lg_u32 s7, 0
    s_cbranch_scc1 sk_120
    s_add_u32 s63, s29, 12288
    buffer_load_dwordx4 a[48:51], v1, s[8:11], s63 offen offset:0
    buffer_load_dwordx4 a[52:55], v1, s[8:11], s63 offen offset:1024
sk_120:
    s_cmp_lg_u32 s7, 0
    s_cbranch_scc1 sk_121
    buffer_load_dwordx4 a[56:59], v1, s[8:11], s63 offen offset:2048
    buffer_load_dwordx4 a[60:63], v1, s[8:11], s63 offen offset:3072
sk_121:
    v_mfma_f32_32x32x16_bf16 v[80:95], v[172:175], v[236:239], v[80:95]
    s_cmp_lg_u32 s7, 0
    s_cbranch_scc1 sk_122
    s_add_u32 s63, s29, 16384
    buffer_load_dwordx4 a[64:67], v1, s[8:11], s63 offen offset:0
    buffer_load_dwordx4 a[68:71], v1, s[8:11], s63 offen offset:1024
sk_122:
    s_cmp_lg_u32 s7, 0
    s_cbranch_scc1 sk_123
    buffer_load_dwordx4 a[72:75], v1, s[8:11], s63 offen offset:2048
    buffer_load_dwordx4 a[76:79], v1, s[8:11], s63 offen offset:3072
sk_123:
    s_waitcnt vmcnt(11)
    v_mfma_f32_32x32x16_bf16 v[64:79], v[144:147], v[240:243], v[64:79]
    s_cmp_lg_u32 s7, 0
    s_cbranch_scc1 sk_124
    s_add_u32 s63, s29, 20480
    buffer_load_dwordx4 a[80:83], v1, s[8:11], s63 offen offset:0
    buffer_load_dwordx4 a[84:87], v1, s[8:11], s63 offen offset:1024
sk_124:
    s_cmp_lg_u32 s7, 0
    s_cbranch_scc1 sk_125
    buffer_load_dwordx4 a[88:91], v1, s[8:11], s63 offen offset:2048
    buffer_load_dwordx4 a[92:95], v1, s[8:11], s63 offen offset:3072
sk_125:
    v_mfma_f32_32x32x16_bf16 v[80:95], v[176:179], v[240:243], v[80:95]
    s_waitcnt vmcnt(10)
    v_mfma_f32_32x32x16_bf16 v[64:79], v[148:151], v[244:247], v[64:79]
    v_mfma_f32_32x32x16_bf16 v[80:95], v[180:183], v[244:247], v[80:95]
    s_waitcnt vmcnt(9)
    v_mfma_f32_32x32x16_bf16 v[64:79], v[152:155], v[248:251], v[64:79]
    v_mfma_f32_32x32x16_bf16 v[80:95], v[184:187], v[248:251], v[80:95]
    s_waitcnt vmcnt(8)
    v_mfma_f32_32x32x16_bf16 v[64:79], v[156:159], v[252:255], v[64:79]
    v_mfma_f32_32x32x16_bf16 v[80:95], v[188:191], v[252:255], v[80:95]
    s_waitcnt vmcnt(7)
    v_mfma_f32_32x32x16_bf16 v[48:63], v[160:163], v[192:195], 0
    s_waitcnt vmcnt(6)
    v_mfma_f32_32x32x16_bf16 v[48:63], v[164:167], v[196:199], v[48:63]
    s_waitcnt vmcnt(5)
    v_mfma_f32_32x32x16_bf16 v[48:63], v[168:171], v[200:203], v[48:63]
    s_xor_b32 s48, s3, 2
    s_mul_i32 s48, s48, 12288
    s_add_u32 s48, s48, 90112
    v_add_u32 v23, s48, v1
    s_nop 0
    ds_write_b128 v23, v[64:67] offset:0
    s_waitcnt vmcnt(4)
    v_mfma_f32_32x32x16_bf16 v[48:63], v[172:175], v[204:207], v[48:63]
    ds_write_b128 v23, v[68:71] offset:1024
    ds_write_b128 v23, v[72:75] offset:2048
    ds_write_b128 v23, v[76:79] offset:3072
    s_waitcnt vmcnt(3)
    v_mfma_f32_32x32x16_bf16 v[48:63], v[176:179], v[208:211], v[48:63]
    s_xor_b32 s48, s3, 3
    s_mul_i32 s48, s48, 12288
    s_add_u32 s48, s48, 94208
    v_add_u32 v24, s48, v1
    ds_write_b128 v24, v[80:83] offset:0
    s_waitcnt vmcnt(2)
    v_mfma_f32_32x32x16_bf16 v[48:63], v[180:183], v[212:215], v[48:63]
    ds_write_b128 v24, v[84:87] offset:1024
    ds_write_b128 v24, v[88:91] offset:2048
    ds_write_b128 v24, v[92:95] offset:3072
    s_waitcnt vmcnt(1)
    v_mfma_f32_32x32x16_bf16 v[48:63], v[184:187], v[216:219], v[48:63]
    s_waitcnt vmcnt(0)
    v_mfma_f32_32x32x16_bf16 v[48:63], v[188:191], v[220:223], v[48:63]
    v_mfma_f32_32x32x16_bf16 v[32:47], v[128:131], v[192:195], v[32:47]
    v_mfma_f32_32x32x16_bf16 v[32:47], v[132:135], v[196:199], v[32:47]
    v_mfma_f32_32x32x16_bf16 v[32:47], v[136:139], v[200:203], v[32:47]
    s_xor_b32 s48, s3, 1
    s_mul_i32 s48, s48, 12288
    s_add_u32 s48, s48, 86016
    v_add_u32 v22, s48, v1
    s_nop 4
    ds_write_b128 v22, v[48:51] offset:0
    v_mfma_f32_32x32x16_bf16 v[32:47], v[140:143], v[204:207], v[32:47]
    ds_write_b128 v22, v[52:55] offset:1024
    ds_write_b128 v22, v[56:59] offset:2048
    ds_write_b128 v22, v[60:63] offset:3072
    v_mfma_f32_32x32x16_bf16 v[32:47], v[144:147], v[208:211], v[32:47]
    v_mfma_f32_32x32x16_bf16 v[32:47], v[148:151], v[212:215], v[32:47]
    v_mfma_f32_32x32x16_bf16 v[32:47], v[152:155], v[216:219], v[32:47]
    v_mfma_f32_32x32x16_bf16 v[32:47], v[156:159], v[220:223], v[32:47]
    s_waitcnt lgkmcnt(0)
    s_barrier
    ds_read_b128 v[48:51], v25 offset:0
    ds_read_b128 v[64:67], v25 offset:4096
    ds_read_b128 v[80:83], v25 offset:8192
    ds_read_b128 v[52:55], v25 offset:1024
    ds_read_b128 v[68:71], v25 offset:5120
    ds_read_b128 v[84:87], v25 offset:9216
    ds_read_b128 v[56:59], v25 offset:2048
    ds_read_b128 v[72:75], v25 offset:6144
    ds_read_b128 v[88:91], v25 offset:10240
    ds_read_b128 v[60:63], v25 offset:3072
    ds_read_b128 v[76:79], v25 offset:7168
    ds_read_b128 v[92:95], v25 offset:11264
    s_waitcnt lgkmcnt(9)
    v_pk_add_f32 v[48:49], v[48:49], v[64:65]
    v_pk_add_f32 v[32:33], v[32:33], v[80:81]
    v_pk_add_f32 v[50:51], v[50:51], v[66:67]
    v_pk_add_f32 v[34:35], v[34:35], v[82:83]
    v_pk_add_f32 v[32:33], v[32:33], v[48:49]
    v_pk_add_f32 v[34:35], v[34:35], v[50:51]
    v_cvt_pk_bf16_f32 v96, v32, v33
    v_cvt_pk_bf16_f32 v97, v34, v35
    s_waitcnt lgkmcnt(6)
    v_pk_add_f32 v[52:53], v[52:53], v[68:69]
    v_pk_add_f32 v[36:37], v[36:37], v[84:85]
    v_pk_add_f32 v[54:55], v[54:55], v[70:71]
    v_pk_add_f32 v[38:39], v[38:39], v[86:87]
    v_pk_add_f32 v[36:37], v[36:37], v[52:53]
    v_pk_add_f32 v[38:39], v[38:39], v[54:55]
    v_cvt_pk_bf16_f32 v98, v36, v37
    v_cvt_pk_bf16_f32 v99, v38, v39
    buffer_store_dwordx4 v[96:99], v1, s[8:11], s101 offen sc1
    s_waitcnt lgkmcnt(3)
    v_pk_add_f32 v[56:57], v[56:57], v[72:73]
    v_pk_add_f32 v[40:41], v[40:41], v[88:89]
    v_pk_add_f32 v[58:59], v[58:59], v[74:75]
    v_pk_add_f32 v[42:43], v[42:43], v[90:91]
    v_pk_add_f32 v[40:41], v[40:41], v[56:57]
    v_pk_add_f32 v[42:43], v[42:43], v[58:59]
    v_cvt_pk_bf16_f32 v100, v40, v41
    v_cvt_pk_bf16_f32 v101, v42, v43
    s_waitcnt lgkmcnt(0)
    v_pk_add_f32 v[60:61], v[60:61], v[76:77]
    v_pk_add_f32 v[44:45], v[44:45], v[92:93]
    v_pk_add_f32 v[62:63], v[62:63], v[78:79]
    v_pk_add_f32 v[46:47], v[46:47], v[94:95]
    v_pk_add_f32 v[44:45], v[44:45], v[60:61]
    v_pk_add_f32 v[46:47], v[46:47], v[62:63]
    v_cvt_pk_bf16_f32 v102, v44, v45
    v_cvt_pk_bf16_f32 v103, v46, v47
    buffer_store_dwordx4 v[100:103], v1, s[8:11], s101 offen offset:1024 sc1
    v_mov_b32 v22, 0
    v_mov_b32 v23, 0
    v_dot2_f32_bf16 v22, v96, v8, v22
    v_dot2_f32_bf16 v23, v96, v96, v23
    v_dot2_f32_bf16 v22, v97, v8, v22
    v_dot2_f32_bf16 v23, v97, v97, v23
    v_dot2_f32_bf16 v22, v98, v8, v22
    v_dot2_f32_bf16 v23, v98, v98, v23
    v_dot2_f32_bf16 v22, v99, v8, v22
    v_dot2_f32_bf16 v23, v99, v99, v23
    v_dot2_f32_bf16 v22, v100, v8, v22
    v_dot2_f32_bf16 v23, v100, v100, v23
    v_dot2_f32_bf16 v22, v101, v8, v22
    v_dot2_f32_bf16 v23, v101, v101, v23
    v_dot2_f32_bf16 v22, v102, v8, v22
    v_dot2_f32_bf16 v23, v102, v102, v23
    v_dot2_f32_bf16 v22, v103, v8, v22
    v_dot2_f32_bf16 v23, v103, v103, v23
    s_nop 2
    v_permlane32_swap_b32 v22, v23
    v_add_f32 v22, v22, v23
    buffer_store_dword v22, v5, s[8:11], s1 offen sc1
    v_mov_b32 v18, s44
    s_waitcnt vmcnt(0)
    s_mov_b64 exec, 1
    buffer_store_dword v18, v11, s[8:11], s60 offen sc1
    s_mov_b64 exec, -1
p3_join_108:
    s_lshl_b32 s52, s6, 7
    s_add_u32 s52, s52, 16384
    s_mul_i32 s51, s6, 28672
    s_add_u32 s51, s51, s39
    s_waitcnt vmcnt(0)
    s_cmp_lg_u32 s7, 0
    s_cbranch_scc1 sk_127
    v_add_f32 v112, v112, v113
    v_add_f32 v114, v114, v115
    v_add_f32 v112, v112, v114
    v_cvt_pk_bf16_f32 v23, v112, v112
    v_and_b32 v23, 0xffff0000, v23
    v_sub_f32 v112, v112, v23
    v_cvt_pk_bf16_f32 v24, v112, v112
    v_and_b32 v24, 0xffff0000, v24
    v_sub_f32 v112, v112, v24
    v_lshrrev_b32 v23, 16, v23
    v_or_b32 v116, v23, v24
    v_cvt_pk_bf16_f32 v117, v112, 0
    v_mov_b32 v118, 0
    v_mov_b32 v119, 0
    v_mov_b32 v120, 0
    v_mov_b32 v121, 0
    v_mov_b32 v122, 0
    v_mov_b32 v123, 0
    s_lshl_b32 s48, s3, 10
    s_add_u32 s48, s48, 144384
    v_lshlrev_b32 v22, 4, v3
    v_lshl_add_u32 v22, v4, 12, v22
    v_add_u32 v22, s48, v22
    ds_write_b128 v22, v[116:119]
    ds_write_b128 v22, v[120:123] offset:512
    s_waitcnt lgkmcnt(0)
sk_127:
    s_barrier
    ds_read_b128 v[192:195], v1 offset:0
    ds_read_b128 v[196:199], v1 offset:28672
    ds_read_b128 v[200:203], v1 offset:1024
    ds_read_b128 v[204:207], v1 offset:29696
    ds_read_b128 v[208:211], v1 offset:2048
    ds_read_b128 v[212:215], v1 offset:30720
    s_mov_b32 s47, 0
poll_128:
    buffer_load_dword v18, v9, s[8:11], s52 offen sc1
    s_add_u32 s47, s47, 1
    s_cmp_gt_u32 s47, 400000
    s_cbranch_scc1 polled_129
    s_waitcnt vmcnt(0)
    v_cmp_gt_u32 vcc, s44, v18
    s_nop 1
    s_cbranch_vccnz poll_128
polled_129:
    s_waitcnt vmcnt(0)
    s_add_u32 s50, s51, 0
    buffer_load_dwordx4 v[32:35], v1, s[8:11], s50 offen offset:0 sc1
    buffer_load_dwordx4 v[36:39], v1, s[8:11], s50 offen offset:1024 sc1
    buffer_load_dwordx4 v[40:43], v1, s[8:11], s50 offen offset:2048 sc1
    buffer_load_dwordx4 v[44:47], v1, s[8:11], s50 offen offset:3072 sc1
    s_mul_i32 s48, s6, 3584
    s_add_u32 s48, s48, s40
    buffer_load_dwordx2 v[224:225], v6, s[8:11], s48 offen offset:0 sc1
    buffer_load_dwordx2 v[226:227], v6, s[8:11], s48 offen offset:256 sc1
    buffer_load_dwordx2 v[228:229], v6, s[8:11], s48 offen offset:512 sc1
    buffer_load_dwordx2 v[230:231], v6, s[8:11], s48 offen offset:768 sc1
    buffer_load_dwordx2 v[232:233], v6, s[8:11], s48 offen offset:1024 sc1
    buffer_load_dwordx2 v[234:235], v6, s[8:11], s48 offen offset:1280 sc1
    buffer_load_dwordx2 v[236:237], v6, s[8:11], s48 offen offset:1536 sc1
    s_add_u32 s50, s51, 4096
    buffer_load_dwordx4 v[48:51], v1, s[8:11], s50 offen offset:0 sc1
    buffer_load_dwordx4 v[52:55], v1, s[8:11], s50 offen offset:1024 sc1
    buffer_load_dwordx4 v[56:59], v1, s[8:11], s50 offen offset:2048 sc1
    buffer_load_dwordx4 v[60:63], v1, s[8:11], s50 offen offset:3072 sc1
    s_add_u32 s50, s51, 8192
    buffer_load_dwordx4 v[64:67], v1, s[8:11], s50 offen offset:0 sc1
    buffer_load_dwordx4 v[68:71], v1, s[8:11], s50 offen offset:1024 sc1
    ds_read_b128 v[216:219], v1 offset:3072
    buffer_load_dwordx4 v[72:75], v1, s[8:11], s50 offen offset:2048 sc1
    s_waitcnt lgkmcnt(5)
    s_waitcnt vmcnt(17)
    v_mfma_f32_32x32x16_bf16 v[144:159], v[192:195], v[32:35], 0
    ds_read_b128 v[220:223], v1 offset:31744
    v_mfma_f32_32x32x16_bf16 v[160:175], v[196:199], v[32:35], 0
    ds_read_b128 v[192:195], v1 offset:4096
    buffer_load_dwordx4 v[76:79], v1, s[8:11], s50 offen offset:3072 sc1
    s_waitcnt lgkmcnt(5)
    s_waitcnt vmcnt(17)
    v_mfma_f32_32x32x16_bf16 v[144:159], v[200:203], v[36:39], v[144:159]
    ds_read_b128 v[196:199], v1 offset:32768
    v_mfma_f32_32x32x16_bf16 v[160:175], v[204:207], v[36:39], v[160:175]
    ds_read_b128 v[200:203], v1 offset:5120
    s_add_u32 s50, s51, 12288
    buffer_load_dwordx4 v[80:83], v1, s[8:11], s50 offen offset:0 sc1
    s_waitcnt lgkmcnt(5)
    s_waitcnt vmcnt(17)
    v_mfma_f32_32x32x16_bf16 v[144:159], v[208:211], v[40:43], v[144:159]
    ds_read_b128 v[204:207], v1 offset:33792
    v_mfma_f32_32x32x16_bf16 v[160:175], v[212:215], v[40:43], v[160:175]
    ds_read_b128 v[208:211], v1 offset:6144
    buffer_load_dwordx4 v[84:87], v1, s[8:11], s50 offen offset:1024 sc1
    s_waitcnt lgkmcnt(5)
    s_waitcnt vmcnt(17)
    v_mfma_f32_32x32x16_bf16 v[144:159], v[216:219], v[44:47], v[144:159]
    s_waitcnt vmcnt(15)
    v_add_f32 v224, v224, v226
    v_add_f32 v225, v225, v227
    s_waitcnt vmcnt(14)
    v_add_f32 v224, v224, v228
    ds_read_b128 v[212:215], v1 offset:34816
    v_mfma_f32_32x32x16_bf16 v[160:175], v[220:223], v[44:47], v[160:175]
    v_add_f32 v225, v225, v229
    s_waitcnt vmcnt(13)
    v_add_f32 v224, v224, v230
    ds_read_b128 v[216:219], v1 offset:7168
    buffer_load_dwordx4 v[88:91], v1, s[8:11], s50 offen offset:2048 sc1
    s_waitcnt lgkmcnt(5)
    s_waitcnt vmcnt(10)
    v_mfma_f32_32x32x16_bf16 v[144:159], v[192:195], v[48:51], v[144:159]
    v_add_f32 v225, v225, v231
    v_add_f32 v224, v224, v232
    v_add_f32 v225, v225, v233
    v_add_f32 v224, v224, v234
    v_add_f32 v225, v225, v235
    ds_read_b128 v[220:223], v1 offset:35840
    v_mfma_f32_32x32x16_bf16 v[160:175], v[196:199], v[48:51], v[160:175]
    v_add_f32 v224, v224, v236
    v_add_f32 v225, v225, v237
    ds_read_b128 v[192:195], v1 offset:8192
    buffer_load_dwordx4 v[92:95], v1, s[8:11], s50 offen offset:3072 sc1
    s_waitcnt lgkmcnt(5)
    s_waitcnt vmcnt(10)
    v_mfma_f32_32x32x16_bf16 v[144:159], v[200:203], v[52:55], v[144:159]
    v_mov_b32 v22, v224
    v_mov_b32 v23, v225
    s_nop 0
    v_permlane32_swap_b32 v224, v22
    v_permlane32_swap_b32 v225, v23
    ds_read_b128 v[196:199], v1 offset:36864
    v_mfma_f32_32x32x16_bf16 v[160:175], v[204:207], v[52:55], v[160:175]
    v_add_f32 v224, v224, v22
    ds_read_b128 v[200:203], v1 offset:9216
    s_add_u32 s50, s51, 16384
    buffer_load_dwordx4 v[96:99], v1, s[8:11], s50 offen offset:0 sc1
    s_waitcnt lgkmcnt(5)
    s_waitcnt vmcnt(10)
    v_mfma_f32_32x32x16_bf16 v[144:159], v[208:211], v[56:59], v[144:159]
    v_add_f32 v225, v225, v23
    v_mul_f32 v224, 3138537765, v224
    v_mul_f32 v225, 991054117, v225
    v_fma_f32 v225, -v224, v224, v225
    v_max_f32 v225, 0, v225
    ds_read_b128 v[204:207], v1 offset:37888
    v_mfma_f32_32x32x16_bf16 v[160:175], v[212:215], v[56:59], v[160:175]
    v_cvt_pk_bf16_f32 v20, v224, v224
    v_cvt_pk_bf16_f32 v23, v225, v225
    ds_read_b128 v[208:211], v1 offset:10240
    buffer_load_dwordx4 v[100:103], v1, s[8:11], s50 offen offset:1024 sc1
    s_waitcnt lgkmcnt(5)
    s_waitcnt vmcnt(10)
    v_mfma_f32_32x32x16_bf16 v[144:159], v[216:219], v[60:63], v[144:159]
    v_and_b32 v23, 0xffff0000, v23
    v_add_f32 v23, 925353388, v23
    v_cvt_pk_bf16_f32 v23, v23, v23
    v_and_b32 v23, 0xffff0000, v23
    ds_read_b128 v[212:215], v1 offset:38912
    v_mfma_f32_32x32x16_bf16 v[160:175], v[220:223], v[60:63], v[160:175]
    v_sqrt_f32 v23, v23
    ds_read_b128 v[216:219], v1 offset:11264
    buffer_load_dwordx4 v[104:107], v1, s[8:11], s50 offen offset:2048 sc1
    s_waitcnt lgkmcnt(5)
    s_waitcnt vmcnt(10)
    v_mfma_f32_32x32x16_bf16 v[144:159], v[192:195], v[64:67], v[144:159]
    v_cvt_pk_bf16_f32 v23, v23, v23
    v_and_b32 v23, 0xffff0000, v23
    v_rcp_f32 v21, v23
    v_mov_b32 v28, v20
    ds_read_b128 v[220:223], v1 offset:39936
    v_mfma_f32_32x32x16_bf16 v[160:175], v[196:199], v[64:67], v[160:175]
    v_mov_b32 v29, v20
    v_mov_b32 v30, v20
    ds_read_b128 v[192:195], v1 offset:12288
    buffer_load_dwordx4 v[108:111], v1, s[8:11], s50 offen offset:3072 sc1
    s_waitcnt lgkmcnt(5)
    s_waitcnt vmcnt(10)
    v_mfma_f32_32x32x16_bf16 v[144:159], v[200:203], v[68:71], v[144:159]
    v_mov_b32 v31, v20
    v_mul_f32 v17, 3216550459, v21
    s_lshl_b32 s33, s6, 7
    s_lshl_b32 s49, s5, 2
    s_add_u32 s33, s33, s49
    ds_read_b128 v[196:199], v1 offset:40960
    v_mfma_f32_32x32x16_bf16 v[160:175], v[204:207], v[68:71], v[160:175]
    s_add_u32 s33, s33, 24576
    ds_read_b128 v[200:203], v1 offset:13312
    s_add_u32 s50, s51, 20480
    buffer_load_dwordx4 v[112:115], v1, s[8:11], s50 offen offset:0 sc1
    s_waitcnt lgkmcnt(5)
    s_waitcnt vmcnt(10)
    v_mfma_f32_32x32x16_bf16 v[144:159], v[208:211], v[72:75], v[144:159]
    s_and_b32 s34, s55, -2
    s_lshl_b32 s34, s34, 7
    s_add_u32 s34, s34, 24576
    s_mul_i32 s49, s3, 28672
    s_add_u32 s49, s49, s41
    ds_read_b128 v[204:207], v1 offset:41984
    v_mfma_f32_32x32x16_bf16 v[160:175], v[212:215], v[72:75], v[160:175]
    s_mul_i32 s35, s55, 114688
    s_add_u32 s35, s35, s49
    ds_read_b128 v[208:211], v1 offset:14336
    buffer_load_dwordx4 v[116:119], v1, s[8:11], s50 offen offset:1024 sc1
    s_waitcnt lgkmcnt(5)
    s_waitcnt vmcnt(10)
    v_mfma_f32_32x32x16_bf16 v[144:159], v[216:219], v[76:79], v[144:159]
    s_mul_i32 s36, s57, 114688
    s_add_u32 s36, s36, s49
    ds_read_b128 v[212:215], v1 offset:43008
    v_mfma_f32_32x32x16_bf16 v[160:175], v[220:223], v[76:79], v[160:175]
    ds_read_b128 v[216:219], v1 offset:15360
    buffer_load_dwordx4 v[120:123], v1, s[8:11], s50 offen offset:2048 sc1
    s_waitcnt lgkmcnt(5)
    s_waitcnt vmcnt(10)
    v_mfma_f32_32x32x16_bf16 v[144:159], v[192:195], v[80:83], v[144:159]
    s_mul_i32 s101, s55, 28
    s_lshl_b32 s49, s54, 1
    s_add_u32 s101, s101, s49
    s_lshl_b32 s101, s101, 10
    s_add_u32 s101, s101, s42
    s_mul_i32 s1, s55, 14
    s_add_u32 s1, s1, s54
    s_lshl_b32 s1, s1, 8
    s_add_u32 s1, s1, s43
    ds_read_b128 v[220:223], v1 offset:44032
    v_mfma_f32_32x32x16_bf16 v[160:175], v[196:199], v[80:83], v[160:175]
    ds_read_b128 v[192:195], v1 offset:16384
    buffer_load_dwordx4 v[124:127], v1, s[8:11], s50 offen offset:3072 sc1
    s_waitcnt lgkmcnt(5)
    s_waitcnt vmcnt(10)
    v_mfma_f32_32x32x16_bf16 v[144:159], v[200:203], v[84:87], v[144:159]
    ds_read_b128 v[196:199], v1 offset:45056
    v_mfma_f32_32x32x16_bf16 v[160:175], v[204:207], v[84:87], v[160:175]
    ds_read_b128 v[200:203], v1 offset:17408
    s_add_u32 s50, s51, 24576
    buffer_load_dwordx4 v[128:131], v1, s[8:11], s50 offen offset:0 sc1
    s_waitcnt lgkmcnt(5)
    s_waitcnt vmcnt(10)
    v_mfma_f32_32x32x16_bf16 v[144:159], v[208:211], v[88:91], v[144:159]
    ds_read_b128 v[204:207], v1 offset:46080
    v_mfma_f32_32x32x16_bf16 v[160:175], v[212:215], v[88:91], v[160:175]
    ds_read_b128 v[208:211], v1 offset:18432
    buffer_load_dwordx4 v[132:135], v1, s[8:11], s50 offen offset:1024 sc1
    s_waitcnt lgkmcnt(5)
    s_waitcnt vmcnt(10)
    v_mfma_f32_32x32x16_bf16 v[144:159], v[216:219], v[92:95], v[144:159]
    ds_read_b128 v[212:215], v1 offset:47104
    v_mfma_f32_32x32x16_bf16 v[160:175], v[220:223], v[92:95], v[160:175]
    ds_read_b128 v[216:219], v1 offset:19456
    buffer_load_dwordx4 v[136:139], v1, s[8:11], s50 offen offset:2048 sc1
    s_waitcnt lgkmcnt(5)
    s_waitcnt vmcnt(10)
    v_mfma_f32_32x32x16_bf16 v[144:159], v[192:195], v[96:99], v[144:159]
    ds_read_b128 v[220:223], v1 offset:48128
    v_mfma_f32_32x32x16_bf16 v[160:175], v[196:199], v[96:99], v[160:175]
    ds_read_b128 v[192:195], v1 offset:20480
    buffer_load_dwordx4 v[140:143], v1, s[8:11], s50 offen offset:3072 sc1
    s_waitcnt lgkmcnt(5)
    s_waitcnt vmcnt(10)
    v_mfma_f32_32x32x16_bf16 v[144:159], v[200:203], v[100:103], v[144:159]
    ds_read_b128 v[196:199], v1 offset:49152
    v_mfma_f32_32x32x16_bf16 v[160:175], v[204:207], v[100:103], v[160:175]
    ds_read_b128 v[200:203], v1 offset:21504
    s_waitcnt lgkmcnt(5)
    s_waitcnt vmcnt(9)
    v_mfma_f32_32x32x16_bf16 v[144:159], v[208:211], v[104:107], v[144:159]
    s_add_u32 m0, s26, 86016
    s_add_u32 s24, s25, 86016
    buffer_load_dwordx4 v1, s[8:11], s24 offen offset:0 lds
    ds_read_b128 v[204:207], v1 offset:50176
    v_mfma_f32_32x32x16_bf16 v[160:175], v[212:215], v[104:107], v[160:175]
    buffer_load_dwordx4 v1, s[8:11], s24 offen offset:1024 lds
    ds_read_b128 v[208:211], v1 offset:22528
    s_waitcnt lgkmcnt(5)
    s_waitcnt vmcnt(10)
    v_mfma_f32_32x32x16_bf16 v[144:159], v[216:219], v[108:111], v[144:159]
    ds_read_b128 v[212:215], v1 offset:51200
    v_mfma_f32_32x32x16_bf16 v[160:175], v[220:223], v[108:111], v[160:175]
    buffer_load_dwordx4 v1, s[8:11], s24 offen offset:2048 lds
    ds_read_b128 v[216:219], v1 offset:23552
    s_waitcnt lgkmcnt(5)
    s_waitcnt vmcnt(10)
    v_mfma_f32_32x32x16_bf16 v[144:159], v[192:195], v[112:115], v[144:159]
    buffer_load_dwordx4 v1, s[8:11], s24 offen offset:3072 lds
    ds_read_b128 v[220:223], v1 offset:52224
    v_mfma_f32_32x32x16_bf16 v[160:175], v[196:199], v[112:115], v[160:175]
    ds_read_b128 v[192:195], v1 offset:24576
    s_waitcnt lgkmcnt(5)
    s_waitcnt vmcnt(10)
    v_mfma_f32_32x32x16_bf16 v[144:159], v[200:203], v[116:119], v[144:159]
    s_add_u32 m0, s26, 90112
    s_add_u32 s24, s25, 90112
    buffer_load_dwordx4 v1, s[8:11], s24 offen offset:0 lds
    ds_read_b128 v[196:199], v1 offset:53248
    v_mfma_f32_32x32x16_bf16 v[160:175], v[204:207], v[116:119], v[160:175]
    buffer_load_dwordx4 v1, s[8:11], s24 offen offset:1024 lds
    ds_read_b128 v[200:203], v1 offset:25600
    s_waitcnt lgkmcnt(5)
    s_waitcnt vmcnt(11)
    v_mfma_f32_32x32x16_bf16 v[144:159], v[208:211], v[120:123], v[144:159]
    ds_read_b128 v[204:207], v1 offset:54272
    v_mfma_f32_32x32x16_bf16 v[160:175], v[212:215], v[120:123], v[160:175]
    buffer_load_dwordx4 v1, s[8:11], s24 offen offset:2048 lds
    ds_read_b128 v[208:211], v1 offset:26624
    s_waitcnt lgkmcnt(5)
    s_waitcnt vmcnt(11)
    v_mfma_f32_32x32x16_bf16 v[144:159], v[216:219], v[124:127], v[144:159]
    s_add_u32 m0, s26, 114688
    s_add_u32 s24, s25, 114688
    buffer_load_dwordx4 v1, s[8:11], s24 offen offset:0 lds
    ds_read_b128 v[212:215], v1 offset:55296
    v_mfma_f32_32x32x16_bf16 v[160:175], v[220:223], v[124:127], v[160:175]
    ds_read_b128 v[216:219], v1 offset:27648
    s_waitcnt lgkmcnt(5)
    s_waitcnt vmcnt(11)
    v_mfma_f32_32x32x16_bf16 v[144:159], v[192:195], v[128:131], v[144:159]
    buffer_load_dwordx4 v1, s[8:11], s24 offen offset:1024 lds
    ds_read_b128 v[220:223], v1 offset:56320
    v_mfma_f32_32x32x16_bf16 v[160:175], v[196:199], v[128:131], v[160:175]
    buffer_load_dwordx4 v1, s[8:11], s24 offen offset:2048 lds
    ds_read_b128 v[192:195], v16 offset:1024
    s_waitcnt lgkmcnt(5)
    s_waitcnt vmcnt(12)
    v_mfma_f32_32x32x16_bf16 v[144:159], v[200:203], v[132:135], v[144:159]
    ds_read_b128 v[196:199], v16 offset:2048
    v_mfma_f32_32x32x16_bf16 v[160:175], v[204:207], v[132:135], v[160:175]
    buffer_load_dwordx4 v1, s[8:11], s24 offen offset:3072 lds
    ds_read_b128 v[200:203], v14 offset:0
    s_waitcnt lgkmcnt(5)
    s_waitcnt vmcnt(12)
    v_mfma_f32_32x32x16_bf16 v[144:159], v[208:211], v[136:139], v[144:159]
    s_add_u32 m0, s26, 118784
    s_add_u32 s24, s25, 118784
    buffer_load_dwordx4 v1, s[8:11], s24 offen offset:0 lds
    ds_read_b128 v[204:207], v14 offset:1024
    v_mfma_f32_32x32x16_bf16 v[160:175], v[212:215], v[136:139], v[160:175]
    ds_read_b128 v[208:211], v14 offset:2048
    s_waitcnt lgkmcnt(5)
    s_waitcnt vmcnt(12)
    v_mfma_f32_32x32x16_bf16 v[144:159], v[216:219], v[140:143], v[144:159]
    buffer_load_dwordx4 v1, s[8:11], s24 offen offset:1024 lds
    ds_read_b128 v[212:215], v14 offset:3072
    v_mfma_f32_32x32x16_bf16 v[160:175], v[220:223], v[140:143], v[160:175]
    buffer_load_dwordx4 v1, s[8:11], s24 offen offset:2048 lds
    ds_read_b128 v[216:219], v14 offset:4096
    s_waitcnt lgkmcnt(5)
    v_mfma_f32_32x32x16_bf16 v[144:159], v[192:195], v[28:31], v[144:159]
    ds_read_b128 v[220:223], v14 offset:5120
    v_mfma_f32_32x32x16_bf16 v[160:175], v[196:199], v[28:31], v[160:175]
    ds_read_b128 v[192:195], v14 offset:6144
    s_waitcnt lgkmcnt(5)
    v_mfma_f32_32x32x16_bf16 v[176:191], v[200:203], v[32:35], 0
    ds_read_b128 v[196:199], v14 offset:7168
    v_mfma_f32_32x32x16_bf16 v[176:191], v[204:207], v[36:39], v[176:191]
    s_nop 4
    v_mul_f32 v224, v17, v144
    ds_read_b128 v[200:203], v14 offset:8192
    s_waitcnt lgkmcnt(5)
    v_mfma_f32_32x32x16_bf16 v[176:191], v[208:211], v[40:43], v[176:191]
    v_mul_f32 v225, v17, v145
    v_mul_f32 v226, v17, v146
    v_mul_f32 v227, v17, v147
    v_mul_f32 v228, v17, v148
    v_mul_f32 v229, v17, v149
    ds_read_b128 v[204:207], v14 offset:9216
    v_mfma_f32_32x32x16_bf16 v[176:191], v[212:215], v[44:47], v[176:191]
    v_mul_f32 v230, v17, v150
    v_mul_f32 v231, v17, v151
    v_exp_f32 v224, v224
    ds_read_b128 v[208:211], v14 offset:10240
    s_waitcnt lgkmcnt(5)
    v_mfma_f32_32x32x16_bf16 v[176:191], v[216:219], v[48:51], v[176:191]
    v_mul_f32 v144, v144, v152
    v_exp_f32 v225, v225
    v_mul_f32 v145, v145, v153
    ds_read_b128 v[212:215], v14 offset:11264
    v_mfma_f32_32x32x16_bf16 v[176:191], v[220:223], v[52:55], v[176:191]
    v_exp_f32 v226, v226
    v_mul_f32 v146, v146, v154
    ds_read_b128 v[216:219], v14 offset:12288
    s_waitcnt lgkmcnt(5)
    v_mfma_f32_32x32x16_bf16 v[176:191], v[192:195], v[56:59], v[176:191]
    v_exp_f32 v227, v227
    v_mul_f32 v147, v147, v155
    v_exp_f32 v228, v228
    ds_read_b128 v[220:223], v14 offset:13312
    v_mfma_f32_32x32x16_bf16 v[176:191], v[196:199], v[60:63], v[176:191]
    v_mul_f32 v148, v148, v156
    v_exp_f32 v229, v229
    v_mul_f32 v149, v149, v157
    ds_read_b128 v[192:195], v14 offset:14336
    s_waitcnt lgkmcnt(5)
    v_mfma_f32_32x32x16_bf16 v[176:191], v[200:203], v[64:67], v[176:191]
    v_exp_f32 v230, v230
    v_mul_f32 v150, v150, v158
    v_exp_f32 v231, v231
    ds_read_b128 v[196:199], v14 offset:15360
    v_mfma_f32_32x32x16_bf16 v[176:191], v[204:207], v[68:71], v[176:191]
    v_mul_f32 v151, v151, v159
    v_add_f32 v224, 1.0, v224
    v_add_f32 v225, 1.0, v225
    v_add_f32 v226, 1.0, v226
    ds_read_b128 v[200:203], v14 offset:16384
    s_waitcnt lgkmcnt(5)
    v_mfma_f32_32x32x16_bf16 v[176:191], v[208:211], v[72:75], v[176:191]
    v_add_f32 v227, 1.0, v227
    v_add_f32 v228, 1.0, v228
    v_add_f32 v229, 1.0, v229
    v_add_f32 v230, 1.0, v230
    v_add_f32 v231, 1.0, v231
    ds_read_b128 v[204:207], v14 offset:17408
    v_mfma_f32_32x32x16_bf16 v[176:191], v[212:215], v[76:79], v[176:191]
    v_rcp_f32 v224, v224
    v_rcp_f32 v225, v225
    ds_read_b128 v[208:211], v14 offset:18432
    s_waitcnt lgkmcnt(5)
    v_mfma_f32_32x32x16_bf16 v[176:191], v[216:219], v[80:83], v[176:191]
    v_mul_f32 v144, v144, v224
    v_rcp_f32 v226, v226
    v_mul_f32 v145, v145, v225
    ds_read_b128 v[212:215], v14 offset:19456
    v_mfma_f32_32x32x16_bf16 v[176:191], v[220:223], v[84:87], v[176:191]
    v_rcp_f32 v227, v227
    v_mul_f32 v146, v146, v226
    ds_read_b128 v[216:219], v14 offset:20480
    s_waitcnt lgkmcnt(5)
    v_mfma_f32_32x32x16_bf16 v[176:191], v[192:195], v[88:91], v[176:191]
    v_rcp_f32 v228, v228
    v_mul_f32 v147, v147, v227
    v_rcp_f32 v229, v229
    ds_read_b128 v[220:223], v14 offset:21504
    v_mfma_f32_32x32x16_bf16 v[176:191], v[196:199], v[92:95], v[176:191]
    v_mul_f32 v148, v148, v228
    v_rcp_f32 v230, v230
    v_mul_f32 v149, v149, v229
    ds_read_b128 v[192:195], v14 offset:22528
    s_waitcnt lgkmcnt(5)
    v_mfma_f32_32x32x16_bf16 v[176:191], v[200:203], v[96:99], v[176:191]
    v_rcp_f32 v231, v231
    v_mul_f32 v150, v150, v230
    v_mul_f32 v151, v151, v231
    v_cvt_pk_bf16_f32 v240, v144, v145
    ds_read_b128 v[196:199], v14 offset:23552
    v_mfma_f32_32x32x16_bf16 v[176:191], v[204:207], v[100:103], v[176:191]
    v_cvt_pk_bf16_f32 v241, v146, v147
    v_cvt_pk_bf16_f32 v242, v148, v149
    v_cvt_pk_bf16_f32 v243, v150, v151
    ds_read_b128 v[200:203], v14 offset:24576
    s_waitcnt lgkmcnt(5)
    v_mfma_f32_32x32x16_bf16 v[176:191], v[208:211], v[104:107], v[176:191]
    buffer_store_dwordx4 v[240:243], v1, s[8:11], s61 offen offset:0 sc1
    v_mul_f32 v232, v17, v160
    ds_read_b128 v[204:207], v14 offset:25600
    v_mfma_f32_32x32x16_bf16 v[176:191], v[212:215], v[108:111], v[176:191]
    v_mul_f32 v233, v17, v161
    v_mul_f32 v234, v17, v162
    v_mul_f32 v235, v17, v163
    v_mul_f32 v236, v17, v164
    ds_read_b128 v[208:211], v14 offset:26624
    s_waitcnt lgkmcnt(5)
    v_mfma_f32_32x32x16_bf16 v[176:191], v[216:219], v[112:115], v[176:191]
    v_mul_f32 v237, v17, v165
    v_mul_f32 v238, v17, v166
    v_mul_f32 v239, v17, v167
    v_exp_f32 v232, v232
    ds_read_b128 v[212:215], v14 offset:27648
    v_mfma_f32_32x32x16_bf16 v[176:191], v[220:223], v[116:119], v[176:191]
    v_mul_f32 v160, v160, v168
    v_exp_f32 v233, v233
    v_mul_f32 v161, v161, v169
    ds_read_b128 v[216:219], v16 offset:3072
    s_waitcnt lgkmcnt(5)
    v_mfma_f32_32x32x16_bf16 v[176:191], v[192:195], v[120:123], v[176:191]
    s_waitcnt vmcnt(1)
    s_waitcnt lgkmcnt(0)
    s_barrier
    ds_read_b128 v[220:223], v14 offset:28672
    v_mfma_f32_32x32x16_bf16 v[176:191], v[196:199], v[124:127], v[176:191]
    v_exp_f32 v234, v234
    v_mul_f32 v162, v162, v170
    ds_read_b128 v[192:195], v14 offset:29696
    v_mfma_f32_32x32x16_bf16 v[176:191], v[200:203], v[128:131], v[176:191]
    v_exp_f32 v235, v235
    v_mul_f32 v163, v163, v171
    v_exp_f32 v236, v236
    ds_read_b128 v[196:199], v14 offset:30720
    v_mfma_f32_32x32x16_bf16 v[176:191], v[204:207], v[132:135], v[176:191]
    v_mul_f32 v164, v164, v172
    v_exp_f32 v237, v237
    v_mul_f32 v165, v165, v173
    ds_read_b128 v[200:203], v14 offset:31744
    v_mfma_f32_32x32x16_bf16 v[176:191], v[208:211], v[136:139], v[176:191]
    v_exp_f32 v238, v238
    v_mul_f32 v166, v166, v174
    v_exp_f32 v239, v239
    ds_read_b128 v[204:207], v14 offset:32768
    v_mfma_f32_32x32x16_bf16 v[176:191], v[212:215], v[140:143], v[176:191]
    v_mul_f32 v167, v167, v175
    v_add_f32 v232, 1.0, v232
    v_add_f32 v233, 1.0, v233
    v_add_f32 v234, 1.0, v234
    ds_read_b128 v[208:211], v14 offset:33792
    s_waitcnt lgkmcnt(5)
    v_mfma_f32_32x32x16_bf16 v[176:191], v[216:219], v[28:31], v[176:191]
    v_add_f32 v235, 1.0, v235
    v_add_f32 v236, 1.0, v236
    v_add_f32 v237, 1.0, v237
    v_add_f32 v238, 1.0, v238
    v_add_f32 v239, 1.0, v239
    ds_read_b128 v[212:215], v14 offset:34816
    v_mfma_f32_32x32x16_bf16 v[144:159], v[220:223], v[32:35], 0
    v_rcp_f32 v232, v232
    v_rcp_f32 v233, v233
    ds_read_b128 v[216:219], v14 offset:35840
    s_waitcnt lgkmcnt(5)
    v_mfma_f32_32x32x16_bf16 v[144:159], v[192:195], v[36:39], v[144:159]
    v_mul_f32 v160, v160, v232
    v_rcp_f32 v234, v234
    v_mul_f32 v161, v161, v233
    ds_read_b128 v[220:223], v14 offset:36864
    v_mfma_f32_32x32x16_bf16 v[144:159], v[196:199], v[40:43], v[144:159]
    v_rcp_f32 v235, v235
    v_mul_f32 v162, v162, v234
    ds_read_b128 v[192:195], v14 offset:37888
    s_waitcnt lgkmcnt(5)
    v_mfma_f32_32x32x16_bf16 v[144:159], v[200:203], v[44:47], v[144:159]
    v_rcp_f32 v236, v236
    v_mul_f32 v163, v163, v235
    v_rcp_f32 v237, v237
    ds_read_b128 v[196:199], v14 offset:38912
    v_mfma_f32_32x32x16_bf16 v[144:159], v[204:207], v[48:51], v[144:159]
    v_mul_f32 v164, v164, v236
    v_rcp_f32 v238, v238
    v_mul_f32 v165, v165, v237
    ds_read_b128 v[200:203], v14 offset:39936
    s_waitcnt lgkmcnt(5)
    v_mfma_f32_32x32x16_bf16 v[144:159], v[208:211], v[52:55], v[144:159]
    v_rcp_f32 v239, v239
    v_mul_f32 v166, v166, v238
    v_mul_f32 v167, v167, v239
    v_cvt_pk_bf16_f32 v244, v160, v161
    ds_read_b128 v[204:207], v14 offset:40960
    v_mfma_f32_32x32x16_bf16 v[144:159], v[212:215], v[56:59], v[144:159]
    v_cvt_pk_bf16_f32 v245, v162, v163
    v_cvt_pk_bf16_f32 v246, v164, v165
    v_cvt_pk_bf16_f32 v247, v166, v167
    ds_read_b128 v[208:211], v14 offset:41984
    s_waitcnt lgkmcnt(5)
    v_mfma_f32_32x32x16_bf16 v[144:159], v[216:219], v[60:63], v[144:159]
    buffer_store_dwordx4 v[244:247], v1, s[8:11], s61 offen offset:1024 sc1
    v_mul_f32 v224, v17, v176
    ds_read_b128 v[212:215], v14 offset:43008
    v_mfma_f32_32x32x16_bf16 v[144:159], v[220:223], v[64:67], v[144:159]
    v_mul_f32 v225, v17, v177
    v_mul_f32 v226, v17, v178
    s_add_u32 m0, s26, 0
    s_add_u32 s24, s25, 143360
    ds_read_b128 v[216:219], v14 offset:44032
    s_waitcnt lgkmcnt(5)
    v_mfma_f32_32x32x16_bf16 v[144:159], v[192:195], v[68:71], v[144:159]
    buffer_load_dwordx4 v1, s[8:11], s24 offen offset:0 lds
    v_mul_f32 v227, v17, v179
    v_mul_f32 v228, v17, v180
    v_mul_f32 v229, v17, v181
    buffer_load_dwordx4 v1, s[8:11], s24 offen offset:1024 lds
    ds_read_b128 v[220:223], v14 offset:45056
    v_mfma_f32_32x32x16_bf16 v[144:159], v[196:199], v[72:75], v[144:159]
    v_mul_f32 v230, v17, v182
    v_mul_f32 v231, v17, v183
    v_exp_f32 v224, v224
    ds_read_b128 v[192:195], v14 offset:46080
    s_waitcnt lgkmcnt(5)
    v_mfma_f32_32x32x16_bf16 v[144:159], v[200:203], v[76:79], v[144:159]
    buffer_load_dwordx4 v1, s[8:11], s24 offen offset:2048 lds
    v_mul_f32 v176, v176, v184
    v_exp_f32 v225, v225
    v_mul_f32 v177, v177, v185
    ds_read_b128 v[196:199], v14 offset:47104
    v_mfma_f32_32x32x16_bf16 v[144:159], v[204:207], v[80:83], v[144:159]
    buffer_load_dwordx4 v1, s[8:11], s24 offen offset:3072 lds
    v_exp_f32 v226, v226
    v_mul_f32 v178, v178, v186
    ds_read_b128 v[200:203], v14 offset:48128
    s_waitcnt lgkmcnt(5)
    v_mfma_f32_32x32x16_bf16 v[144:159], v[208:211], v[84:87], v[144:159]
    v_exp_f32 v227, v227
    s_add_u32 m0, s26, 4096
    s_add_u32 s24, s25, 147456
    buffer_load_dwordx4 v1, s[8:11], s24 offen offset:0 lds
    ds_read_b128 v[204:207], v14 offset:49152
    v_mfma_f32_32x32x16_bf16 v[144:159], v[212:215], v[88:91], v[144:159]
    v_mul_f32 v179, v179, v187
    v_exp_f32 v228, v228
    v_mul_f32 v180, v180, v188
    ds_read_b128 v[208:211], v14 offset:50176
    s_waitcnt lgkmcnt(5)
    v_mfma_f32_32x32x16_bf16 v[144:159], v[216:219], v[92:95], v[144:159]
    buffer_load_dwordx4 v1, s[8:11], s24 offen offset:1024 lds
    v_exp_f32 v229, v229
    v_mul_f32 v181, v181, v189
    ds_read_b128 v[212:215], v14 offset:51200
    v_mfma_f32_32x32x16_bf16 v[144:159], v[220:223], v[96:99], v[144:159]
    v_exp_f32 v230, v230
    buffer_load_dwordx4 v1, s[8:11], s24 offen offset:2048 lds
    v_mul_f32 v182, v182, v190
    ds_read_b128 v[216:219], v14 offset:52224
    s_waitcnt lgkmcnt(5)
    v_mfma_f32_32x32x16_bf16 v[144:159], v[192:195], v[100:103], v[144:159]
    v_exp_f32 v231, v231
    v_mul_f32 v183, v183, v191
    s_add_u32 m0, s26, 28672
    s_add_u32 s24, s25, 172032
    ds_read_b128 v[220:223], v14 offset:53248
    v_mfma_f32_32x32x16_bf16 v[144:159], v[196:199], v[104:107], v[144:159]
    buffer_load_dwordx4 v1, s[8:11], s24 offen offset:0 lds
    v_add_f32 v224, 1.0, v224
    v_add_f32 v225, 1.0, v225
    v_add_f32 v226, 1.0, v226
    ds_read_b128 v[192:195], v14 offset:54272
    s_waitcnt lgkmcnt(5)
    v_mfma_f32_32x32x16_bf16 v[144:159], v[200:203], v[108:111], v[144:159]
    buffer_load_dwordx4 v1, s[8:11], s24 offen offset:1024 lds
    v_add_f32 v227, 1.0, v227
    v_add_f32 v228, 1.0, v228
    v_add_f32 v229, 1.0, v229
    buffer_load_dwordx4 v1, s[8:11], s24 offen offset:2048 lds
    ds_read_b128 v[196:199], v14 offset:55296
    v_mfma_f32_32x32x16_bf16 v[144:159], v[204:207], v[112:115], v[144:159]
    v_add_f32 v230, 1.0, v230
    v_add_f32 v231, 1.0, v231
    v_rcp_f32 v224, v224
    ds_read_b128 v[200:203], v14 offset:56320
    s_waitcnt lgkmcnt(5)
    v_mfma_f32_32x32x16_bf16 v[144:159], v[208:211], v[116:119], v[144:159]
    buffer_load_dwordx4 v1, s[8:11], s24 offen offset:3072 lds
    v_rcp_f32 v225, v225
    v_mul_f32 v176, v176, v224
    ds_read_b128 v[204:207], v16 offset:4096
    v_mfma_f32_32x32x16_bf16 v[144:159], v[212:215], v[120:123], v[144:159]
    v_rcp_f32 v226, v226
    s_add_u32 m0, s26, 32768
    s_add_u32 s24, s25, 176128
    ds_read_b128 v[208:211], v15 offset:0
    s_waitcnt lgkmcnt(5)
    v_mfma_f32_32x32x16_bf16 v[144:159], v[216:219], v[124:127], v[144:159]
    buffer_load_dwordx4 v1, s[8:11], s24 offen offset:0 lds
    v_mul_f32 v177, v177, v225
    v_rcp_f32 v227, v227
    v_mul_f32 v178, v178, v226
    ds_read_b128 v[212:215], v15 offset:1024
    v_mfma_f32_32x32x16_bf16 v[144:159], v[220:223], v[128:131], v[144:159]
    buffer_load_dwordx4 v1, s[8:11], s24 offen offset:1024 lds
    v_rcp_f32 v228, v228
    v_mul_f32 v179, v179, v227
    ds_read_b128 v[216:219], v15 offset:2048
    s_waitcnt lgkmcnt(5)
    v_mfma_f32_32x32x16_bf16 v[144:159], v[192:195], v[132:135], v[144:159]
    v_rcp_f32 v229, v229
    buffer_load_dwordx4 v1, s[8:11], s24 offen offset:2048 lds
    v_mul_f32 v180, v180, v228
    ds_read_b128 v[220:223], v15 offset:3072
    v_mfma_f32_32x32x16_bf16 v[144:159], v[196:199], v[136:139], v[144:159]
    v_rcp_f32 v230, v230
    v_mul_f32 v181, v181, v229
    ds_read_b128 v[192:195], v15 offset:4096
    s_waitcnt lgkmcnt(5)
    v_mfma_f32_32x32x16_bf16 v[144:159], v[200:203], v[140:143], v[144:159]
    ds_read_b128 v[196:199], v15 offset:5120
    v_mfma_f32_32x32x16_bf16 v[144:159], v[204:207], v[28:31], v[144:159]
    v_rcp_f32 v231, v231
    v_mul_f32 v182, v182, v230
    v_mul_f32 v183, v183, v231
    ds_read_b128 v[200:203], v15 offset:6144
    s_waitcnt lgkmcnt(5)
    v_mfma_f32_32x32x16_bf16 v[160:175], v[208:211], v[32:35], 0
    v_cvt_pk_bf16_f32 v240, v176, v177
    v_cvt_pk_bf16_f32 v241, v178, v179
    v_cvt_pk_bf16_f32 v242, v180, v181
    v_cvt_pk_bf16_f32 v243, v182, v183
    ds_read_b128 v[204:207], v15 offset:7168
    v_mfma_f32_32x32x16_bf16 v[160:175], v[212:215], v[36:39], v[160:175]
    buffer_store_dwordx4 v[240:243], v1, s[8:11], s61 offen offset:2048 sc1
    ds_read_b128 v[208:211], v15 offset:8192
    s_waitcnt lgkmcnt(5)
    v_mfma_f32_32x32x16_bf16 v[160:175], v[216:219], v[40:43], v[160:175]
    v_mul_f32 v232, v17, v144
    v_mul_f32 v233, v17, v145
    v_mul_f32 v234, v17, v146
    ds_read_b128 v[212:215], v15 offset:9216
    v_mfma_f32_32x32x16_bf16 v[160:175], v[220:223], v[44:47], v[160:175]
    s_cmp_lg_u32 s7, 0
    s_cbranch_scc1 sk_130
    s_add_u32 s63, s29, 24576
    buffer_load_dwordx4 a[96:99], v1, s[8:11], s63 offen offset:0
sk_130:
    v_mul_f32 v235, v17, v147
    ds_read_b128 v[216:219], v15 offset:10240
    s_waitcnt lgkmcnt(5)
    v_mfma_f32_32x32x16_bf16 v[160:175], v[192:195], v[48:51], v[160:175]
    v_mul_f32 v236, v17, v148
    v_mul_f32 v237, v17, v149
    s_cmp_lg_u32 s7, 0
    s_cbranch_scc1 sk_131
    buffer_load_dwordx4 a[100:103], v1, s[8:11], s63 offen offset:1024
sk_131:
    ds_read_b128 v[220:223], v15 offset:11264
    v_mfma_f32_32x32x16_bf16 v[160:175], v[196:199], v[52:55], v[160:175]
    v_mul_f32 v238, v17, v150
    v_mul_f32 v239, v17, v151
    v_exp_f32 v232, v232
    ds_read_b128 v[192:195], v15 offset:12288
    s_waitcnt lgkmcnt(5)
    v_mfma_f32_32x32x16_bf16 v[160:175], v[200:203], v[56:59], v[160:175]
    s_cmp_lg_u32 s7, 0
    s_cbranch_scc1 sk_132
    buffer_load_dwordx4 a[104:107], v1, s[8:11], s63 offen offset:2048
sk_132:
    v_mul_f32 v144, v144, v152
    ds_read_b128 v[196:199], v15 offset:13312
    v_mfma_f32_32x32x16_bf16 v[160:175], v[204:207], v[60:63], v[160:175]
    v_exp_f32 v233, v233
    v_mul_f32 v145, v145, v153
    ds_read_b128 v[200:203], v15 offset:14336
    s_waitcnt lgkmcnt(5)
    v_mfma_f32_32x32x16_bf16 v[160:175], v[208:211], v[64:67], v[160:175]
    s_cmp_lg_u32 s7, 0
    s_cbranch_scc1 sk_133
    buffer_load_dwordx4 a[108:111], v1, s[8:11], s63 offen offset:3072
sk_133:
    v_exp_f32 v234, v234
    ds_read_b128 v[204:207], v15 offset:15360
    v_mfma_f32_32x32x16_bf16 v[160:175], v[212:215], v[68:71], v[160:175]
    v_mul_f32 v146, v146, v154
    v_exp_f32 v235, v235
    ds_read_b128 v[208:211], v15 offset:16384
    s_waitcnt lgkmcnt(5)
    v_mfma_f32_32x32x16_bf16 v[160:175], v[216:219], v[72:75], v[160:175]
    s_cmp_lg_u32 s7, 0
    s_cbranch_scc1 sk_134
    s_add_u32 s63, s30, 0
    buffer_load_dwordx4 a[112:115], v1, s[8:11], s63 offen offset:0
sk_134:
    v_mul_f32 v147, v147, v155
    ds_read_b128 v[212:215], v15 offset:17408
    v_mfma_f32_32x32x16_bf16 v[160:175], v[220:223], v[76:79], v[160:175]
    v_exp_f32 v236, v236
    v_mul_f32 v148, v148, v156
    ds_read_b128 v[216:219], v15 offset:18432
    s_waitcnt lgkmcnt(5)
    v_mfma_f32_32x32x16_bf16 v[160:175], v[192:195], v[80:83], v[160:175]
    s_cmp_lg_u32 s7, 0
    s_cbranch_scc1 sk_135
    buffer_load_dwordx4 a[116:119], v1, s[8:11], s63 offen offset:1024
sk_135:
    v_exp_f32 v237, v237
    ds_read_b128 v[220:223], v15 offset:19456
    v_mfma_f32_32x32x16_bf16 v[160:175], v[196:199], v[84:87], v[160:175]
    v_mul_f32 v149, v149, v157
    v_exp_f32 v238, v238
    ds_read_b128 v[192:195], v15 offset:20480
    s_waitcnt lgkmcnt(5)
    v_mfma_f32_32x32x16_bf16 v[160:175], v[200:203], v[88:91], v[160:175]
    s_cmp_lg_u32 s7, 0
    s_cbranch_scc1 sk_136
    buffer_load_dwordx4 a[120:123], v1, s[8:11], s63 offen offset:2048
sk_136:
    v_mul_f32 v150, v150, v158
    ds_read_b128 v[196:199], v15 offset:21504
    v_mfma_f32_32x32x16_bf16 v[160:175], v[204:207], v[92:95], v[160:175]
    v_exp_f32 v239, v239
    v_mul_f32 v151, v151, v159
    ds_read_b128 v[200:203], v15 offset:22528
    s_waitcnt lgkmcnt(5)
    v_mfma_f32_32x32x16_bf16 v[160:175], v[208:211], v[96:99], v[160:175]
    s_cmp_lg_u32 s7, 0
    s_cbranch_scc1 sk_137
    buffer_load_dwordx4 a[124:127], v1, s[8:11], s63 offen offset:3072
sk_137:
    v_add_f32 v232, 1.0, v232
    v_add_f32 v233, 1.0, v233
    ds_read_b128 v[204:207], v15 offset:23552
    v_mfma_f32_32x32x16_bf16 v[160:175], v[212:215], v[100:103], v[160:175]
    v_add_f32 v234, 1.0, v234
    s_cmp_lg_u32 s7, 0
    s_cbranch_scc1 sk_138
    s_add_u32 s63, s30, 4096
    buffer_load_dwordx4 a[128:131], v1, s[8:11], s63 offen offset:0
sk_138:
    ds_read_b128 v[208:211], v15 offset:24576
    s_waitcnt lgkmcnt(5)
    v_mfma_f32_32x32x16_bf16 v[160:175], v[216:219], v[104:107], v[160:175]
    v_add_f32 v235, 1.0, v235
    v_add_f32 v236, 1.0, v236
    v_add_f32 v237, 1.0, v237
    ds_read_b128 v[212:215], v15 offset:25600
    v_mfma_f32_32x32x16_bf16 v[160:175], v[220:223], v[108:111], v[160:175]
    s_cmp_lg_u32 s7, 0
    s_cbranch_scc1 sk_139
    buffer_load_dwordx4 a[132:135], v1, s[8:11], s63 offen offset:1024
sk_139:
    v_add_f32 v238, 1.0, v238
    ds_read_b128 v[216:219], v15 offset:26624
    s_waitcnt lgkmcnt(5)
    v_mfma_f32_32x32x16_bf16 v[160:175], v[192:195], v[112:115], v[160:175]
    v_add_f32 v239, 1.0, v239
    v_rcp_f32 v232, v232
    ds_read_b128 v[220:223], v15 offset:27648
    v_mfma_f32_32x32x16_bf16 v[160:175], v[196:199], v[116:119], v[160:175]
    s_cmp_lg_u32 s7, 0
    s_cbranch_scc1 sk_140
    buffer_load_dwordx4 a[136:139], v1, s[8:11], s63 offen offset:2048
sk_140:
    ds_read_b128 v[192:195], v16 offset:5120
    s_waitcnt lgkmcnt(5)
    v_mfma_f32_32x32x16_bf16 v[160:175], v[200:203], v[120:123], v[160:175]
    s_waitcnt vmcnt(1)
    s_waitcnt lgkmcnt(0)
    s_barrier
    ds_read_b128 v[196:199], v1 offset:0
    v_mfma_f32_32x32x16_bf16 v[160:175], v[204:207], v[124:127], v[160:175]
    v_rcp_f32 v233, v233
    v_mul_f32 v144, v144, v232
    ds_read_b128 v[200:203], v1 offset:1024
    v_mfma_f32_32x32x16_bf16 v[160:175], v[208:211], v[128:131], v[160:175]
    v_rcp_f32 v234, v234
    s_cmp_lg_u32 s7, 0
    s_cbranch_scc1 sk_141
    buffer_load_dwordx4 a[140:143], v1, s[8:11], s63 offen offset:3072
sk_141:
    ds_read_b128 v[204:207], v1 offset:2048
    v_mfma_f32_32x32x16_bf16 v[160:175], v[212:215], v[132:135], v[160:175]
    v_mul_f32 v145, v145, v233
    v_rcp_f32 v235, v235
    v_mul_f32 v146, v146, v234
    ds_read_b128 v[208:211], v1 offset:3072
    v_mfma_f32_32x32x16_bf16 v[160:175], v[216:219], v[136:139], v[160:175]
    s_cmp_lg_u32 s7, 0
    s_cbranch_scc1 sk_142
    s_add_u32 s63, s30, 8192
    buffer_load_dwordx4 a[144:147], v1, s[8:11], s63 offen offset:0
sk_142:
    v_rcp_f32 v236, v236
    ds_read_b128 v[212:215], v1 offset:4096
    v_mfma_f32_32x32x16_bf16 v[160:175], v[220:223], v[140:143], v[160:175]
    v_mul_f32 v147, v147, v235
    v_rcp_f32 v237, v237
    ds_read_b128 v[216:219], v1 offset:5120
    s_waitcnt lgkmcnt(5)
    v_mfma_f32_32x32x16_bf16 v[160:175], v[192:195], v[28:31], v[160:175]
    s_cmp_lg_u32 s7, 0
    s_cbranch_scc1 sk_143
    buffer_load_dwordx4 a[148:151], v1, s[8:11], s63 offen offset:1024
sk_143:
    v_mul_f32 v148, v148, v236
    ds_read_b128 v[220:223], v1 offset:6144
    v_mfma_f32_32x32x16_bf16 v[176:191], v[196:199], v[32:35], 0
    v_rcp_f32 v238, v238
    v_mul_f32 v149, v149, v237
    ds_read_b128 v[192:195], v1 offset:7168
    s_waitcnt lgkmcnt(5)
    v_mfma_f32_32x32x16_bf16 v[176:191], v[200:203], v[36:39], v[176:191]
    s_cmp_lg_u32 s7, 0
    s_cbranch_scc1 sk_144
    buffer_load_dwordx4 a[152:155], v1, s[8:11], s63 offen offset:2048
sk_144:
    v_rcp_f32 v239, v239
    ds_read_b128 v[196:199], v1 offset:8192
    v_mfma_f32_32x32x16_bf16 v[176:191], v[204:207], v[40:43], v[176:191]
    v_mul_f32 v150, v150, v238
    v_mul_f32 v151, v151, v239
    ds_read_b128 v[200:203], v1 offset:9216
    s_waitcnt lgkmcnt(5)
    v_mfma_f32_32x32x16_bf16 v[176:191], v[208:211], v[44:47], v[176:191]
    s_cmp_lg_u32 s7, 0
    s_cbranch_scc1 sk_145
    buffer_load_dwordx4 a[156:159], v1, s[8:11], s63 offen offset:3072
sk_145:
    v_cvt_pk_bf16_f32 v244, v144, v145
    v_cvt_pk_bf16_f32 v245, v146, v147
    ds_read_b128 v[204:207], v1 offset:10240
    v_mfma_f32_32x32x16_bf16 v[176:191], v[212:215], v[48:51], v[176:191]
    v_cvt_pk_bf16_f32 v246, v148, v149
    v_cvt_pk_bf16_f32 v247, v150, v151
    ds_read_b128 v[208:211], v1 offset:11264
    s_waitcnt lgkmcnt(5)
    v_mfma_f32_32x32x16_bf16 v[176:191], v[216:219], v[52:55], v[176:191]
    buffer_store_dwordx4 v[244:247], v1, s[8:11], s61 offen offset:3072 sc1
    s_mul_i32 s60, s7, 3
    ds_read_b128 v[212:215], v1 offset:12288
    v_mfma_f32_32x32x16_bf16 v[176:191], v[220:223], v[56:59], v[176:191]
    s_add_u32 s62, s60, 2
    s_add_u32 s60, s60, 1
    v_mul_f32 v224, v17, v160
    ds_read_b128 v[216:219], v1 offset:13312
    s_waitcnt lgkmcnt(5)
    v_mfma_f32_32x32x16_bf16 v[176:191], v[192:195], v[60:63], v[176:191]
    s_cmp_lg_u32 s7, 0
    s_cbranch_scc1 sk_146
    s_add_u32 s63, s30, 12288
    buffer_load_dwordx4 a[160:163], v1, s[8:11], s63 offen offset:0
sk_146:
    v_mul_f32 v225, v17, v161
    ds_read_b128 v[220:223], v1 offset:14336
    v_mfma_f32_32x32x16_bf16 v[176:191], v[196:199], v[64:67], v[176:191]
    s_cmp_lg_u32 s7, 0
    s_cbranch_scc1 sk_147
    buffer_load_dwordx4 a[164:167], v1, s[8:11], s63 offen offset:1024
sk_147:
    v_mul_f32 v226, v17, v162
    ds_read_b128 v[192:195], v1 offset:15360
    s_waitcnt lgkmcnt(5)
    v_mfma_f32_32x32x16_bf16 v[176:191], v[200:203], v[68:71], v[176:191]
    s_cmp_lg_u32 s7, 0
    s_cbranch_scc1 sk_148
    buffer_load_dwordx4 a[168:171], v1, s[8:11], s63 offen offset:2048
sk_148:
    v_mul_f32 v227, v17, v163
    ds_read_b128 v[196:199], v1 offset:16384
    v_mfma_f32_32x32x16_bf16 v[176:191], v[204:207], v[72:75], v[176:191]
    s_cmp_lg_u32 s7, 0
    s_cbranch_scc1 sk_149
    buffer_load_dwordx4 a[172:175], v1, s[8:11], s63 offen offset:3072
sk_149:
    v_mul_f32 v228, v17, v164
    ds_read_b128 v[200:203], v1 offset:17408
    s_waitcnt lgkmcnt(5)
    v_mfma_f32_32x32x16_bf16 v[176:191], v[208:211], v[76:79], v[176:191]
    s_cmp_lg_u32 s7, 0
    s_cbranch_scc1 sk_150
    s_add_u32 s63, s30, 16384
    buffer_load_dwordx4 a[176:179], v1, s[8:11], s63 offen offset:0
sk_150:
    v_mul_f32 v229, v17, v165
    ds_read_b128 v[204:207], v1 offset:18432
    v_mfma_f32_32x32x16_bf16 v[176:191], v[212:215], v[80:83], v[176:191]
    s_cmp_lg_u32 s7, 0
    s_cbranch_scc1 sk_151
    buffer_load_dwordx4 a[180:183], v1, s[8:11], s63 offen offset:1024
sk_151:
    v_mul_f32 v230, v17, v166
    ds_read_b128 v[208:211], v1 offset:19456
    s_waitcnt lgkmcnt(5)
    v_mfma_f32_32x32x16_bf16 v[176:191], v[216:219], v[84:87], v[176:191]
    s_cmp_lg_u32 s7, 0
    s_cbranch_scc1 sk_152
    buffer_load_dwordx4 a[184:187], v1, s[8:11], s63 offen offset:2048
sk_152:
    v_mul_f32 v231, v17, v167
    ds_read_b128 v[212:215], v1 offset:20480
    v_mfma_f32_32x32x16_bf16 v[176:191], v[220:223], v[88:91], v[176:191]
    s_cmp_lg_u32 s7, 0
    s_cbranch_scc1 sk_153
    buffer_load_dwordx4 a[188:191], v1, s[8:11], s63 offen offset:3072
sk_153:
    ds_read_b128 v[216:219], v1 offset:21504
    s_waitcnt lgkmcnt(5)
    v_mfma_f32_32x32x16_bf16 v[176:191], v[192:195], v[92:95], v[176:191]
    v_exp_f32 v224, v224
    s_cmp_lg_u32 s7, 0
    s_cbranch_scc1 sk_154
    s_add_u32 s63, s30, 20480
    buffer_load_dwordx4 a[192:195], v1, s[8:11], s63 offen offset:0
sk_154:
    ds_read_b128 v[220:223], v1 offset:22528
    v_mfma_f32_32x32x16_bf16 v[176:191], v[196:199], v[96:99], v[176:191]
    v_mul_f32 v160, v160, v168
    s_cmp_lg_u32 s7, 0
    s_cbranch_scc1 sk_155
    buffer_load_dwordx4 a[196:199], v1, s[8:11], s63 offen offset:1024
sk_155:
    ds_read_b128 v[192:195], v1 offset:23552
    s_waitcnt lgkmcnt(5)
    v_mfma_f32_32x32x16_bf16 v[176:191], v[200:203], v[100:103], v[176:191]
    v_exp_f32 v225, v225
    s_cmp_lg_u32 s7, 0
    s_cbranch_scc1 sk_156
    buffer_load_dwordx4 a[200:203], v1, s[8:11], s63 offen offset:2048
sk_156:
    ds_read_b128 v[196:199], v1 offset:24576
    v_mfma_f32_32x32x16_bf16 v[176:191], v[204:207], v[104:107], v[176:191]
    v_mul_f32 v161, v161, v169
    s_cmp_lg_u32 s7, 0
    s_cbranch_scc1 sk_157
    buffer_load_dwordx4 a[204:207], v1, s[8:11], s63 offen offset:3072
sk_157:
    ds_read_b128 v[200:203], v1 offset:25600
    s_waitcnt lgkmcnt(5)
    v_mfma_f32_32x32x16_bf16 v[176:191], v[208:211], v[108:111], v[176:191]
    v_exp_f32 v226, v226
    s_cmp_lg_u32 s7, 0
    s_cbranch_scc1 sk_158
    s_add_u32 s63, s30, 24576
    buffer_load_dwordx4 a[208:211], v1, s[8:11], s63 offen offset:0
sk_158:
    ds_read_b128 v[204:207], v1 offset:26624
    v_mfma_f32_32x32x16_bf16 v[176:191], v[212:215], v[112:115], v[176:191]
    v_mul_f32 v162, v162, v170
    s_cmp_lg_u32 s7, 0
    s_cbranch_scc1 sk_159
    buffer_load_dwordx4 a[212:215], v1, s[8:11], s63 offen offset:1024
sk_159:
    ds_read_b128 v[208:211], v1 offset:27648
    s_waitcnt lgkmcnt(5)
    v_mfma_f32_32x32x16_bf16 v[176:191], v[216:219], v[116:119], v[176:191]
    v_exp_f32 v227, v227
    s_cmp_lg_u32 s7, 0
    s_cbranch_scc1 sk_160
    buffer_load_dwordx4 a[216:219], v1, s[8:11], s63 offen offset:2048
sk_160:
    ds_read_b128 v[212:215], v16 offset:6144
    v_mfma_f32_32x32x16_bf16 v[176:191], v[220:223], v[120:123], v[176:191]
    v_mul_f32 v163, v163, v171
    s_cmp_lg_u32 s7, 0
    s_cbranch_scc1 sk_161
    buffer_load_dwordx4 a[220:223], v1, s[8:11], s63 offen offset:3072
sk_161:
    ds_read_b128 v[216:219], v1 offset:28672
    s_waitcnt lgkmcnt(5)
    v_mfma_f32_32x32x16_bf16 v[176:191], v[192:195], v[124:127], v[176:191]
    v_exp_f32 v228, v228
    s_cmp_lg_u32 s7, 0
    s_cbranch_scc1 sk_162
    v_min_u32 v19, 1, v2
    v_lshlrev_b32 v19, 7, v19
    s_add_u32 s0, s1, 0
    buffer_load_dword v0, v19, s[8:11], s0 offen sc1
sk_162:
    ds_read_b128 v[220:223], v1 offset:29696
    v_mfma_f32_32x32x16_bf16 v[176:191], v[196:199], v[128:131], v[176:191]
    v_mul_f32 v164, v164, v172
    v_exp_f32 v229, v229
    v_mul_f32 v165, v165, v173
    ds_read_b128 v[192:195], v1 offset:30720
    s_waitcnt lgkmcnt(5)
    v_mfma_f32_32x32x16_bf16 v[176:191], v[200:203], v[132:135], v[176:191]
    v_exp_f32 v230, v230
    v_mul_f32 v166, v166, v174
    v_exp_f32 v231, v231
    ds_read_b128 v[196:199], v1 offset:31744
    v_mfma_f32_32x32x16_bf16 v[176:191], v[204:207], v[136:139], v[176:191]
    v_mul_f32 v167, v167, v175
    v_add_f32 v224, 1.0, v224
    v_add_f32 v225, 1.0, v225
    v_add_f32 v226, 1.0, v226
    ds_read_b128 v[200:203], v1 offset:32768
    s_waitcnt lgkmcnt(5)
    v_mfma_f32_32x32x16_bf16 v[176:191], v[208:211], v[140:143], v[176:191]
    v_add_f32 v227, 1.0, v227
    v_add_f32 v228, 1.0, v228
    v_add_f32 v229, 1.0, v229
    ds_read_b128 v[204:207], v1 offset:33792
    v_mfma_f32_32x32x16_bf16 v[176:191], v[212:215], v[28:31], v[176:191]
    v_mov_b32 v18, s60
    s_waitcnt vmcnt(0)
    s_mov_b64 exec, 1
    buffer_store_dword v18, v11, s[8:11], s33 offen sc1
    s_mov_b64 exec, -1
    ds_read_b128 v[208:211], v1 offset:34816
    s_waitcnt lgkmcnt(5)
    v_mfma_f32_32x32x16_bf16 v[144:159], v[216:219], v[32:35], 0
    v_add_f32 v230, 1.0, v230
    v_add_f32 v231, 1.0, v231
    v_rcp_f32 v224, v224
    ds_read_b128 v[212:215], v1 offset:35840
    v_mfma_f32_32x32x16_bf16 v[144:159], v[220:223], v[36:39], v[144:159]
    v_rcp_f32 v225, v225
    v_mul_f32 v160, v160, v224
    ds_read_b128 v[216:219], v1 offset:36864
    s_waitcnt lgkmcnt(5)
    v_mfma_f32_32x32x16_bf16 v[144:159], v[192:195], v[40:43], v[144:159]
    v_rcp_f32 v226, v226
    v_mul_f32 v161, v161, v225
    v_rcp_f32 v227, v227
    ds_read_b128 v[220:223], v1 offset:37888
    v_mfma_f32_32x32x16_bf16 v[144:159], v[196:199], v[44:47], v[144:159]
    v_mul_f32 v162, v162, v226
    v_rcp_f32 v228, v228
    v_mul_f32 v163, v163, v227
    v_rcp_f32 v229, v229
    v_mul_f32 v164, v164, v228
    v_rcp_f32 v230, v230
    v_mul_f32 v165, v165, v229
    v_rcp_f32 v231, v231
    v_mul_f32 v166, v166, v230
    v_mul_f32 v167, v167, v231
    v_cvt_pk_bf16_f32 v240, v160, v161
    v_cvt_pk_bf16_f32 v241, v162, v163
    v_cvt_pk_bf16_f32 v242, v164, v165
    v_cvt_pk_bf16_f32 v243, v166, v167
    s_add_u32 s61, s61, 4096
    buffer_store_dwordx4 v[240:243], v1, s[8:11], s61 offen offset:0 sc1
    ds_read_b128 v[192:195], v1 offset:38912
    s_waitcnt lgkmcnt(5)
    v_mfma_f32_32x32x16_bf16 v[144:159], v[200:203], v[48:51], v[144:159]
    v_mul_f32 v232, v17, v176
    v_mul_f32 v233, v17, v177
    v_mul_f32 v234, v17, v178
    v_mul_f32 v235, v17, v179
    v_mul_f32 v236, v17, v180
    ds_read_b128 v[196:199], v1 offset:39936
    v_mfma_f32_32x32x16_bf16 v[144:159], v[204:207], v[52:55], v[144:159]
    v_mul_f32 v237, v17, v181
    v_mul_f32 v238, v17, v182
    v_mul_f32 v239, v17, v183
    ds_read_b128 v[200:203], v1 offset:40960
    s_waitcnt lgkmcnt(5)
    v_mfma_f32_32x32x16_bf16 v[144:159], v[208:211], v[56:59], v[144:159]
    v_exp_f32 v232, v232
    v_mul_f32 v176, v176, v184
    v_exp_f32 v233, v233
    ds_read_b128 v[204:207], v1 offset:41984
    v_mfma_f32_32x32x16_bf16 v[144:159], v[212:215], v[60:63], v[144:159]
    v_mul_f32 v177, v177, v185
    v_exp_f32 v234, v234
    ds_read_b128 v[208:211], v1 offset:43008
    buffer_load_dword v19, v10, s[8:11], s34 offen sc1
    s_waitcnt lgkmcnt(5)
    v_mfma_f32_32x32x16_bf16 v[144:159], v[216:219], v[64:67], v[144:159]
    v_mul_f32 v178, v178, v186
    v_exp_f32 v235, v235
    v_mul_f32 v179, v179, v187
    ds_read_b128 v[212:215], v1 offset:44032
    v_mfma_f32_32x32x16_bf16 v[144:159], v[220:223], v[68:71], v[144:159]
    v_exp_f32 v236, v236
    v_mul_f32 v180, v180, v188
    ds_read_b128 v[216:219], v1 offset:45056
    s_waitcnt lgkmcnt(5)
    v_mfma_f32_32x32x16_bf16 v[144:159], v[192:195], v[72:75], v[144:159]
    v_exp_f32 v237, v237
    v_mul_f32 v181, v181, v189
    v_exp_f32 v238, v238
    ds_read_b128 v[220:223], v1 offset:46080
    v_mfma_f32_32x32x16_bf16 v[144:159], v[196:199], v[76:79], v[144:159]
    v_mul_f32 v182, v182, v190
    v_exp_f32 v239, v239
    v_mul_f32 v183, v183, v191
    ds_read_b128 v[192:195], v1 offset:47104
    s_waitcnt lgkmcnt(5)
    v_mfma_f32_32x32x16_bf16 v[144:159], v[200:203], v[80:83], v[144:159]
    v_add_f32 v232, 1.0, v232
    v_add_f32 v233, 1.0, v233
    v_add_f32 v234, 1.0, v234
    v_add_f32 v235, 1.0, v235
    v_add_f32 v236, 1.0, v236
    ds_read_b128 v[196:199], v1 offset:48128
    v_mfma_f32_32x32x16_bf16 v[144:159], v[204:207], v[84:87], v[144:159]
    v_add_f32 v237, 1.0, v237
    v_add_f32 v238, 1.0, v238
    v_add_f32 v239, 1.0, v239
    ds_read_b128 v[200:203], v1 offset:49152
    s_waitcnt lgkmcnt(5)
    v_mfma_f32_32x32x16_bf16 v[144:159], v[208:211], v[88:91], v[144:159]
    v_rcp_f32 v232, v232
    v_rcp_f32 v233, v233
    v_mul_f32 v176, v176, v232
    ds_read_b128 v[204:207], v1 offset:50176
    v_mfma_f32_32x32x16_bf16 v[144:159], v[212:215], v[92:95], v[144:159]
    v_rcp_f32 v234, v234
    v_mul_f32 v177, v177, v233
    ds_read_b128 v[208:211], v1 offset:51200
    s_waitcnt lgkmcnt(5)
    v_mfma_f32_32x32x16_bf16 v[144:159], v[216:219], v[96:99], v[144:159]
    v_rcp_f32 v235, v235
    v_mul_f32 v178, v178, v234
    v_rcp_f32 v236, v236
    ds_read_b128 v[212:215], v1 offset:52224
    v_mfma_f32_32x32x16_bf16 v[144:159], v[220:223], v[100:103], v[144:159]
    ds_read_b128 v[216:219], v1 offset:53248
    s_waitcnt vmcnt(0)
    v_cmp_gt_u32 vcc, s60, v19
    s_nop 1
    s_cbranch_vccnz hwait_164
hok_163:
    s_add_u32 s48, s36, 0
    buffer_load_dwordx4 v[100:103], v1, s[8:11], s48 offen sc1
    s_add_u32 s48, s35, 0
    buffer_load_dwordx4 v[96:99], v1, s[8:11], s48 offen sc1
    s_waitcnt lgkmcnt(5)
    v_mfma_f32_32x32x16_bf16 v[144:159], v[192:195], v[104:107], v[144:159]
    v_mul_f32 v179, v179, v235
    v_rcp_f32 v237, v237
    v_mul_f32 v180, v180, v236
    ds_read_b128 v[220:223], v1 offset:54272
    v_mfma_f32_32x32x16_bf16 v[144:159], v[196:199], v[108:111], v[144:159]
    ds_read_b128 v[192:195], v1 offset:55296
    s_add_u32 s48, s36, 1024
    buffer_load_dwordx4 v[108:111], v1, s[8:11], s48 offen sc1
    s_add_u32 s48, s35, 1024
    buffer_load_dwordx4 v[104:107], v1, s[8:11], s48 offen sc1
    s_waitcnt lgkmcnt(5)
    v_mfma_f32_32x32x16_bf16 v[144:159], v[200:203], v[112:115], v[144:159]
    v_rcp_f32 v238, v238
    v_mul_f32 v181, v181, v237
    v_rcp_f32 v239, v239
    v_mul_f32 v182, v182, v238
    v_mul_f32 v183, v183, v239
    v_cvt_pk_bf16_f32 v244, v176, v177
    v_cvt_pk_bf16_f32 v245, v178, v179
    v_cvt_pk_bf16_f32 v246, v180, v181
    v_cvt_pk_bf16_f32 v247, v182, v183
    buffer_store_dwordx4 v[244:247], v1, s[8:11], s61 offen offset:1024 sc1
    ds_read_b128 v[196:199], v1 offset:56320
    v_mfma_f32_32x32x16_bf16 v[144:159], v[204:207], v[116:119], v[144:159]
    ds_read_b128 v[200:203], v16 offset:7168
    s_add_u32 s48, s36, 2048
    buffer_load_dwordx4 v[116:119], v1, s[8:11], s48 offen sc1
    s_add_u32 s48, s35, 2048
    buffer_load_dwordx4 v[112:115], v1, s[8:11], s48 offen sc1
    s_waitcnt lgkmcnt(5)
    v_mfma_f32_32x32x16_bf16 v[144:159], v[208:211], v[120:123], v[144:159]
    v_mfma_f32_32x32x16_bf16 v[144:159], v[212:215], v[124:127], v[144:159]
    s_add_u32 s48, s36, 3072
    buffer_load_dwordx4 v[124:127], v1, s[8:11], s48 offen sc1
    s_add_u32 s48, s35, 3072
    buffer_load_dwordx4 v[120:123], v1, s[8:11], s48 offen sc1
    s_waitcnt lgkmcnt(3)
    v_mfma_f32_32x32x16_bf16 v[144:159], v[216:219], v[128:131], v[144:159]
    v_mfma_f32_32x32x16_bf16 v[144:159], v[220:223], v[132:135], v[144:159]
    s_add_u32 s48, s36, 7168
    buffer_load_dwordx4 v[132:135], v1, s[8:11], s48 offen sc1
    s_add_u32 s48, s35, 7168
    buffer_load_dwordx4 v[128:131], v1, s[8:11], s48 offen sc1
    s_waitcnt lgkmcnt(1)
    v_mfma_f32_32x32x16_bf16 v[144:159], v[192:195], v[136:139], v[144:159]
    v_mfma_f32_32x32x16_bf16 v[144:159], v[196:199], v[140:143], v[144:159]
    s_add_u32 s48, s36, 8192
    buffer_load_dwordx4 v[140:143], v1, s[8:11], s48 offen sc1
    s_add_u32 s48, s35, 8192
    buffer_load_dwordx4 v[136:139], v1, s[8:11], s48 offen sc1
    s_waitcnt lgkmcnt(0)
    v_mfma_f32_32x32x16_bf16 v[144:159], v[200:203], v[28:31], v[144:159]
    s_add_u32 s0, s60, 2
    v_mov_b32 v18, s62
    s_waitcnt vmcnt(8)
    s_mov_b64 exec, 1
    buffer_store_dword v18, v11, s[8:11], s33 offen sc1
    s_mov_b64 exec, -1
    s_cmp_eq_u32 s46, 0
    s_cbranch_scc1 p5_skip_167
    s_add_u32 s48, s36, 9216
    buffer_load_dwordx4 v[164:167], v1, s[8:11], s48 offen sc1
    s_add_u32 s48, s35, 9216
    buffer_load_dwordx4 v[160:163], v1, s[8:11], s48 offen sc1
    v_mfma_f32_32x32x16_bf16 v[64:79], a[0:3], v[100:103], 0
    v_mul_f32 v224, v17, v144
    v_mul_f32 v225, v17, v145
    v_mul_f32 v226, v17, v146
    v_mul_f32 v227, v17, v147
    v_mul_f32 v228, v17, v148
    v_mul_f32 v229, v17, v149
    v_mfma_f32_32x32x16_bf16 v[80:95], a[112:115], v[100:103], 0
    v_mul_f32 v230, v17, v150
    v_mul_f32 v231, v17, v151
    v_exp_f32 v224, v224
    v_mul_f32 v144, v144, v152
    v_mfma_f32_32x32x16_bf16 v[48:63], a[112:115], v[96:99], 0
    v_exp_f32 v225, v225
    v_mul_f32 v145, v145, v153
    v_exp_f32 v226, v226
    v_mul_f32 v146, v146, v154
    v_mfma_f32_32x32x16_bf16 v[32:47], a[0:3], v[96:99], 0
    s_add_u32 s48, s36, 10240
    buffer_load_dwordx4 v[172:175], v1, s[8:11], s48 offen sc1
    s_add_u32 s48, s35, 10240
    buffer_load_dwordx4 v[168:171], v1, s[8:11], s48 offen sc1
    v_mfma_f32_32x32x16_bf16 v[64:79], a[4:7], v[108:111], v[64:79]
    v_exp_f32 v227, v227
    v_mul_f32 v147, v147, v155
    v_exp_f32 v228, v228
    v_mul_f32 v148, v148, v156
    v_mfma_f32_32x32x16_bf16 v[80:95], a[116:119], v[108:111], v[80:95]
    v_exp_f32 v229, v229
    v_mul_f32 v149, v149, v157
    v_exp_f32 v230, v230
    v_mfma_f32_32x32x16_bf16 v[48:63], a[116:119], v[104:107], v[48:63]
    v_mul_f32 v150, v150, v158
    v_exp_f32 v231, v231
    v_mul_f32 v151, v151, v159
    v_add_f32 v224, 1.0, v224
    v_add_f32 v225, 1.0, v225
    v_mfma_f32_32x32x16_bf16 v[32:47], a[4:7], v[104:107], v[32:47]
    v_add_f32 v226, 1.0, v226
    s_add_u32 s48, s36, 14336
    buffer_load_dwordx4 v[180:183], v1, s[8:11], s48 offen sc1
    s_add_u32 s48, s35, 14336
    buffer_load_dwordx4 v[176:179], v1, s[8:11], s48 offen sc1
    s_waitcnt vmcnt(14)
    v_mfma_f32_32x32x16_bf16 v[64:79], a[8:11], v[116:119], v[64:79]
    v_add_f32 v227, 1.0, v227
    v_add_f32 v228, 1.0, v228
    v_add_f32 v229, 1.0, v229
    v_add_f32 v230, 1.0, v230
    v_add_f32 v231, 1.0, v231
    v_mfma_f32_32x32x16_bf16 v[80:95], a[120:123], v[116:119], v[80:95]
    v_rcp_f32 v224, v224
    v_rcp_f32 v225, v225
    v_mul_f32 v144, v144, v224
    s_waitcnt vmcnt(13)
    v_mfma_f32_32x32x16_bf16 v[48:63], a[120:123], v[112:115], v[48:63]
    v_rcp_f32 v226, v226
    v_mul_f32 v145, v145, v225
    v_rcp_f32 v227, v227
    v_mul_f32 v146, v146, v226
    v_mfma_f32_32x32x16_bf16 v[32:47], a[8:11], v[112:115], v[32:47]
    s_add_u32 s48, s36, 15360
    buffer_load_dwordx4 v[188:191], v1, s[8:11], s48 offen sc1
    s_add_u32 s48, s35, 15360
    buffer_load_dwordx4 v[184:187], v1, s[8:11], s48 offen sc1
    s_waitcnt vmcnt(14)
    v_mfma_f32_32x32x16_bf16 v[64:79], a[12:15], v[124:127], v[64:79]
    v_rcp_f32 v228, v228
    v_mul_f32 v147, v147, v227
    v_rcp_f32 v229, v229
    v_mul_f32 v148, v148, v228
    v_mfma_f32_32x32x16_bf16 v[80:95], a[124:127], v[124:127], v[80:95]
    v_rcp_f32 v230, v230
    v_mul_f32 v149, v149, v229
    v_rcp_f32 v231, v231
    s_waitcnt vmcnt(13)
    v_mfma_f32_32x32x16_bf16 v[48:63], a[124:127], v[120:123], v[48:63]
    v_mul_f32 v150, v150, v230
    v_mul_f32 v151, v151, v231
    v_cvt_pk_bf16_f32 v240, v144, v145
    v_cvt_pk_bf16_f32 v241, v146, v147
    v_cvt_pk_bf16_f32 v242, v148, v149
    v_cvt_pk_bf16_f32 v243, v150, v151
    v_mfma_f32_32x32x16_bf16 v[32:47], a[12:15], v[120:123], v[32:47]
    s_add_u32 s48, s36, 16384
    buffer_load_dwordx4 v[196:199], v1, s[8:11], s48 offen sc1
    s_add_u32 s48, s35, 16384
    buffer_load_dwordx4 v[192:195], v1, s[8:11], s48 offen sc1
    s_waitcnt vmcnt(14)
    v_mfma_f32_32x32x16_bf16 v[64:79], a[28:31], v[132:135], v[64:79]
    buffer_store_dwordx4 v[240:243], v1, s[8:11], s61 offen offset:2048 sc1
    v_mfma_f32_32x32x16_bf16 v[80:95], a[140:143], v[132:135], v[80:95]
    s_waitcnt vmcnt(14)
    v_mfma_f32_32x32x16_bf16 v[48:63], a[140:143], v[128:131], v[48:63]
    v_mfma_f32_32x32x16_bf16 v[32:47], a[28:31], v[128:131], v[32:47]
    s_add_u32 s48, s36, 17408
    buffer_load_dwordx4 v[204:207], v1, s[8:11], s48 offen sc1
    s_add_u32 s48, s35, 17408
    buffer_load_dwordx4 v[200:203], v1, s[8:11], s48 offen sc1
    s_waitcnt vmcnt(15)
    v_mfma_f32_32x32x16_bf16 v[64:79], a[32:35], v[140:143], v[64:79]
    v_mfma_f32_32x32x16_bf16 v[80:95], a[144:147], v[140:143], v[80:95]
    s_waitcnt vmcnt(14)
    v_mfma_f32_32x32x16_bf16 v[48:63], a[144:147], v[136:139], v[48:63]
    v_mfma_f32_32x32x16_bf16 v[32:47], a[32:35], v[136:139], v[32:47]
    s_add_u32 s48, s36, 21504
    buffer_load_dwordx4 v[212:215], v1, s[8:11], s48 offen sc1
    s_add_u32 s48, s35, 21504
    buffer_load_dwordx4 v[208:211], v1, s[8:11], s48 offen sc1
    buffer_load_dword v19, v10, s[8:11], s34 offen sc1
    s_waitcnt vmcnt(15)
    v_mfma_f32_32x32x16_bf16 v[64:79], a[36:39], v[164:167], v[64:79]
    v_mfma_f32_32x32x16_bf16 v[80:95], a[148:151], v[164:167], v[80:95]
    s_waitcnt vmcnt(14)
    v_mfma_f32_32x32x16_bf16 v[48:63], a[148:151], v[160:163], v[48:63]
    v_mov_b32 v18, s0
    s_waitcnt vmcnt(5)
    s_mov_b64 exec, 1
    buffer_store_dword v18, v11, s[8:11], s33 offen sc1
    s_mov_b64 exec, -1
    v_mfma_f32_32x32x16_bf16 v[32:47], a[36:39], v[160:163], v[32:47]
    s_add_u32 s48, s36, 22528
    buffer_load_dwordx4 v[220:223], v1, s[8:11], s48 offen sc1
    s_add_u32 s48, s35, 22528
    buffer_load_dwordx4 v[216:219], v1, s[8:11], s48 offen sc1
    v_mfma_f32_32x32x16_bf16 v[64:79], a[40:43], v[172:175], v[64:79]
    s_mul_i32 s50, s55, 28
    s_lshl_b32 s49, s54, 1
    s_add_u32 s50, s50, s49
    s_lshl_b32 s50, s50, 10
    s_add_u32 s50, s50, s39
    buffer_load_dwordx4 v[232:235], v1, s[8:11], s50 offen sc1
    v_mfma_f32_32x32x16_bf16 v[80:95], a[152:155], v[172:175], v[80:95]
    buffer_load_dwordx4 v[236:239], v1, s[8:11], s50 offen offset:1024 sc1
    s_mul_i32 s51, s55, 3584
    s_add_u32 s51, s51, s40
    buffer_load_dwordx2 v[144:145], v6, s[8:11], s51 offen offset:0 sc1
    buffer_load_dwordx2 v[146:147], v6, s[8:11], s51 offen offset:256 sc1
    v_mfma_f32_32x32x16_bf16 v[48:63], a[152:155], v[168:171], v[48:63]
    buffer_load_dwordx2 v[148:149], v6, s[8:11], s51 offen offset:512 sc1
    buffer_load_dwordx2 v[150:151], v6, s[8:11], s51 offen offset:768 sc1
    buffer_load_dwordx2 v[152:153], v6, s[8:11], s51 offen offset:1024 sc1
    buffer_load_dwordx2 v[154:155], v6, s[8:11], s51 offen offset:1280 sc1
    buffer_load_dwordx2 v[156:157], v6, s[8:11], s51 offen offset:1536 sc1
    v_mfma_f32_32x32x16_bf16 v[32:47], a[40:43], v[168:171], v[32:47]
    s_add_u32 s48, s36, 23552
    buffer_load_dwordx4 v[100:103], v1, s[8:11], s48 offen sc1
    s_add_u32 s48, s35, 23552
    buffer_load_dwordx4 v[96:99], v1, s[8:11], s48 offen sc1
    v_mfma_f32_32x32x16_bf16 v[64:79], a[56:59], v[180:183], v[64:79]
    v_mfma_f32_32x32x16_bf16 v[80:95], a[168:171], v[180:183], v[80:95]
    v_mfma_f32_32x32x16_bf16 v[48:63], a[168:171], v[176:179], v[48:63]
    v_mfma_f32_32x32x16_bf16 v[32:47], a[56:59], v[176:179], v[32:47]
    s_add_u32 s48, s36, 24576
    buffer_load_dwordx4 v[108:111], v1, s[8:11], s48 offen sc1
    s_add_u32 s48, s35, 24576
    buffer_load_dwordx4 v[104:107], v1, s[8:11], s48 offen sc1
    v_mfma_f32_32x32x16_bf16 v[64:79], a[60:63], v[188:191], v[64:79]
    v_mfma_f32_32x32x16_bf16 v[80:95], a[172:175], v[188:191], v[80:95]
    v_mfma_f32_32x32x16_bf16 v[48:63], a[172:175], v[184:187], v[48:63]
    v_mfma_f32_32x32x16_bf16 v[32:47], a[60:63], v[184:187], v[32:47]
    s_waitcnt vmcnt(16)
    v_cmp_gt_u32 vcc, s62, v19
    s_nop 1
    s_cbranch_vccnz hwait_170
hok_169:
    s_add_u32 s48, s36, 4096
    buffer_load_dwordx4 v[116:119], v1, s[8:11], s48 offen sc1
    s_add_u32 s48, s35, 4096
    buffer_load_dwordx4 v[112:115], v1, s[8:11], s48 offen sc1
    v_mfma_f32_32x32x16_bf16 v[64:79], a[64:67], v[196:199], v[64:79]
    v_mfma_f32_32x32x16_bf16 v[80:95], a[176:179], v[196:199], v[80:95]
    v_mfma_f32_32x32x16_bf16 v[48:63], a[176:179], v[192:195], v[48:63]
    v_mfma_f32_32x32x16_bf16 v[32:47], a[64:67], v[192:195], v[32:47]
    s_add_u32 s48, s36, 5120
    buffer_load_dwordx4 v[124:127], v1, s[8:11], s48 offen sc1
    s_add_u32 s48, s35, 5120
    buffer_load_dwordx4 v[120:123], v1, s[8:11], s48 offen sc1
    v_mfma_f32_32x32x16_bf16 v[64:79], a[68:71], v[204:207], v[64:79]
    v_mfma_f32_32x32x16_bf16 v[80:95], a[180:183], v[204:207], v[80:95]
    v_mfma_f32_32x32x16_bf16 v[48:63], a[180:183], v[200:203], v[48:63]
    v_mfma_f32_32x32x16_bf16 v[32:47], a[68:71], v[200:203], v[32:47]
    s_add_u32 s48, s36, 11264
    buffer_load_dwordx4 v[132:135], v1, s[8:11], s48 offen sc1
    s_add_u32 s48, s35, 11264
    buffer_load_dwordx4 v[128:131], v1, s[8:11], s48 offen sc1
    v_mfma_f32_32x32x16_bf16 v[64:79], a[84:87], v[212:215], v[64:79]
    v_mfma_f32_32x32x16_bf16 v[80:95], a[196:199], v[212:215], v[80:95]
    v_mfma_f32_32x32x16_bf16 v[48:63], a[196:199], v[208:211], v[48:63]
    v_mfma_f32_32x32x16_bf16 v[32:47], a[84:87], v[208:211], v[32:47]
    s_add_u32 s48, s36, 12288
    buffer_load_dwordx4 v[140:143], v1, s[8:11], s48 offen sc1
    s_add_u32 s48, s35, 12288
    buffer_load_dwordx4 v[136:139], v1, s[8:11], s48 offen sc1
    s_waitcnt vmcnt(22)
    v_mfma_f32_32x32x16_bf16 v[64:79], a[88:91], v[220:223], v[64:79]
    s_waitcnt vmcnt(17)
    v_add_f32 v144, v144, v146
    v_add_f32 v145, v145, v147
    s_waitcnt vmcnt(16)
    v_add_f32 v144, v144, v148
    v_add_f32 v145, v145, v149
    v_mfma_f32_32x32x16_bf16 v[80:95], a[200:203], v[220:223], v[80:95]
    s_waitcnt vmcnt(15)
    v_add_f32 v144, v144, v150
    v_add_f32 v145, v145, v151
    s_waitcnt vmcnt(14)
    v_add_f32 v144, v144, v152
    v_mfma_f32_32x32x16_bf16 v[48:63], a[200:203], v[216:219], v[48:63]
    v_add_f32 v145, v145, v153
    s_waitcnt vmcnt(13)
    v_add_f32 v144, v144, v154
    v_add_f32 v145, v145, v155
    s_waitcnt vmcnt(12)
    v_add_f32 v144, v144, v156
    v_mfma_f32_32x32x16_bf16 v[32:47], a[88:91], v[216:219], v[32:47]
    s_add_u32 s48, s36, 18432
    buffer_load_dwordx4 v[164:167], v1, s[8:11], s48 offen sc1
    s_add_u32 s48, s35, 18432
    buffer_load_dwordx4 v[160:163], v1, s[8:11], s48 offen sc1
    buffer_load_dword v19, v10, s[8:11], s34 offen sc1
    s_waitcnt vmcnt(14)
    v_mfma_f32_32x32x16_bf16 v[64:79], a[92:95], v[100:103], v[64:79]
    v_add_f32 v145, v145, v157
    v_mov_b32 v22, v144
    v_mov_b32 v23, v145
    s_nop 0
    v_permlane32_swap_b32 v144, v22
    v_permlane32_swap_b32 v145, v23
    v_mfma_f32_32x32x16_bf16 v[80:95], a[204:207], v[100:103], v[80:95]
    v_add_f32 v144, v144, v22
    v_add_f32 v145, v145, v23
    v_mul_f32 v144, 3138537765, v144
    v_mul_f32 v145, 991054117, v145
    v_fma_f32 v145, -v144, v144, v145
    s_waitcnt vmcnt(13)
    v_mfma_f32_32x32x16_bf16 v[48:63], a[204:207], v[96:99], v[48:63]
    v_max_f32 v145, 0, v145
    v_cvt_pk_bf16_f32 v20, v144, v144
    v_cvt_pk_bf16_f32 v23, v145, v145
    v_and_b32 v23, 0xffff0000, v23
    v_add_f32 v23, 925353388, v23
    v_cvt_pk_bf16_f32 v23, v23, v23
    v_mfma_f32_32x32x16_bf16 v[32:47], a[92:95], v[96:99], v[32:47]
    v_and_b32 v23, 0xffff0000, v23
    s_add_u32 s48, s36, 19456
    buffer_load_dwordx4 v[172:175], v1, s[8:11], s48 offen sc1
    s_add_u32 s48, s35, 19456
    buffer_load_dwordx4 v[168:171], v1, s[8:11], s48 offen sc1
    s_waitcnt vmcnt(14)
    v_mfma_f32_32x32x16_bf16 v[64:79], a[96:99], v[108:111], v[64:79]
    v_sqrt_f32 v23, v23
    s_nop 0
    v_cvt_pk_bf16_f32 v23, v23, v23
    v_and_b32 v23, 0xffff0000, v23
    v_mfma_f32_32x32x16_bf16 v[80:95], a[208:211], v[108:111], v[80:95]
    v_rcp_f32 v21, v23
    s_nop 0
    v_mul_f32 v28, v21, v21
    v_mul_f32 v29, v21, v21
    s_waitcnt vmcnt(13)
    v_mfma_f32_32x32x16_bf16 v[48:63], a[208:211], v[104:107], v[48:63]
    v_lshlrev_b32 v240, 16, v232
    v_and_b32 v241, 0xffff0000, v232
    v_lshlrev_b32 v242, 16, v233
    v_and_b32 v243, 0xffff0000, v233
    v_lshlrev_b32 v244, 16, v234
    v_and_b32 v245, 0xffff0000, v234
    v_mfma_f32_32x32x16_bf16 v[32:47], a[96:99], v[104:107], v[32:47]
    v_lshlrev_b32 v246, 16, v235
    s_add_u32 s48, s36, 25600
    buffer_load_dwordx4 v[180:183], v1, s[8:11], s48 offen sc1
    s_add_u32 s48, s35, 25600
    buffer_load_dwordx4 v[176:179], v1, s[8:11], s48 offen sc1
    s_waitcnt vmcnt(14)
    v_mfma_f32_32x32x16_bf16 v[64:79], a[16:19], v[116:119], v[64:79]
    v_and_b32 v247, 0xffff0000, v235
    v_lshlrev_b32 v248, 16, v236
    v_and_b32 v249, 0xffff0000, v236
    v_lshlrev_b32 v250, 16, v237
    v_and_b32 v251, 0xffff0000, v237
    v_lshlrev_b32 v252, 16, v238
    v_mfma_f32_32x32x16_bf16 v[80:95], a[128:131], v[116:119], v[80:95]
    v_and_b32 v253, 0xffff0000, v238
    v_lshlrev_b32 v254, 16, v239
    v_and_b32 v255, 0xffff0000, v239
    s_waitcnt vmcnt(13)
    v_mfma_f32_32x32x16_bf16 v[48:63], a[128:131], v[112:115], v[48:63]
    s_mul_i32 s51, s3, 12288
    s_add_u32 s51, s51, 86016
    v_add_u32 v25, s51, v1
    s_lshl_b32 s53, s55, 7
    s_lshl_b32 s49, s54, 2
    s_add_u32 s53, s53, s49
    s_add_u32 s53, s53, 0
    v_mfma_f32_32x32x16_bf16 v[32:47], a[16:19], v[112:115], v[32:47]
    s_add_u32 s48, s36, 26624
    buffer_load_dwordx4 v[188:191], v1, s[8:11], s48 offen sc1
    s_add_u32 s48, s35, 26624
    buffer_load_dwordx4 v[184:187], v1, s[8:11], s48 offen sc1
    s_waitcnt vmcnt(14)
    v_mfma_f32_32x32x16_bf16 v[64:79], a[20:23], v[124:127], v[64:79]
    v_mfma_f32_32x32x16_bf16 v[80:95], a[132:135], v[124:127], v[80:95]
    s_waitcnt vmcnt(13)
    v_mfma_f32_32x32x16_bf16 v[48:63], a[132:135], v[120:123], v[48:63]
    v_mfma_f32_32x32x16_bf16 v[32:47], a[20:23], v[120:123], v[32:47]
    s_waitcnt vmcnt(6)
    v_cmp_gt_u32 vcc, s0, v19
    s_nop 1
    s_cbranch_vccnz hwait_174
hok_173:
    s_add_u32 s48, s36, 6144
    buffer_load_dwordx4 v[196:199], v1, s[8:11], s48 offen sc1
    s_add_u32 s48, s35, 6144
    buffer_load_dwordx4 v[192:195], v1, s[8:11], s48 offen sc1
    v_mfma_f32_32x32x16_bf16 v[64:79], a[44:47], v[132:135], v[64:79]
    v_mfma_f32_32x32x16_bf16 v[80:95], a[156:159], v[132:135], v[80:95]
    v_mfma_f32_32x32x16_bf16 v[48:63], a[156:159], v[128:131], v[48:63]
    v_mfma_f32_32x32x16_bf16 v[32:47], a[44:47], v[128:131], v[32:47]
    s_add_u32 s48, s36, 13312
    buffer_load_dwordx4 v[204:207], v1, s[8:11], s48 offen sc1
    s_add_u32 s48, s35, 13312
    buffer_load_dwordx4 v[200:203], v1, s[8:11], s48 offen sc1
    v_mfma_f32_32x32x16_bf16 v[64:79], a[48:51], v[140:143], v[64:79]
    v_mfma_f32_32x32x16_bf16 v[80:95], a[160:163], v[140:143], v[80:95]
    v_mfma_f32_32x32x16_bf16 v[48:63], a[160:163], v[136:139], v[48:63]
    v_mfma_f32_32x32x16_bf16 v[32:47], a[48:51], v[136:139], v[32:47]
    s_add_u32 s48, s36, 20480
    buffer_load_dwordx4 v[212:215], v1, s[8:11], s48 offen sc1
    s_add_u32 s48, s35, 20480
    buffer_load_dwordx4 v[208:211], v1, s[8:11], s48 offen sc1
    v_mfma_f32_32x32x16_bf16 v[64:79], a[72:75], v[164:167], v[64:79]
    v_mfma_f32_32x32x16_bf16 v[80:95], a[184:187], v[164:167], v[80:95]
    v_mfma_f32_32x32x16_bf16 v[48:63], a[184:187], v[160:163], v[48:63]
    v_mfma_f32_32x32x16_bf16 v[32:47], a[72:75], v[160:163], v[32:47]
    s_add_u32 s48, s36, 27648
    buffer_load_dwordx4 v[220:223], v1, s[8:11], s48 offen sc1
    s_add_u32 s48, s35, 27648
    buffer_load_dwordx4 v[216:219], v1, s[8:11], s48 offen sc1
    s_waitcnt vmcnt(13)
    v_mfma_f32_32x32x16_bf16 v[64:79], a[76:79], v[172:175], v[64:79]
    v_mfma_f32_32x32x16_bf16 v[80:95], a[188:191], v[172:175], v[80:95]
    s_waitcnt vmcnt(12)
    v_mfma_f32_32x32x16_bf16 v[48:63], a[188:191], v[168:171], v[48:63]
    s_barrier
    v_mfma_f32_32x32x16_bf16 v[32:47], a[76:79], v[168:171], v[32:47]
    s_waitcnt vmcnt(11)
    v_mfma_f32_32x32x16_bf16 v[64:79], a[100:103], v[180:183], v[64:79]
    s_cmp_lg_u32 s7, 0
    s_cbranch_scc1 sk_177
    s_add_u32 m0, s28, 0
    s_add_u32 s24, s27, 0
    buffer_load_dwordx4 v1, s[8:11], s24 offen offset:0 lds
    buffer_load_dwordx4 v1, s[8:11], s24 offen offset:1024 lds
    buffer_load_dwordx4 v1, s[8:11], s24 offen offset:2048 lds
    buffer_load_dwordx4 v1, s[8:11], s24 offen offset:3072 lds
sk_177:
    v_mfma_f32_32x32x16_bf16 v[80:95], a[212:215], v[180:183], v[80:95]
    s_waitcnt vmcnt(10)
    v_mfma_f32_32x32x16_bf16 v[48:63], a[212:215], v[176:179], v[48:63]
    s_cmp_lg_u32 s7, 0
    s_cbranch_scc1 sk_178
    s_add_u32 m0, s28, 4096
    s_add_u32 s24, s27, 4096
    buffer_load_dwordx4 v1, s[8:11], s24 offen offset:0 lds
    buffer_load_dwordx4 v1, s[8:11], s24 offen offset:1024 lds
    buffer_load_dwordx4 v1, s[8:11], s24 offen offset:2048 lds
    buffer_load_dwordx4 v1, s[8:11], s24 offen offset:3072 lds
sk_178:
    v_mfma_f32_32x32x16_bf16 v[32:47], a[100:103], v[176:179], v[32:47]
    s_waitcnt vmcnt(9)
    v_mfma_f32_32x32x16_bf16 v[64:79], a[104:107], v[188:191], v[64:79]
    s_cmp_lg_u32 s7, 0
    s_cbranch_scc1 sk_179
    s_add_u32 m0, s28, 8192
    s_add_u32 s24, s27, 8192
    buffer_load_dwordx4 v1, s[8:11], s24 offen offset:0 lds
    buffer_load_dwordx4 v1, s[8:11], s24 offen offset:1024 lds
    buffer_load_dwordx4 v1, s[8:11], s24 offen offset:2048 lds
    buffer_load_dwordx4 v1, s[8:11], s24 offen offset:3072 lds
sk_179:
    v_mfma_f32_32x32x16_bf16 v[80:95], a[216:219], v[188:191], v[80:95]
    s_waitcnt vmcnt(8)
    v_mfma_f32_32x32x16_bf16 v[48:63], a[216:219], v[184:187], v[48:63]
    s_cmp_lg_u32 s7, 0
    s_cbranch_scc1 sk_180
    s_add_u32 m0, s28, 12288
    s_add_u32 s24, s27, 12288
    buffer_load_dwordx4 v1, s[8:11], s24 offen offset:0 lds
    buffer_load_dwordx4 v1, s[8:11], s24 offen offset:1024 lds
    buffer_load_dwordx4 v1, s[8:11], s24 offen offset:2048 lds
    buffer_load_dwordx4 v1, s[8:11], s24 offen offset:3072 lds
sk_180:
    s_waitcnt vmcnt(7)
    v_mfma_f32_32x32x16_bf16 v[64:79], a[24:27], v[196:199], v[64:79]
    v_mfma_f32_32x32x16_bf16 v[80:95], a[136:139], v[196:199], v[80:95]
    s_cmp_lg_u32 s7, 0
    s_cbranch_scc1 sk_181
    s_add_u32 m0, s28, 16384
    s_add_u32 s24, s27, 16384
    buffer_load_dwordx4 v1, s[8:11], s24 offen offset:0 lds
    buffer_load_dwordx4 v1, s[8:11], s24 offen offset:1024 lds
    buffer_load_dwordx4 v1, s[8:11], s24 offen offset:2048 lds
    buffer_load_dwordx4 v1, s[8:11], s24 offen offset:3072 lds
sk_181:
    s_waitcnt vmcnt(6)
    v_mfma_f32_32x32x16_bf16 v[48:63], a[136:139], v[192:195], v[48:63]
    s_waitcnt vmcnt(5)
    v_mfma_f32_32x32x16_bf16 v[64:79], a[52:55], v[204:207], v[64:79]
    s_cmp_lg_u32 s7, 0
    s_cbranch_scc1 sk_182
    s_add_u32 m0, s28, 20480
    s_add_u32 s24, s27, 20480
    buffer_load_dwordx4 v1, s[8:11], s24 offen offset:0 lds
sk_182:
    v_mfma_f32_32x32x16_bf16 v[80:95], a[164:167], v[204:207], v[80:95]
    s_waitcnt vmcnt(4)
    v_mfma_f32_32x32x16_bf16 v[48:63], a[164:167], v[200:203], v[48:63]
    s_waitcnt vmcnt(3)
    v_mfma_f32_32x32x16_bf16 v[64:79], a[80:83], v[212:215], v[64:79]
    v_mfma_f32_32x32x16_bf16 v[80:95], a[192:195], v[212:215], v[80:95]
    s_waitcnt vmcnt(2)
    v_mfma_f32_32x32x16_bf16 v[48:63], a[192:195], v[208:211], v[48:63]
    s_waitcnt vmcnt(1)
    v_mfma_f32_32x32x16_bf16 v[64:79], a[108:111], v[220:223], v[64:79]
    v_mfma_f32_32x32x16_bf16 v[80:95], a[220:223], v[220:223], v[80:95]
    s_waitcnt vmcnt(0)
    v_mfma_f32_32x32x16_bf16 v[48:63], a[220:223], v[216:219], v[48:63]
    v_mfma_f32_32x32x16_bf16 v[32:47], a[104:107], v[184:187], v[32:47]
    s_xor_b32 s48, s3, 2
    s_mul_i32 s48, s48, 12288
    s_add_u32 s48, s48, 90112
    v_add_u32 v23, s48, v1
    s_nop 3
    ds_write_b128 v23, v[64:67] offset:0
    v_mfma_f32_32x32x16_bf16 v[32:47], a[24:27], v[192:195], v[32:47]
    ds_write_b128 v23, v[68:71] offset:1024
    ds_write_b128 v23, v[72:75] offset:2048
    ds_write_b128 v23, v[76:79] offset:3072
    v_mfma_f32_32x32x16_bf16 v[32:47], a[52:55], v[200:203], v[32:47]
    s_xor_b32 s48, s3, 3
    s_mul_i32 s48, s48, 12288
    s_add_u32 s48, s48, 94208
    v_add_u32 v24, s48, v1
    ds_write_b128 v24, v[80:83] offset:0
    v_mfma_f32_32x32x16_bf16 v[32:47], a[80:83], v[208:211], v[32:47]
    ds_write_b128 v24, v[84:87] offset:1024
    ds_write_b128 v24, v[88:91] offset:2048
    ds_write_b128 v24, v[92:95] offset:3072
    v_mfma_f32_32x32x16_bf16 v[32:47], a[108:111], v[216:219], v[32:47]
    s_xor_b32 s48, s3, 1
    s_mul_i32 s48, s48, 12288
    s_add_u32 s48, s48, 86016
    v_add_u32 v22, s48, v1
    ds_write_b128 v22, v[48:51] offset:0
    ds_write_b128 v22, v[52:55] offset:1024
    ds_write_b128 v22, v[56:59] offset:2048
    ds_write_b128 v22, v[60:63] offset:3072
    s_waitcnt lgkmcnt(0)
    s_barrier
    ds_read_b128 v[48:51], v25 offset:0
    ds_read_b128 v[64:67], v25 offset:4096
    ds_read_b128 v[80:83], v25 offset:8192
    ds_read_b128 v[52:55], v25 offset:1024
    ds_read_b128 v[68:71], v25 offset:5120
    ds_read_b128 v[84:87], v25 offset:9216
    ds_read_b128 v[56:59], v25 offset:2048
    ds_read_b128 v[72:75], v25 offset:6144
    ds_read_b128 v[88:91], v25 offset:10240
    ds_read_b128 v[60:63], v25 offset:3072
    ds_read_b128 v[76:79], v25 offset:7168
    ds_read_b128 v[92:95], v25 offset:11264
    s_waitcnt lgkmcnt(9)
    v_pk_add_f32 v[48:49], v[48:49], v[64:65]
    v_pk_add_f32 v[32:33], v[32:33], v[80:81]
    v_pk_add_f32 v[50:51], v[50:51], v[66:67]
    v_pk_add_f32 v[34:35], v[34:35], v[82:83]
    v_pk_add_f32 v[32:33], v[32:33], v[48:49]
    v_pk_add_f32 v[34:35], v[34:35], v[50:51]
    v_pk_fma_f32 v[32:33], v[32:33], v[28:29], v[240:241]
    v_pk_fma_f32 v[34:35], v[34:35], v[28:29], v[242:243]
    v_cvt_pk_bf16_f32 v232, v32, v33
    v_cvt_pk_bf16_f32 v233, v34, v35
    s_waitcnt lgkmcnt(6)
    v_pk_add_f32 v[52:53], v[52:53], v[68:69]
    v_pk_add_f32 v[36:37], v[36:37], v[84:85]
    v_pk_add_f32 v[54:55], v[54:55], v[70:71]
    v_pk_add_f32 v[38:39], v[38:39], v[86:87]
    v_pk_add_f32 v[36:37], v[36:37], v[52:53]
    v_pk_add_f32 v[38:39], v[38:39], v[54:55]
    v_pk_fma_f32 v[36:37], v[36:37], v[28:29], v[244:245]
    v_pk_fma_f32 v[38:39], v[38:39], v[28:29], v[246:247]
    v_cvt_pk_bf16_f32 v234, v36, v37
    v_cvt_pk_bf16_f32 v235, v38, v39
    s_waitcnt lgkmcnt(3)
    v_pk_add_f32 v[56:57], v[56:57], v[72:73]
    v_pk_add_f32 v[40:41], v[40:41], v[88:89]
    v_pk_add_f32 v[58:59], v[58:59], v[74:75]
    v_pk_add_f32 v[42:43], v[42:43], v[90:91]
    v_pk_add_f32 v[40:41], v[40:41], v[56:57]
    v_pk_add_f32 v[42:43], v[42:43], v[58:59]
    v_pk_fma_f32 v[40:41], v[40:41], v[28:29], v[248:249]
    v_pk_fma_f32 v[42:43], v[42:43], v[28:29], v[250:251]
    v_cvt_pk_bf16_f32 v236, v40, v41
    v_cvt_pk_bf16_f32 v237, v42, v43
    s_waitcnt lgkmcnt(0)
    v_pk_add_f32 v[60:61], v[60:61], v[76:77]
    v_pk_add_f32 v[44:45], v[44:45], v[92:93]
    v_pk_add_f32 v[62:63], v[62:63], v[78:79]
    v_pk_add_f32 v[46:47], v[46:47], v[94:95]
    v_pk_add_f32 v[44:45], v[44:45], v[60:61]
    v_pk_add_f32 v[46:47], v[46:47], v[62:63]
    v_pk_fma_f32 v[44:45], v[44:45], v[28:29], v[252:253]
    v_pk_fma_f32 v[46:47], v[46:47], v[28:29], v[254:255]
    v_cvt_pk_bf16_f32 v238, v44, v45
    v_cvt_pk_bf16_f32 v239, v46, v47
    s_cmp_eq_u32 s7, 1
    s_cbranch_scc1 MAIN_fin
    buffer_store_dwordx4 v[232:235], v1, s[8:11], s101 offen sc1
    buffer_store_dwordx4 v[236:239], v1, s[8:11], s101 offen offset:1024 sc1
    v_mov_b32 v22, 0
    v_mov_b32 v23, 0
    v_dot2_f32_bf16 v22, v232, v8, v22
    v_dot2_f32_bf16 v23, v232, v232, v23
    v_dot2_f32_bf16 v22, v233, v8, v22
    v_dot2_f32_bf16 v23, v233, v233, v23
    v_dot2_f32_bf16 v22, v234, v8, v22
    v_dot2_f32_bf16 v23, v234, v234, v23
    v_dot2_f32_bf16 v22, v235, v8, v22
    v_dot2_f32_bf16 v23, v235, v235, v23
    v_dot2_f32_bf16 v22, v236, v8, v22
    v_dot2_f32_bf16 v23, v236, v236, v23
    v_dot2_f32_bf16 v22, v237, v8, v22
    v_dot2_f32_bf16 v23, v237, v237, v23
    v_dot2_f32_bf16 v22, v238, v8, v22
    v_dot2_f32_bf16 v23, v238, v238, v23
    v_dot2_f32_bf16 v22, v239, v8, v22
    v_dot2_f32_bf16 v23, v239, v239, v23
    s_nop 2
    v_permlane32_swap_b32 v22, v23
    v_add_f32 v22, v22, v23
    buffer_store_dword v22, v5, s[8:11], s1 offen sc1
    v_mov_b32 v18, 1
    s_waitcnt vmcnt(0)
    s_mov_b64 exec, 1
    buffer_store_dword v18, v11, s[8:11], s53 offen sc1
    s_mov_b64 exec, -1
p5_join_168:
    s_waitcnt vmcnt(0) lgkmcnt(0)
    s_barrier
    s_mov_b32 s7, 1
    s_mov_b32 s44, 2
    s_mov_b32 s39, 40071168
    s_mov_b32 s42, 38236160
    s_mov_b32 s40, 42135552
    s_mov_b32 s43, 421888
    s_mov_b32 s37, 15429632
    s_mov_b32 s38, 34304000
    s_mov_b32 s41, 26963968
    s_lshl_b32 s100, s5, 6
    s_add_u32 s100, s100, s6
    s_lshl_b32 s100, s100, 11
    s_add_u32 s100, s100, s38
    s_mul_i32 s61, s6, 112
    s_mul_i32 s53, s5, 7
    s_add_u32 s61, s61, s53
    s_lshl_b32 s61, s61, 10
    s_add_u32 s61, s61, s41
    s_mul_i32 s101, s55, 28
    s_lshl_b32 s49, s54, 1
    s_add_u32 s101, s101, s49
    s_lshl_b32 s101, s101, 10
    s_add_u32 s101, s101, s39
    s_mul_i32 s1, s55, 14
    s_add_u32 s1, s1, s54
    s_lshl_b32 s1, s1, 8
    s_add_u32 s1, s1, s40
    s_lshl_b32 s52, s6, 7
    s_add_u32 s52, s52, 0
    s_mul_i32 s51, s6, 28672
    s_add_u32 s51, s51, s42
    ds_read_b128 v[192:195], v1 offset:28672
    ds_read_b128 v[196:199], v7 offset:0
    ds_read_b128 v[200:203], v1 offset:0
    ds_read_b128 v[204:207], v1 offset:29696
    v_min_u32 v19, 15, v2
    v_lshlrev_b32 v19, 7, v19
    s_add_u32 s0, s100, 0
    buffer_load_dword v0, v19, s[8:11], s0 offen sc1
    s_mov_b32 s47, 0
poll_183:
    buffer_load_dword v18, v9, s[8:11], s52 offen sc1
    s_add_u32 s47, s47, 1
    s_cmp_gt_u32 s47, 400000
    s_cbranch_scc1 polled_184
    s_waitcnt vmcnt(0)
    v_cmp_gt_u32 vcc, 1, v18
    s_nop 1
    s_cbranch_vccnz poll_183
polled_184:
    s_waitcnt vmcnt(0)
    s_add_u32 s50, s51, 0
    buffer_load_dwordx4 v[32:35], v1, s[8:11], s50 offen offset:0 sc1
    buffer_load_dwordx4 v[36:39], v1, s[8:11], s50 offen offset:1024 sc1
    buffer_load_dwordx4 v[40:43], v1, s[8:11], s50 offen offset:2048 sc1
    buffer_load_dwordx4 v[44:47], v1, s[8:11], s50 offen offset:3072 sc1
    s_mul_i32 s48, s6, 3584
    s_add_u32 s48, s48, s43
    buffer_load_dwordx2 v[216:217], v6, s[8:11], s48 offen offset:0 sc1
    buffer_load_dwordx2 v[218:219], v6, s[8:11], s48 offen offset:256 sc1
    buffer_load_dwordx2 v[220:221], v6, s[8:11], s48 offen offset:512 sc1
    buffer_load_dwordx2 v[222:223], v6, s[8:11], s48 offen offset:768 sc1
    buffer_load_dwordx2 v[224:225], v6, s[8:11], s48 offen offset:1024 sc1
    buffer_load_dwordx2 v[226:227], v6, s[8:11], s48 offen offset:1280 sc1
    buffer_load_dwordx2 v[228:229], v6, s[8:11], s48 offen offset:1536 sc1
    s_add_u32 s50, s51, 4096
    buffer_load_dwordx4 v[48:51], v1, s[8:11], s50 offen offset:0 sc1
    buffer_load_dwordx4 v[52:55], v1, s[8:11], s50 offen offset:1024 sc1
    buffer_load_dwordx4 v[56:59], v1, s[8:11], s50 offen offset:2048 sc1
    buffer_load_dwordx4 v[60:63], v1, s[8:11], s50 offen offset:3072 sc1
    s_add_u32 s50, s51, 8192
    buffer_load_dwordx4 v[64:67], v1, s[8:11], s50 offen offset:0 sc1
    buffer_load_dwordx4 v[68:71], v1, s[8:11], s50 offen offset:1024 sc1
    ds_read_b128 v[208:211], v7 offset:1024
    buffer_load_dwordx4 v[72:75], v1, s[8:11], s50 offen offset:2048 sc1
    s_waitcnt lgkmcnt(3)
    s_waitcnt vmcnt(17)
    v_mfma_f32_32x32x16_bf16 v[160:175], v[192:195], v[32:35], 0
    ds_read_b128 v[212:215], v1 offset:1024
    v_mfma_f32_32x32x16_bf16 v[176:191], v[32:35], v[196:199], 0
    ds_read_b128 v[192:195], v1 offset:30720
    s_waitcnt lgkmcnt(3)
    v_mfma_f32_32x32x16_bf16 v[144:159], v[200:203], v[32:35], 0
    ds_read_b128 v[196:199], v7 offset:2048
    buffer_load_dwordx4 v[76:79], v1, s[8:11], s50 offen offset:3072 sc1
    s_waitcnt vmcnt(17)
    v_mfma_f32_32x32x16_bf16 v[160:175], v[204:207], v[36:39], v[160:175]
    ds_read_b128 v[200:203], v1 offset:2048
    s_waitcnt lgkmcnt(3)
    v_mfma_f32_32x32x16_bf16 v[176:191], v[36:39], v[208:211], v[176:191]
    ds_read_b128 v[204:207], v1 offset:31744
    v_mfma_f32_32x32x16_bf16 v[144:159], v[212:215], v[36:39], v[144:159]
    ds_read_b128 v[208:211], v7 offset:3072
    s_add_u32 s50, s51, 12288
    buffer_load_dwordx4 v[80:83], v1, s[8:11], s50 offen offset:0 sc1
    s_waitcnt lgkmcnt(3)
    s_waitcnt vmcnt(17)
    v_mfma_f32_32x32x16_bf16 v[160:175], v[192:195], v[40:43], v[160:175]
    ds_read_b128 v[212:215], v1 offset:3072
    v_mfma_f32_32x32x16_bf16 v[176:191], v[40:43], v[196:199], v[176:191]
    ds_read_b128 v[192:195], v1 offset:32768
    s_waitcnt lgkmcnt(3)
    v_mfma_f32_32x32x16_bf16 v[144:159], v[200:203], v[40:43], v[144:159]
    s_waitcnt vmcnt(14)
    v_add_f32 v216, v216, v218
    v_add_f32 v217, v217, v219
    ds_read_b128 v[196:199], v7 offset:4096
    buffer_load_dwordx4 v[84:87], v1, s[8:11], s50 offen offset:1024 sc1
    v_mfma_f32_32x32x16_bf16 v[160:175], v[204:207], v[44:47], v[160:175]
    s_waitcnt vmcnt(14)
    v_add_f32 v216, v216, v220
    v_add_f32 v217, v217, v221
    s_waitcnt vmcnt(13)
    v_add_f32 v216, v216, v222
    ds_read_b128 v[200:203], v1 offset:4096
    s_waitcnt lgkmcnt(3)
    v_mfma_f32_32x32x16_bf16 v[176:191], v[44:47], v[208:211], v[176:191]
    v_add_f32 v217, v217, v223
    s_waitcnt vmcnt(12)
    v_add_f32 v216, v216, v224
    v_add_f32 v217, v217, v225
    s_waitcnt vmcnt(11)
    v_add_f32 v216, v216, v226
    ds_read_b128 v[204:207], v1 offset:33792
    v_mfma_f32_32x32x16_bf16 v[144:159], v[212:215], v[44:47], v[144:159]
    v_add_f32 v217, v217, v227
    s_waitcnt vmcnt(10)
    v_add_f32 v216, v216, v228
    ds_read_b128 v[208:211], v7 offset:5120
    buffer_load_dwordx4 v[88:91], v1, s[8:11], s50 offen offset:2048 sc1
    s_waitcnt lgkmcnt(3)
    s_waitcnt vmcnt(10)
    v_mfma_f32_32x32x16_bf16 v[160:175], v[192:195], v[48:51], v[160:175]
    v_add_f32 v217, v217, v229
    v_mov_b32 v22, v216
    v_mov_b32 v23, v217
    s_nop 0
    v_permlane32_swap_b32 v216, v22
    ds_read_b128 v[212:215], v1 offset:5120
    v_mfma_f32_32x32x16_bf16 v[176:191], v[48:51], v[196:199], v[176:191]
    v_permlane32_swap_b32 v217, v23
    v_add_f32 v216, v216, v22
    v_add_f32 v217, v217, v23
    v_mul_f32 v216, 3138537765, v216
    ds_read_b128 v[192:195], v1 offset:34816
    s_waitcnt lgkmcnt(3)
    v_mfma_f32_32x32x16_bf16 v[144:159], v[200:203], v[48:51], v[144:159]
    v_mul_f32 v217, 991054117, v217
    v_fma_f32 v217, -v216, v216, v217
    v_max_f32 v217, 0, v217
    ds_read_b128 v[196:199], v7 offset:6144
    buffer_load_dwordx4 v[92:95], v1, s[8:11], s50 offen offset:3072 sc1
    s_waitcnt vmcnt(10)
    v_mfma_f32_32x32x16_bf16 v[160:175], v[204:207], v[52:55], v[160:175]
    v_cvt_pk_bf16_f32 v20, v216, v216
    v_cvt_pk_bf16_f32 v23, v217, v217
    v_and_b32 v23, 0xffff0000, v23
    v_add_f32 v23, 925353388, v23
    ds_read_b128 v[200:203], v1 offset:35840
    s_waitcnt lgkmcnt(3)
    v_mfma_f32_32x32x16_bf16 v[176:191], v[52:55], v[208:211], v[176:191]
    v_cvt_pk_bf16_f32 v23, v23, v23
    v_and_b32 v23, 0xffff0000, v23
    v_sqrt_f32 v23, v23
    s_nop 0
    v_cvt_pk_bf16_f32 v23, v23, v23
    ds_read_b128 v[204:207], v7 offset:7168
    v_mfma_f32_32x32x16_bf16 v[144:159], v[212:215], v[52:55], v[144:159]
    v_and_b32 v23, 0xffff0000, v23
    ds_read_b128 v[208:211], v1 offset:36864
    s_add_u32 s50, s51, 16384
    buffer_load_dwordx4 v[96:99], v1, s[8:11], s50 offen offset:0 sc1
    s_waitcnt lgkmcnt(3)
    s_waitcnt vmcnt(10)
    v_mfma_f32_32x32x16_bf16 v[160:175], v[192:195], v[56:59], v[160:175]
    v_rcp_f32 v21, v23
    v_mov_b32 v28, v20
    v_mov_b32 v29, v20
    v_mov_b32 v30, v20
    ds_read_b128 v[212:215], v7 offset:8192
    v_mfma_f32_32x32x16_bf16 v[176:191], v[56:59], v[196:199], v[176:191]
    v_mov_b32 v31, v20
    s_lshl_b32 s48, s3, 8
    ds_read_b128 v[192:195], v1 offset:37888
    buffer_load_dwordx4 v[100:103], v1, s[8:11], s50 offen offset:1024 sc1
    s_waitcnt lgkmcnt(3)
    s_waitcnt vmcnt(10)
    v_mfma_f32_32x32x16_bf16 v[160:175], v[200:203], v[60:63], v[160:175]
    s_add_u32 s48, s48, 143360
    v_lshlrev_b32 v22, 2, v3
    v_add_u32 v22, s48, v22
    ds_write_b32 v22, v21
    v_lshlrev_b32 v23, 4, v4
    ds_read_b128 v[196:199], v7 offset:9216
    v_mfma_f32_32x32x16_bf16 v[176:191], v[60:63], v[204:207], v[176:191]
    v_add_u32 v23, s48, v23
    ds_read_b128 v[240:243], v23 offset:0
    ds_read_b128 v[200:203], v1 offset:38912
    buffer_load_dwordx4 v[104:107], v1, s[8:11], s50 offen offset:2048 sc1
    s_waitcnt lgkmcnt(5)
    s_waitcnt vmcnt(10)
    v_mfma_f32_32x32x16_bf16 v[160:175], v[208:211], v[64:67], v[160:175]
    ds_read_b128 v[244:247], v23 offset:32
    ds_read_b128 v[248:251], v23 offset:64
    ds_read_b128 v[252:255], v23 offset:96
    s_lshl_b32 s48, s5, 6
    s_add_u32 s48, s48, s6
    ds_read_b128 v[204:207], v7 offset:10240
    v_mfma_f32_32x32x16_bf16 v[176:191], v[64:67], v[212:215], v[176:191]
    s_lshl_b32 s52, s48, 2
    s_add_u32 s52, s52, 32768
    ds_read_b128 v[208:211], v1 offset:39936
    buffer_load_dwordx4 v[108:111], v1, s[8:11], s50 offen offset:3072 sc1
    s_waitcnt lgkmcnt(7)
    s_waitcnt vmcnt(10)
    v_mfma_f32_32x32x16_bf16 v[160:175], v[192:195], v[68:71], v[160:175]
    s_lshl_b32 s53, s48, 12
    s_add_u32 s53, s53, s37
    ds_read_b128 v[212:215], v7 offset:11264
    v_mfma_f32_32x32x16_bf16 v[176:191], v[68:71], v[196:199], v[176:191]
    ds_read_b128 v[192:195], v1 offset:40960
    s_add_u32 s50, s51, 20480
    buffer_load_dwordx4 v[112:115], v1, s[8:11], s50 offen offset:0 sc1
    s_waitcnt lgkmcnt(3)
    s_waitcnt vmcnt(10)
    v_mfma_f32_32x32x16_bf16 v[160:175], v[200:203], v[72:75], v[160:175]
    ds_read_b128 v[196:199], v7 offset:12288
    v_mfma_f32_32x32x16_bf16 v[176:191], v[72:75], v[204:207], v[176:191]
    ds_read_b128 v[200:203], v1 offset:41984
    buffer_load_dwordx4 v[116:119], v1, s[8:11], s50 offen offset:1024 sc1
    s_waitcnt lgkmcnt(3)
    s_waitcnt vmcnt(10)
    v_mfma_f32_32x32x16_bf16 v[160:175], v[208:211], v[76:79], v[160:175]
    ds_read_b128 v[204:207], v7 offset:13312
    v_mfma_f32_32x32x16_bf16 v[176:191], v[76:79], v[212:215], v[176:191]
    ds_read_b128 v[208:211], v1 offset:43008
    buffer_load_dwordx4 v[120:123], v1, s[8:11], s50 offen offset:2048 sc1
    s_waitcnt lgkmcnt(3)
    s_waitcnt vmcnt(10)
    v_mfma_f32_32x32x16_bf16 v[160:175], v[192:195], v[80:83], v[160:175]
    ds_read_b128 v[212:215], v7 offset:14336
    v_mfma_f32_32x32x16_bf16 v[176:191], v[80:83], v[196:199], v[176:191]
    ds_read_b128 v[192:195], v1 offset:44032
    buffer_load_dwordx4 v[124:127], v1, s[8:11], s50 offen offset:3072 sc1
    s_waitcnt lgkmcnt(3)
    s_waitcnt vmcnt(10)
    v_mfma_f32_32x32x16_bf16 v[160:175], v[200:203], v[84:87], v[160:175]
    ds_read_b128 v[196:199], v7 offset:15360
    v_mfma_f32_32x32x16_bf16 v[176:191], v[84:87], v[204:207], v[176:191]
    ds_read_b128 v[200:203], v1 offset:45056
    s_add_u32 s50, s51, 24576
    buffer_load_dwordx4 v[128:131], v1, s[8:11], s50 offen offset:0 sc1
    s_waitcnt lgkmcnt(3)
    s_waitcnt vmcnt(10)
    v_mfma_f32_32x32x16_bf16 v[160:175], v[208:211], v[88:91], v[160:175]
    ds_read_b128 v[204:207], v7 offset:16384
    v_mfma_f32_32x32x16_bf16 v[176:191], v[88:91], v[212:215], v[176:191]
    ds_read_b128 v[208:211], v1 offset:46080
    buffer_load_dwordx4 v[132:135], v1, s[8:11], s50 offen offset:1024 sc1
    s_waitcnt lgkmcnt(3)
    s_waitcnt vmcnt(10)
    v_mfma_f32_32x32x16_bf16 v[160:175], v[192:195], v[92:95], v[160:175]
    ds_read_b128 v[212:215], v7 offset:17408
    v_mfma_f32_32x32x16_bf16 v[176:191], v[92:95], v[196:199], v[176:191]
    ds_read_b128 v[192:195], v1 offset:47104
    buffer_load_dwordx4 v[136:139], v1, s[8:11], s50 offen offset:2048 sc1
    s_waitcnt lgkmcnt(3)
    s_waitcnt vmcnt(10)
    v_mfma_f32_32x32x16_bf16 v[160:175], v[200:203], v[96:99], v[160:175]
    ds_read_b128 v[196:199], v7 offset:18432
    v_mfma_f32_32x32x16_bf16 v[176:191], v[96:99], v[204:207], v[176:191]
    ds_read_b128 v[200:203], v1 offset:48128
    buffer_load_dwordx4 v[140:143], v1, s[8:11], s50 offen offset:3072 sc1
    s_waitcnt lgkmcnt(3)
    s_waitcnt vmcnt(10)
    v_mfma_f32_32x32x16_bf16 v[160:175], v[208:211], v[100:103], v[160:175]
    ds_read_b128 v[204:207], v7 offset:19456
    v_mfma_f32_32x32x16_bf16 v[176:191], v[100:103], v[212:215], v[176:191]
    ds_read_b128 v[208:211], v1 offset:49152
    s_waitcnt lgkmcnt(3)
    s_waitcnt vmcnt(9)
    v_mfma_f32_32x32x16_bf16 v[160:175], v[192:195], v[104:107], v[160:175]
    ds_read_b128 v[212:215], v7 offset:20480
    v_mfma_f32_32x32x16_bf16 v[176:191], v[104:107], v[196:199], v[176:191]
    ds_read_b128 v[192:195], v1 offset:50176
    s_waitcnt lgkmcnt(3)
    s_waitcnt vmcnt(8)
    v_mfma_f32_32x32x16_bf16 v[160:175], v[200:203], v[108:111], v[160:175]
    ds_read_b128 v[196:199], v7 offset:21504
    v_mfma_f32_32x32x16_bf16 v[176:191], v[108:111], v[204:207], v[176:191]
    ds_read_b128 v[200:203], v1 offset:51200
    s_waitcnt lgkmcnt(3)
    s_waitcnt vmcnt(7)
    v_mfma_f32_32x32x16_bf16 v[160:175], v[208:211], v[112:115], v[160:175]
    ds_read_b128 v[204:207], v7 offset:22528
    v_mfma_f32_32x32x16_bf16 v[176:191], v[112:115], v[212:215], v[176:191]
    ds_read_b128 v[208:211], v1 offset:52224
    s_waitcnt lgkmcnt(3)
    s_waitcnt vmcnt(6)
    v_mfma_f32_32x32x16_bf16 v[160:175], v[192:195], v[116:119], v[160:175]
    ds_read_b128 v[212:215], v7 offset:23552
    v_mfma_f32_32x32x16_bf16 v[176:191], v[116:119], v[196:199], v[176:191]
    ds_read_b128 v[192:195], v1 offset:53248
    s_waitcnt lgkmcnt(3)
    s_waitcnt vmcnt(5)
    v_mfma_f32_32x32x16_bf16 v[160:175], v[200:203], v[120:123], v[160:175]
    ds_read_b128 v[196:199], v7 offset:24576
    v_mfma_f32_32x32x16_bf16 v[176:191], v[120:123], v[204:207], v[176:191]
    ds_read_b128 v[200:203], v1 offset:54272
    s_waitcnt lgkmcnt(3)
    s_waitcnt vmcnt(4)
    v_mfma_f32_32x32x16_bf16 v[160:175], v[208:211], v[124:127], v[160:175]
    ds_read_b128 v[204:207], v7 offset:25600
    v_mfma_f32_32x32x16_bf16 v[176:191], v[124:127], v[212:215], v[176:191]
    ds_read_b128 v[208:211], v1 offset:55296
    s_waitcnt lgkmcnt(3)
    s_waitcnt vmcnt(3)
    v_mfma_f32_32x32x16_bf16 v[160:175], v[192:195], v[128:131], v[160:175]
    ds_read_b128 v[212:215], v7 offset:26624
    v_mfma_f32_32x32x16_bf16 v[176:191], v[128:131], v[196:199], v[176:191]
    ds_read_b128 v[192:195], v1 offset:56320
    s_waitcnt lgkmcnt(3)
    s_waitcnt vmcnt(2)
    v_mfma_f32_32x32x16_bf16 v[160:175], v[200:203], v[132:135], v[160:175]
    ds_read_b128 v[196:199], v7 offset:27648
    v_mfma_f32_32x32x16_bf16 v[176:191], v[132:135], v[204:207], v[176:191]
    ds_read_b128 v[200:203], v16 offset:10240
    s_waitcnt lgkmcnt(3)
    s_waitcnt vmcnt(1)
    v_mfma_f32_32x32x16_bf16 v[160:175], v[208:211], v[136:139], v[160:175]
    ds_read_b128 v[204:207], v16 offset:11264
    v_mfma_f32_32x32x16_bf16 v[176:191], v[136:139], v[212:215], v[176:191]
    ds_read_b128 v[208:211], v1 offset:6144
    s_waitcnt lgkmcnt(3)
    s_waitcnt vmcnt(0)
    v_mfma_f32_32x32x16_bf16 v[160:175], v[192:195], v[140:143], v[160:175]
    ds_read_b128 v[212:215], v1 offset:7168
    v_mfma_f32_32x32x16_bf16 v[176:191], v[140:143], v[196:199], v[176:191]
    ds_read_b128 v[192:195], v1 offset:8192
    s_waitcnt lgkmcnt(3)
    v_mfma_f32_32x32x16_bf16 v[160:175], v[200:203], v[28:31], v[160:175]
    ds_read_b128 v[196:199], v1 offset:9216
    v_mfma_f32_32x32x16_bf16 v[176:191], v[28:31], v[204:207], v[176:191]
    ds_read_b128 v[200:203], v1 offset:10240
    s_waitcnt lgkmcnt(3)
    v_mfma_f32_32x32x16_bf16 v[144:159], v[208:211], v[56:59], v[144:159]
    ds_read_b128 v[204:207], v1 offset:11264
    v_mfma_f32_32x32x16_bf16 v[144:159], v[212:215], v[60:63], v[144:159]
    s_nop 4
    v_mul_f32 v160, v21, v160
    ds_read_b128 v[208:211], v1 offset:12288
    s_waitcnt lgkmcnt(3)
    v_mfma_f32_32x32x16_bf16 v[144:159], v[192:195], v[64:67], v[144:159]
    v_mul_f32 v161, v21, v161
    v_mul_f32 v162, v21, v162
    v_mul_f32 v163, v21, v163
    v_mul_f32 v164, v21, v164
    v_mul_f32 v165, v21, v165
    ds_read_b128 v[212:215], v1 offset:13312
    v_mfma_f32_32x32x16_bf16 v[144:159], v[196:199], v[68:71], v[144:159]
    v_mul_f32 v166, v21, v166
    v_mul_f32 v167, v21, v167
    v_mul_f32 v168, v21, v168
    v_mul_f32 v169, v21, v169
    ds_read_b128 v[192:195], v1 offset:14336
    s_waitcnt lgkmcnt(3)
    v_mfma_f32_32x32x16_bf16 v[144:159], v[200:203], v[72:75], v[144:159]
    v_mul_f32 v170, v21, v170
    v_mul_f32 v171, v21, v171
    v_mul_f32 v172, v21, v172
    v_mul_f32 v173, v21, v173
    v_mul_f32 v174, v21, v174
    ds_read_b128 v[196:199], v1 offset:15360
    v_mfma_f32_32x32x16_bf16 v[144:159], v[204:207], v[76:79], v[144:159]
    v_mul_f32 v175, v21, v175
    v_cvt_pk_bf16_f32 v216, v160, v161
    v_cvt_pk_bf16_f32 v217, v162, v163
    v_cvt_pk_bf16_f32 v218, v164, v165
    ds_read_b128 v[200:203], v1 offset:16384
    s_waitcnt lgkmcnt(3)
    v_mfma_f32_32x32x16_bf16 v[144:159], v[208:211], v[80:83], v[144:159]
    v_cvt_pk_bf16_f32 v219, v166, v167
    v_cvt_pk_bf16_f32 v220, v168, v169
    v_cvt_pk_bf16_f32 v221, v170, v171
    v_cvt_pk_bf16_f32 v222, v172, v173
    v_cvt_pk_bf16_f32 v223, v174, v175
    ds_read_b128 v[204:207], v1 offset:17408
    v_mfma_f32_32x32x16_bf16 v[144:159], v[212:215], v[84:87], v[144:159]
    buffer_store_dwordx4 v[216:219], v1, s[8:11], s53 offen offset:0 sc1
    buffer_store_dwordx4 v[220:223], v1, s[8:11], s53 offen offset:1024 sc1
    ds_read_b128 v[208:211], v1 offset:18432
    s_waitcnt lgkmcnt(3)
    v_mfma_f32_32x32x16_bf16 v[144:159], v[192:195], v[88:91], v[144:159]
    v_mul_f32 v176, v240, v176
    v_mul_f32 v177, v241, v177
    v_mul_f32 v178, v242, v178
    v_mul_f32 v179, v243, v179
    v_mul_f32 v180, v244, v180
    ds_read_b128 v[212:215], v1 offset:19456
    v_mfma_f32_32x32x16_bf16 v[144:159], v[196:199], v[92:95], v[144:159]
    v_mul_f32 v181, v245, v181
    v_mul_f32 v182, v246, v182
    v_mul_f32 v183, v247, v183
    v_mul_f32 v184, v248, v184
    ds_read_b128 v[192:195], v1 offset:20480
    s_waitcnt lgkmcnt(3)
    v_mfma_f32_32x32x16_bf16 v[144:159], v[200:203], v[96:99], v[144:159]
    v_mul_f32 v185, v249, v185
    v_mul_f32 v186, v250, v186
    v_mul_f32 v187, v251, v187
    v_mul_f32 v188, v252, v188
    v_mul_f32 v189, v253, v189
    ds_read_b128 v[196:199], v1 offset:21504
    v_mfma_f32_32x32x16_bf16 v[144:159], v[204:207], v[100:103], v[144:159]
    v_mul_f32 v190, v254, v190
    v_mul_f32 v191, v255, v191
    v_cvt_pk_bf16_f32 v224, v176, v177
    v_cndmask_b32 v224, v224, v8, s[98:99]
    ds_read_b128 v[200:203], v1 offset:22528
    s_waitcnt lgkmcnt(3)
    v_mfma_f32_32x32x16_bf16 v[144:159], v[208:211], v[104:107], v[144:159]
    v_cvt_pk_bf16_f32 v225, v178, v179
    v_cndmask_b32 v225, v225, v8, s[98:99]
    v_cvt_pk_bf16_f32 v226, v180, v181
    v_cndmask_b32 v226, v226, v8, s[98:99]
    v_cvt_pk_bf16_f32 v227, v182, v183
    ds_read_b128 v[204:207], v1 offset:23552
    v_mfma_f32_32x32x16_bf16 v[144:159], v[212:215], v[108:111], v[144:159]
    v_cndmask_b32 v227, v227, v8, s[98:99]
    v_cvt_pk_bf16_f32 v228, v184, v185
    v_cndmask_b32 v228, v228, v8, s[98:99]
    v_cvt_pk_bf16_f32 v229, v186, v187
    ds_read_b128 v[208:211], v1 offset:24576
    s_waitcnt lgkmcnt(3)
    v_mfma_f32_32x32x16_bf16 v[144:159], v[192:195], v[112:115], v[144:159]
    v_cndmask_b32 v229, v229, v8, s[98:99]
    v_cvt_pk_bf16_f32 v230, v188, v189
    v_cndmask_b32 v230, v230, v8, s[98:99]
    v_cvt_pk_bf16_f32 v231, v190, v191
    v_cndmask_b32 v231, v231, v8, s[98:99]
    ds_read_b128 v[212:215], v1 offset:25600
    v_mfma_f32_32x32x16_bf16 v[144:159], v[196:199], v[116:119], v[144:159]
    buffer_store_dwordx4 v[224:227], v1, s[8:11], s53 offen offset:2048 sc1
    buffer_store_dwordx4 v[228:231], v1, s[8:11], s53 offen offset:3072 sc1
    ds_read_b128 v[192:195], v1 offset:26624
    s_waitcnt lgkmcnt(3)
    v_mfma_f32_32x32x16_bf16 v[144:159], v[200:203], v[120:123], v[144:159]
    ds_read_b128 v[196:199], v1 offset:27648
    v_mfma_f32_32x32x16_bf16 v[144:159], v[204:207], v[124:127], v[144:159]
    ds_write_b128 v12, v[216:219] offset:32768
    ds_write_b128 v12, v[220:223] offset:33792
    ds_read_b128 v[200:203], v16 offset:9216
    s_waitcnt lgkmcnt(5)
    v_mfma_f32_32x32x16_bf16 v[144:159], v[208:211], v[128:131], v[144:159]
    ds_write_b128 v12, v[224:227] offset:34816
    ds_write_b128 v12, v[228:231] offset:35840
    v_mfma_f32_32x32x16_bf16 v[144:159], v[212:215], v[132:135], v[144:159]
    s_waitcnt lgkmcnt(5)
    v_mfma_f32_32x32x16_bf16 v[144:159], v[192:195], v[136:139], v[144:159]
    v_mfma_f32_32x32x16_bf16 v[144:159], v[196:199], v[140:143], v[144:159]
    v_mov_b32 v18, 2
    s_waitcnt vmcnt(0)
    s_mov_b64 exec, 1
    buffer_store_dword v18, v11, s[8:11], s52 offen sc1
    s_mov_b64 exec, -1
    s_waitcnt lgkmcnt(2)
    v_mfma_f32_32x32x16_bf16 v[144:159], v[200:203], v[28:31], v[144:159]
    v_mul_f32 v22, 1049335798, v21
    s_nop 10
    v_pk_mul_f32 v[144:145], v[144:145], v[22:23] op_sel_hi:[1,0]
    v_pk_mul_f32 v[146:147], v[146:147], v[22:23] op_sel_hi:[1,0]
    v_pk_mul_f32 v[148:149], v[148:149], v[22:23] op_sel_hi:[1,0]
    v_pk_mul_f32 v[150:151], v[150:151], v[22:23] op_sel_hi:[1,0]
    v_pk_mul_f32 v[152:153], v[152:153], v[22:23] op_sel_hi:[1,0]
    v_pk_mul_f32 v[154:155], v[154:155], v[22:23] op_sel_hi:[1,0]
    v_pk_mul_f32 v[156:157], v[156:157], v[22:23] op_sel_hi:[1,0]
    v_pk_mul_f32 v[158:159], v[158:159], v[22:23] op_sel_hi:[1,0]
    v_cvt_pk_bf16_f32 v232, v144, v145
    v_cvt_pk_bf16_f32 v233, v146, v147
    v_cvt_pk_bf16_f32 v234, v148, v149
    v_cvt_pk_bf16_f32 v235, v150, v151
    v_cvt_pk_bf16_f32 v236, v152, v153
    v_cvt_pk_bf16_f32 v237, v154, v155
    v_cvt_pk_bf16_f32 v238, v156, v157
    v_cvt_pk_bf16_f32 v239, v158, v159
    v_mov_b32 v23, 0x3f80
    v_cndmask_b32 v238, v238, v23, s[96:97]
    s_waitcnt lgkmcnt(0)
    s_barrier
    s_branch ATT_s
A_fill_88:
    v_mov_b32 v248, 0
    v_mov_b32 v249, 0
    v_mov_b32 v250, 0
    v_mov_b32 v251, 0
    v_mov_b32 v252, 0
    v_mov_b32 v253, 0
    v_mov_b32 v255, 0
    v_mov_b32 v23, 0xf14a
    v_cndmask_b32 v254, 0, v23, s[96:97]
    v_add_u32 v22, s53, v1
    ds_write_b128 v22, v[248:251] offset:0
    ds_write_b128 v22, v[252:255] offset:1024
    ds_write_b128 v22, v[248:251] offset:2048
    ds_write_b128 v22, v[248:251] offset:3072
    ds_write_b128 v22, v[248:251] offset:4096
    ds_write_b128 v22, v[252:255] offset:5120
    ds_write_b128 v22, v[248:251] offset:6144
    ds_write_b128 v22, v[248:251] offset:7168
    s_waitcnt lgkmcnt(0)
    s_branch A_join_89
att_fb_100:
    s_nop 7
    s_nop 7
    v_mov_b32 v28, v12
    v_mov_b32 v27, v26
    s_mov_b32 s62, 0
fb1_101:
    s_nop 7
    s_nop 4
    ds_read_b128 v[96:99], v28
    ds_read_b128 v[100:103], v28 offset:1024
    ds_read_b128 v[104:107], v28 offset:2048
    ds_read_b128 v[108:111], v28 offset:3072
    s_waitcnt lgkmcnt(3)
    v_mfma_f32_32x32x16_bf16 v[32:47], v[96:99], v[232:235], 0
    s_waitcnt lgkmcnt(2)
    v_mfma_f32_32x32x16_bf16 v[32:47], v[100:103], v[236:239], v[32:47]
    s_cmp_lg_u32 s62, 0
    s_cbranch_scc1 sk_103
    s_nop 9
    v_cndmask_b32 v32, v32, v26, s[64:65]
    v_cndmask_b32 v33, v33, v26, s[66:67]
    v_cndmask_b32 v34, v34, v26, s[68:69]
    v_cndmask_b32 v35, v35, v26, s[70:71]
    v_cndmask_b32 v36, v36, v26, s[72:73]
    v_cndmask_b32 v37, v37, v26, s[74:75]
    v_cndmask_b32 v38, v38, v26, s[76:77]
    v_cndmask_b32 v39, v39, v26, s[78:79]
    v_cndmask_b32 v40, v40, v26, s[80:81]
    v_cndmask_b32 v41, v41, v26, s[82:83]
    v_cndmask_b32 v42, v42, v26, s[84:85]
    v_cndmask_b32 v43, v43, v26, s[86:87]
    v_cndmask_b32 v44, v44, v26, s[88:89]
    v_cndmask_b32 v45, v45, v26, s[90:91]
    v_cndmask_b32 v46, v46, v26, s[92:93]
    v_cndmask_b32 v47, v47, v26, s[94:95]
sk_103:
    s_cmp_lg_u32 s62, 8
    s_cbranch_scc1 sk_104
    s_nop 7
    v_cndmask_b32 v32, v26, v32, s[64:65]
    v_cndmask_b32 v33, v26, v33, s[66:67]
    v_cndmask_b32 v34, v26, v34, s[68:69]
    v_cndmask_b32 v35, v26, v35, s[70:71]
    v_cndmask_b32 v36, v26, v36, s[72:73]
    v_cndmask_b32 v37, v26, v37, s[74:75]
    v_cndmask_b32 v38, v26, v38, s[76:77]
    v_cndmask_b32 v39, v26, v39, s[78:79]
    v_cndmask_b32 v40, v26, v40, s[80:81]
    v_cndmask_b32 v41, v26, v41, s[82:83]
    v_cndmask_b32 v42, v26, v42, s[84:85]
    v_cndmask_b32 v43, v26, v43, s[86:87]
    v_cndmask_b32 v44, v26, v44, s[88:89]
    v_cndmask_b32 v45, v26, v45, s[90:91]
    v_cndmask_b32 v46, v26, v46, s[92:93]
    v_cndmask_b32 v47, v26, v47, s[94:95]
sk_104:
    s_nop 7
    v_max3_f32 v27, v32, v33, v27
    v_max3_f32 v27, v34, v35, v27
    v_max3_f32 v27, v36, v37, v27
    v_max3_f32 v27, v38, v39, v27
    v_max3_f32 v27, v40, v41, v27
    v_max3_f32 v27, v42, v43, v27
    v_max3_f32 v27, v44, v45, v27
    v_max3_f32 v27, v46, v47, v27
    v_add_u32 v28, 4096, v28
    s_add_u32 s62, s62, 1
    s_cmp_lt_u32 s62, 9
    s_waitcnt lgkmcnt(0)
    s_cbranch_scc1 fb1_101
    v_mov_b32 v23, v27
    s_nop 1
    v_permlane32_swap_b32 v27, v23
    v_max_f32 v27, v27, v23
    v_mov_b32 v28, v12
    s_mov_b32 s62, 0
    v_mov_b32 v64, 0
    v_mov_b32 v65, 0
    v_mov_b32 v66, 0
    v_mov_b32 v67, 0
    v_mov_b32 v68, 0
    v_mov_b32 v69, 0
    v_mov_b32 v70, 0
    v_mov_b32 v71, 0
    v_mov_b32 v72, 0
    v_mov_b32 v73, 0
    v_mov_b32 v74, 0
    v_mov_b32 v75, 0
    v_mov_b32 v76, 0
    v_mov_b32 v77, 0
    v_mov_b32 v78, 0
    v_mov_b32 v79, 0
fb2_102:
    s_nop 7
    s_nop 4
    ds_read_b128 v[96:99], v28
    ds_read_b128 v[100:103], v28 offset:1024
    ds_read_b128 v[104:107], v28 offset:2048
    ds_read_b128 v[108:111], v28 offset:3072
    s_waitcnt lgkmcnt(3)
    v_mfma_f32_32x32x16_bf16 v[32:47], v[96:99], v[232:235], 0
    s_waitcnt lgkmcnt(2)
    v_mfma_f32_32x32x16_bf16 v[32:47], v[100:103], v[236:239], v[32:47]
    s_cmp_lg_u32 s62, 0
    s_cbranch_scc1 sk_105
    s_nop 9
    v_cndmask_b32 v32, v32, v26, s[64:65]
    v_cndmask_b32 v33, v33, v26, s[66:67]
    v_cndmask_b32 v34, v34, v26, s[68:69]
    v_cndmask_b32 v35, v35, v26, s[70:71]
    v_cndmask_b32 v36, v36, v26, s[72:73]
    v_cndmask_b32 v37, v37, v26, s[74:75]
    v_cndmask_b32 v38, v38, v26, s[76:77]
    v_cndmask_b32 v39, v39, v26, s[78:79]
    v_cndmask_b32 v40, v40, v26, s[80:81]
    v_cndmask_b32 v41, v41, v26, s[82:83]
    v_cndmask_b32 v42, v42, v26, s[84:85]
    v_cndmask_b32 v43, v43, v26, s[86:87]
    v_cndmask_b32 v44, v44, v26, s[88:89]
    v_cndmask_b32 v45, v45, v26, s[90:91]
    v_cndmask_b32 v46, v46, v26, s[92:93]
    v_cndmask_b32 v47, v47, v26, s[94:95]
sk_105:
    s_cmp_lg_u32 s62, 8
    s_cbranch_scc1 sk_106
    s_nop 7
    v_cndmask_b32 v32, v26, v32, s[64:65]
    v_cndmask_b32 v33, v26, v33, s[66:67]
    v_cndmask_b32 v34, v26, v34, s[68:69]
    v_cndmask_b32 v35, v26, v35, s[70:71]
    v_cndmask_b32 v36, v26, v36, s[72:73]
    v_cndmask_b32 v37, v26, v37, s[74:75]
    v_cndmask_b32 v38, v26, v38, s[76:77]
    v_cndmask_b32 v39, v26, v39, s[78:79]
    v_cndmask_b32 v40, v26, v40, s[80:81]
    v_cndmask_b32 v41, v26, v41, s[82:83]
    v_cndmask_b32 v42, v26, v42, s[84:85]
    v_cndmask_b32 v43, v26, v43, s[86:87]
    v_cndmask_b32 v44, v26, v44, s[88:89]
    v_cndmask_b32 v45, v26, v45, s[90:91]
    v_cndmask_b32 v46, v26, v46, s[92:93]
    v_cndmask_b32 v47, v26, v47, s[94:95]
sk_106:
    s_nop 7
    v_sub_f32 v32, v32, v27
    v_sub_f32 v33, v33, v27
    v_sub_f32 v34, v34, v27
    v_sub_f32 v35, v35, v27
    v_sub_f32 v36, v36, v27
    v_sub_f32 v37, v37, v27
    v_sub_f32 v38, v38, v27
    v_sub_f32 v39, v39, v27
    v_sub_f32 v40, v40, v27
    v_sub_f32 v41, v41, v27
    v_sub_f32 v42, v42, v27
    v_sub_f32 v43, v43, v27
    v_sub_f32 v44, v44, v27
    v_sub_f32 v45, v45, v27
    v_sub_f32 v46, v46, v27
    v_sub_f32 v47, v47, v27
    v_exp_f32 v32, v32
    v_exp_f32 v33, v33
    v_exp_f32 v34, v34
    v_exp_f32 v35, v35
    v_exp_f32 v36, v36
    v_exp_f32 v37, v37
    v_exp_f32 v38, v38
    v_exp_f32 v39, v39
    v_exp_f32 v40, v40
    v_exp_f32 v41, v41
    v_exp_f32 v42, v42
    v_exp_f32 v43, v43
    v_exp_f32 v44, v44
    v_exp_f32 v45, v45
    v_exp_f32 v46, v46
    v_exp_f32 v47, v47
    v_cvt_pk_bf16_f32 v48, v32, v33
    v_cvt_pk_bf16_f32 v49, v34, v35
    v_cvt_pk_bf16_f32 v50, v36, v37
    v_cvt_pk_bf16_f32 v51, v38, v39
    v_cvt_pk_bf16_f32 v52, v40, v41
    v_cvt_pk_bf16_f32 v53, v42, v43
    v_cvt_pk_bf16_f32 v54, v44, v45
    v_cvt_pk_bf16_f32 v55, v46, v47
    s_waitcnt lgkmcnt(1)
    v_mfma_f32_32x32x16_bf16 v[64:79], v[104:107], v[48:51], v[64:79]
    s_waitcnt lgkmcnt(0)
    v_mfma_f32_32x32x16_bf16 v[64:79], v[108:111], v[52:55], v[64:79]
    v_add_u32 v28, 4096, v28
    s_add_u32 s62, s62, 1
    s_cmp_lt_u32 s62, 9
    s_waitcnt lgkmcnt(0)
    s_cbranch_scc1 fb2_102
    s_nop 6
    v_mov_b32 v22, v76
    v_mov_b32 v23, v76
    s_nop 1
    v_permlane32_swap_b32 v22, v23
    s_nop 7
    s_branch att_ok_99
p3_skip_107:
    s_barrier
    s_cmp_eq_u32 s7, 0
    s_cbranch_scc1 sk_126
    v_min_u32 v19, 55, v2
    v_lshlrev_b32 v19, 7, v19
    s_add_u32 s0, s61, 0
    buffer_load_dword v0, v19, s[8:11], s0 offen sc1
sk_126:
    s_branch p3_join_108
hwait_164:
    s_mov_b32 s47, 0
poll_165:
    buffer_load_dword v19, v10, s[8:11], s34 offen sc1
    s_add_u32 s47, s47, 1
    s_cmp_gt_u32 s47, 400000
    s_cbranch_scc1 polled_166
    s_waitcnt vmcnt(0)
    v_cmp_gt_u32 vcc, s60, v19
    s_nop 1
    s_cbranch_vccnz poll_165
polled_166:
    s_waitcnt vmcnt(0)
    s_branch hok_163
hwait_170:
    s_mov_b32 s47, 0
poll_171:
    buffer_load_dword v19, v10, s[8:11], s34 offen sc1
    s_add_u32 s47, s47, 1
    s_cmp_gt_u32 s47, 400000
    s_cbranch_scc1 polled_172
    s_waitcnt vmcnt(0)
    v_cmp_gt_u32 vcc, s62, v19
    s_nop 1
    s_cbranch_vccnz poll_171
polled_172:
    s_waitcnt vmcnt(0)
    s_branch hok_169
hwait_174:
    s_mov_b32 s47, 0
poll_175:
    buffer_load_dword v19, v10, s[8:11], s34 offen sc1
    s_add_u32 s47, s47, 1
    s_cmp_gt_u32 s47, 400000
    s_cbranch_scc1 polled_176
    s_waitcnt vmcnt(0)
    v_cmp_gt_u32 vcc, s0, v19
    s_nop 1
    s_cbranch_vccnz poll_175
polled_176:
    s_waitcnt vmcnt(0)
    s_branch hok_173
p5_skip_167:
    s_nop 3
    v_mul_f32 v224, v17, v144
    v_mul_f32 v225, v17, v145
    v_mul_f32 v226, v17, v146
    v_mul_f32 v227, v17, v147
    v_mul_f32 v228, v17, v148
    v_mul_f32 v229, v17, v149
    v_mul_f32 v230, v17, v150
    v_mul_f32 v231, v17, v151
    v_exp_f32 v224, v224
    v_mul_f32 v144, v144, v152
    v_exp_f32 v225, v225
    v_mul_f32 v145, v145, v153
    v_exp_f32 v226, v226
    v_mul_f32 v146, v146, v154
    v_exp_f32 v227, v227
    v_mul_f32 v147, v147, v155
    v_exp_f32 v228, v228
    v_mul_f32 v148, v148, v156
    v_exp_f32 v229, v229
    v_mul_f32 v149, v149, v157
    v_exp_f32 v230, v230
    v_mul_f32 v150, v150, v158
    v_exp_f32 v231, v231
    v_mul_f32 v151, v151, v159
    v_add_f32 v224, 1.0, v224
    v_add_f32 v225, 1.0, v225
    v_add_f32 v226, 1.0, v226
    v_add_f32 v227, 1.0, v227
    v_add_f32 v228, 1.0, v228
    v_add_f32 v229, 1.0, v229
    v_add_f32 v230, 1.0, v230
    v_add_f32 v231, 1.0, v231
    v_rcp_f32 v224, v224
    v_rcp_f32 v225, v225
    v_mul_f32 v144, v144, v224
    v_rcp_f32 v226, v226
    v_mul_f32 v145, v145, v225
    v_rcp_f32 v227, v227
    v_mul_f32 v146, v146, v226
    v_rcp_f32 v228, v228
    v_mul_f32 v147, v147, v227
    v_rcp_f32 v229, v229
    v_mul_f32 v148, v148, v228
    v_rcp_f32 v230, v230
    v_mul_f32 v149, v149, v229
    v_rcp_f32 v231, v231
    v_mul_f32 v150, v150, v230
    v_mul_f32 v151, v151, v231
    v_cvt_pk_bf16_f32 v240, v144, v145
    v_cvt_pk_bf16_f32 v241, v146, v147
    v_cvt_pk_bf16_f32 v242, v148, v149
    v_cvt_pk_bf16_f32 v243, v150, v151
    buffer_store_dwordx4 v[240:243], v1, s[8:11], s61 offen offset:2048 sc1
    v_mov_b32 v18, s0
    s_waitcnt vmcnt(0)
    s_mov_b64 exec, 1
    buffer_store_dword v18, v11, s[8:11], s33 offen sc1
    s_mov_b64 exec, -1
    s_cmp_eq_u32 s7, 1
    s_cbranch_scc1 MAIN_tail
    s_barrier
    s_add_u32 m0, s28, 0
    s_add_u32 s24, s27, 0
    buffer_load_dwordx4 v1, s[8:11], s24 offen offset:0 lds
    buffer_load_dwordx4 v1, s[8:11], s24 offen offset:1024 lds
    buffer_load_dwordx4 v1, s[8:11], s24 offen offset:2048 lds
    buffer_load_dwordx4 v1, s[8:11], s24 offen offset:3072 lds
    s_add_u32 m0, s28, 4096
    s_add_u32 s24, s27, 4096
    buffer_load_dwordx4 v1, s[8:11], s24 offen offset:0 lds
    buffer_load_dwordx4 v1, s[8:11], s24 offen offset:1024 lds
    buffer_load_dwordx4 v1, s[8:11], s24 offen offset:2048 lds
    buffer_load_dwordx4 v1, s[8:11], s24 offen offset:3072 lds
    s_add_u32 m0, s28, 8192
    s_add_u32 s24, s27, 8192
    buffer_load_dwordx4 v1, s[8:11], s24 offen offset:0 lds
    buffer_load_dwordx4 v1, s[8:11], s24 offen offset:1024 lds
    buffer_load_dwordx4 v1, s[8:11], s24 offen offset:2048 lds
    buffer_load_dwordx4 v1, s[8:11], s24 offen offset:3072 lds
    s_add_u32 m0, s28, 12288
    s_add_u32 s24, s27, 12288
    buffer_load_dwordx4 v1, s[8:11], s24 offen offset:0 lds
    buffer_load_dwordx4 v1, s[8:11], s24 offen offset:1024 lds
    buffer_load_dwordx4 v1, s[8:11], s24 offen offset:2048 lds
    buffer_load_dwordx4 v1, s[8:11], s24 offen offset:3072 lds
    s_add_u32 m0, s28, 16384
    s_add_u32 s24, s27, 16384
    buffer_load_dwordx4 v1, s[8:11], s24 offen offset:0 lds
    buffer_load_dwordx4 v1, s[8:11], s24 offen offset:1024 lds
    buffer_load_dwordx4 v1, s[8:11], s24 offen offset:2048 lds
    buffer_load_dwordx4 v1, s[8:11], s24 offen offset:3072 lds
    s_add_u32 m0, s28, 20480
    s_add_u32 s24, s27, 20480
    buffer_load_dwordx4 v1, s[8:11], s24 offen offset:0 lds
    s_branch p5_join_168
.section .rodata,"a"
.p2align 6
.amdhsa_kernel interleave_layers__sliding_block__glu_gated_swiglu__prompt_kernel
  .amdhsa_next_free_vgpr 512
  .amdhsa_next_free_sgpr 102
  .amdhsa_accum_offset 256
  .amdhsa_group_segment_fixed_size 0
  .amdhsa_kernarg_size 80
  .amdhsa_user_sgpr_count 2
  .amdhsa_user_sgpr_kernarg_segment_ptr 1
  .amdhsa_system_sgpr_workgroup_id_x 1
.end_amdhsa_kernel
.text
```
